```python
import torch

def _softmax(x, axis=-1):
    return torch.softmax(x, dim=axis)

def _gelu(x):
    return torch.nn.functional.gelu(x, approximate='tanh')

def _silu(x):
    return torch.nn.functional.silu(x)

def _sigmoid(x):
    return torch.sigmoid(x)

def _layernorm(x, axis=-1, eps=1e-05):
    m = x.mean(dim=axis, keepdim=True)
    v = x.var(dim=axis, keepdim=True, unbiased=False)
    return (x - m) / torch.sqrt(v + eps)

def _scatter_add(tgt, idx, src, axis=0):
    return tgt.clone().index_add_(axis, idx, src)

def _segment_sum(src, seg, n):
    out = torch.zeros((n,) + src.shape[1:], dtype=src.dtype)
    return out.index_add_(0, seg, src)

def _pad(x, pw):
    flat = tuple((v for pair in reversed(pw) for v in pair))
    return torch.nn.functional.pad(x, flat)
kernel_name = 'recurrent_scan__memory_aug_recurrent_mem_tr__dense_activation_silu__prompt'

def setup_inputs():

    _w = lambda a: (lambda t: t.to(torch.bfloat16) if t.is_floating_point() else t)(torch.as_tensor(a))

    def _A_setup():
        B, S, Dm = (1, 2048, 640)
        H, Dh = (32, 128)
        M, seg = (8, 32)
        seg = min(seg, S)
        S = S // seg * seg
        return {'x': _w((lambda *s: torch.randn(*s, dtype=torch.bfloat16) * 0.1)(B, S, Dm)), 'mem0': _w((lambda *s: torch.randn(*s, dtype=torch.bfloat16) * 1.6)(B, M, Dm)), 'Wq': _w((lambda *s: torch.randn(*s, dtype=torch.bfloat16) * 0.8)(Dm, H, Dh) * Dm ** (-0.5)), 'Wk': _w((lambda *s: torch.randn(*s, dtype=torch.bfloat16) * 0.8)(Dm, H, Dh) * Dm ** (-0.5)), 'Wv': _w((lambda *s: torch.randn(*s, dtype=torch.bfloat16) * 1.6)(Dm, H, Dh) * Dm ** (-0.5)), 'Wo': _w((lambda *s: torch.randn(*s, dtype=torch.bfloat16) * 1.6)(H, Dh, Dm) * (H * Dh) ** (-0.5)), 'seg_len': seg}
    _A_in = _A_setup()

    def _B_setup():
        B, S, D, F = (1, 2048, 640, 1728)
        return {'x': _w((lambda *s: torch.randn(*s, dtype=torch.bfloat16) * 0.1)(B, S, D)), 'w1': _w((lambda *s: torch.randn(*s, dtype=torch.bfloat16) * 0.4)(D, F) * D ** (-0.5)), 'w2': _w((lambda *s: torch.randn(*s, dtype=torch.bfloat16) * 0.4)(F, D) * F ** (-0.5))}
    _B_in = _B_setup()
    return {'A_x': _A_in['x'], 'A_mem0': _A_in['mem0'], 'A_Wq': _A_in['Wq'], 'A_Wk': _A_in['Wk'], 'A_Wv': _A_in['Wv'], 'A_Wo': _A_in['Wo'], 'A_seg_len': _A_in['seg_len'], 'B_x': _B_in['x'], 'B_w1': _B_in['w1'], 'B_w2': _B_in['w2']}

def reference(A_x, A_mem0, A_Wq, A_Wk, A_Wv, A_Wo, A_seg_len, B_x, B_w1, B_w2):

    def _A_ref(x, mem0, Wq, Wk, Wv, Wo, seg_len):
        B, S, Dm = x.shape
        H, Dh = (Wq.shape[1], Wq.shape[2])
        M = mem0.shape[1]
        scale = Dh ** (-0.5)
        n_seg = S // seg_len
        L = M + seg_len
        idx = torch.arange(L)
        mask = (idx[:, None] < M) | (idx[:, None] >= idx[None, :])
        mem = mem0
        outs = []
        for s in range(n_seg):
            xs = x[:, s * seg_len:(s + 1) * seg_len, :].clone()
            h = torch.concatenate([mem, xs], axis=1)
            q = torch.einsum('btd,dhe->bhte', h, Wq)
            k = torch.einsum('btd,dhe->bhte', h, Wk)
            v = torch.einsum('btd,dhe->bhte', h, Wv)
            scores = torch.einsum('bhqe,bhke->bhqk', q, k) * scale
            scores = torch.where(mask[None, None], scores, -1000000000.0)
            p = _softmax(scores, axis=-1)
            o = torch.einsum('bhqk,bhke->bhqe', p, v)
            o = torch.einsum('bhte,hed->btd', o, Wo)
            mem = o[:, :M, :].clone()
            outs.append(o[:, M:, :])
        return torch.concatenate(outs, axis=1)

    def _B_ref(x, w1, w2):
        h = torch.einsum('bsd,df->bsf', x, w1)
        h = _silu(h)
        out = torch.einsum('bsf,fd->bsd', h, w2)
        return out
    x = A_x
    xn = _layernorm(x, axis=-1)
    s = _A_ref(xn, A_mem0, A_Wq, A_Wk, A_Wv, A_Wo, A_seg_len)
    g = _silu(_B_ref(xn, B_w1, B_w2))
    return x + s * g
```

```asm
; @launch grid=(256,1,1) block=(256,1,1) lds=163840
.amdgcn_target "amdgcn-amd-amdhsa--gfx950"
.text
.globl recurrent_scan__memory_aug_recurrent_mem_tr__dense_activation_silu__prompt_kernel
.p2align 8
.type recurrent_scan__memory_aug_recurrent_mem_tr__dense_activation_silu__prompt_kernel,@function
recurrent_scan__memory_aug_recurrent_mem_tr__dense_activation_silu__prompt_kernel:
    s_load_dwordx2 s[12:13], s[0:1], 96
    s_load_dwordx2 s[6:7], s[0:1], 88
    s_getreg_b32 s8, hwreg(HW_REG_XCC_ID, 0, 4)
    s_and_b32 s8, s8, 7
    s_lshl_b32 s8, s8, 2
    s_lshr_b32 s8, 0x76541302, s8
    s_and_b32 s8, s8, 7
    v_lshrrev_b32 v1, 6, v0
    s_nop 0
    v_readfirstlane_b32 s10, v1
    v_and_b32 v0, 63, v0
    s_lshl_b32 s60, s8, 6
    s_lshl_b32 s61, s8, 2
    s_add_u32 s61, s61, 128
    s_cmp_lt_u32 s8, 2
    s_cselect_b32 s60, s60, s61
    s_waitcnt lgkmcnt(0)
    s_cmp_lg_u32 s10, 0
    s_cbranch_scc1 P_tk
    v_mov_b32 v2, 1
    v_mov_b32 v3, s60
    s_mov_b64 exec, 1
    global_atomic_add v4, v3, v2, s[6:7] sc0
    v_mov_b32 v5, 0
    s_waitcnt vmcnt(0)
    ds_write_b32 v5, v4
    s_waitcnt lgkmcnt(0)
    s_mov_b64 exec, -1
P_tk:
    s_add_u32 s12, s12, 0x1fffff
    s_addc_u32 s13, s13, 0
    s_and_b32 s12, s12, 0xffe00000
    s_mov_b32 s14, 266338304
    s_mov_b32 s15, 0x00020000
    s_cmp_lg_u32 s10, 3
    s_cbranch_scc1 P_nw
    buffer_load_dword v6, off, s[12:15], 0 offset:4092
P_nw:
    s_barrier
    v_mov_b32 v5, 0
    ds_read_b32 v4, v5
    s_waitcnt lgkmcnt(0)
    v_readfirstlane_b32 s9, v4
    s_cmp_ge_u32 s9, 32
    s_cbranch_scc1 P_end
    s_cmp_ge_u32 s8, 2
    s_cbranch_scc1 P_worker
    s_cmp_eq_u32 s10, 3
    s_cbranch_scc0 C_novote
    s_and_b32 s61, s9, 1
    s_lshl_b32 s60, s9, 1
    s_add_u32 s60, s60, s61
    s_lshl_b32 s60, s60, 6
    s_add_u32 s60, s60, s8
    s_lshl_b32 s60, s60, 7
    s_add_u32 s60, s60, 7168
    v_mov_b32 v21, 1
    v_mov_b32 v22, 0
    s_mov_b32 s25, 0
    s_mov_b64 exec, 1
    s_waitcnt vmcnt(0)
    buffer_store_dword v21, off, s[12:15], s60 sc1
    buffer_load_dword v22, off, s[12:15], s60 sc1
C_vote:
    s_add_u32 s25, s25, 1024
    v_cmp_eq_u32 vcc, 0, v22
    s_cmp_lt_u32 s25, 65536
    s_cbranch_scc0 C_voted
    s_cbranch_vccnz C_vote
C_voted:
    s_mov_b64 exec, -1
    s_sub_u32 s60, 0, s25
    s_cmp_eq_u32 s61, 0
    s_cselect_b32 s25, s25, s60
    s_add_u32 s25, s25, 1
    s_waitcnt vmcnt(0)
C_novote:
    s_load_dwordx2 s[72:73], s[0:1], 16
    s_mov_b32 s74, 5242880
    s_mov_b32 s75, 0x00020000
    s_load_dwordx2 s[76:77], s[0:1], 24
    s_mov_b32 s78, 5242880
    s_mov_b32 s79, 0x00020000
    s_load_dwordx2 s[80:81], s[0:1], 32
    s_mov_b32 s82, 5242880
    s_mov_b32 s83, 0x00020000
    s_load_dwordx2 s[84:85], s[0:1], 40
    s_mov_b32 s86, 5242880
    s_mov_b32 s87, 0x00020000
    s_load_dwordx2 s[88:89], s[0:1], 8
    s_mov_b32 s90, 10240
    s_mov_b32 s91, 0x00020000
    v_mov_b32 v79, v0
    v_lshrrev_b32 v78, 4, v79
    v_and_b32 v77, 15, v79
    v_bfe_u32 v76, v79, 2, 2
    v_and_b32 v75, 3, v79
    v_lshlrev_b32 v0, 4, v79
    s_lshl_b32 s60, s10, 8
    s_add_u32 s60, s60, 4096
    v_lshl_add_u32 v1, v79, 2, s60
    s_xor_b32 s60, s10, 0
    s_lshl_b32 s60, s60, 10
    v_add_u32 v2, s60, v0
    s_xor_b32 s60, s10, 1
    s_lshl_b32 s60, s60, 10
    v_add_u32 v3, s60, v0
    s_xor_b32 s60, s10, 2
    s_lshl_b32 s60, s60, 10
    v_add_u32 v4, s60, v0
    s_xor_b32 s60, s10, 3
    s_lshl_b32 s60, s60, 10
    v_add_u32 v5, s60, v0
    s_add_u32 s60, s10, 1
    s_lshl_b32 s53, s60, 15
    v_add_u32 v6, s53, v0
    s_and_b32 s60, s9, 16
    s_lshl_b32 s60, s60, 1
    s_add_u32 s18, s9, s60
    s_add_u32 s19, s9, 16
    s_cmp_eq_u32 s10, 0
    s_cselect_b32 s11, s18, s19
    s_add_u32 s60, s9, 64
    s_cmp_eq_u32 s10, 2
    s_cselect_b32 s11, s60, s11
    s_cmp_eq_u32 s10, 3
    s_cselect_b32 s11, 99, s11
    s_cmp_lt_u32 s11, 80
    s_cselect_b32 s21, 1, 0
    s_lshl_b32 s60, s8, 19
    s_add_u32 s30, s60, 3162112
    s_add_u32 s31, s30, 0x8000
    s_add_u32 s32, s30, 0x10000
    s_add_u32 s33, s30, 0x18000
    s_add_u32 s34, s30, 0x20000
    s_lshl_b32 s61, s11, 11
    s_add_u32 s35, s30, s61
    s_lshl_b32 s60, s8, 15
    s_add_u32 s54, s60, 2164736
    s_lshl_b32 s55, s11, 6
    s_lshl_b32 s60, s8, 14
    s_add_u32 s39, s60, s55
    s_xor_b32 s37, s60, 0x4000
    s_mul_i32 s60, s9, 16384
    s_lshl_b32 s61, s10, 11
    s_add_u32 s41, s60, s61
    s_add_u32 s41, s41, 16777216
    s_mul_i32 s60, s9, 266240
    s_lshl_b32 s61, s8, 11
    s_add_u32 s42, s60, s61
    s_add_u32 s42, s42, 7340032
    s_lshl_b32 s60, s9, 14
    s_add_u32 s44, s60, 5120
    s_mov_b32 s46, 0xcccccccc
    s_mov_b32 s47, 0xcccccccc
    s_mov_b32 s48, 0x33333333
    s_mov_b32 s49, 0x33333333
    s_mov_b32 s50, 0x000f000f
    s_mov_b32 s51, 0x000f000f
    s_mov_b32 s52, 0x3e0293ee
    s_mov_b32 s20, 0
    s_mov_b32 s43, 0
    s_waitcnt lgkmcnt(0)
    v_mov_b32 v40, -1
    v_mov_b32 v41, -1
    v_mov_b32 v42, -1
    v_mov_b32 v43, -1
    s_lshl_b32 s60, s10, 9
    v_lshl_add_u32 v20, v79, 3, s60
    s_add_u32 s60, s42, 258048
    s_sub_u32 s60, s60, 4096
    s_sub_u32 s60, s60, 4096
    s_sub_u32 s60, s60, 4096
    s_sub_u32 s60, s60, 4096
    s_sub_u32 s60, s60, 4096
    s_cmp_eq_u32 s21, 0
    s_cbranch_scc1 C_noinit
    s_and_b32 s60, s11, 3
    s_mul_i32 s60, s60, 2560
    s_lshr_b32 s61, s11, 2
    s_lshl_b32 s61, s61, 5
    s_add_u32 s60, s60, s61
    s_mul_i32 s61, s8, 640
    s_add_u32 s60, s60, s61
    v_and_b32 v20, 1, v79
    v_mul_u32_u24 v20, 1280, v20
    v_bfe_u32 v21, v79, 1, 1
    v_lshl_add_u32 v20, v21, 2, v20
    buffer_load_dword v44, v20, s[88:91], s60 offen
    buffer_load_dword v45, v20, s[88:91], s60 offen offset:8
    buffer_load_dword v46, v20, s[88:91], s60 offen offset:16
    buffer_load_dword v47, v20, s[88:91], s60 offen offset:24
    buffer_store_dwordx4 v[40:43], v0, s[12:15], s35 offen
    buffer_store_dwordx4 v[40:43], v0, s[12:15], s35 offen offset:1024
    s_xor_b32 s60, s35, 0x40000
    buffer_store_dwordx4 v[40:43], v0, s[12:15], s60 offen
    buffer_store_dwordx4 v[40:43], v0, s[12:15], s60 offen offset:1024
    v_lshrrev_b32 v21, 2, v79
    v_lshlrev_b32 v22, 13, v21
    v_lshl_add_u32 v22, v75, 4, v22
    s_add_u32 s60, s54, s55
    s_mov_b64 exec, 0xfff0
    buffer_store_dwordx4 v[40:43], v22, s[12:15], s60 offen
    s_mov_b64 exec, -1
    v_lshrrev_b32 v23, 3, v79
    v_lshlrev_b32 v23, 15, v23
    v_and_b32 v24, 1, v21
    v_lshl_add_u32 v23, v24, 13, v23
    v_lshl_add_u32 v23, v75, 4, v23
    s_mov_b32 exec_lo, 0xffffff00
    buffer_store_dwordx4 v[40:43], v23, s[12:15], s39 offen sc1
    s_mov_b32 exec_lo, -1
    s_add_u32 s61, s39, 262144
    buffer_store_dwordx4 v[40:43], v23, s[12:15], s61 offen sc1
    s_add_u32 s61, s39, 524288
    buffer_store_dwordx4 v[40:43], v23, s[12:15], s61 offen sc1
    s_add_u32 s61, s39, 786432
    buffer_store_dwordx4 v[40:43], v23, s[12:15], s61 offen sc1
    s_add_u32 s61, s39, 1048576
    buffer_store_dwordx4 v[40:43], v23, s[12:15], s61 offen sc1
    s_add_u32 s61, s39, 1310720
    buffer_store_dwordx4 v[40:43], v23, s[12:15], s61 offen sc1
    s_add_u32 s61, s39, 1572864
    buffer_store_dwordx4 v[40:43], v23, s[12:15], s61 offen sc1
    s_add_u32 s61, s39, 1835008
    buffer_store_dwordx4 v[40:43], v23, s[12:15], s61 offen sc1
    s_waitcnt vmcnt(13)
    s_mov_b64 exec, 0xf
    buffer_store_dwordx4 v[44:47], v22, s[12:15], s60 offen
    s_mov_b64 exec, 0xff
    buffer_store_dwordx4 v[44:47], v23, s[12:15], s39 offen sc1
    s_mov_b64 exec, -1
C_noinit:
    s_cmp_eq_u32 s10, 3
    s_cbranch_scc0 C_noflag
    s_cmp_eq_u32 s8, 0
    s_cbranch_scc0 C_noflag
    v_mov_b32 v48, 0
    v_mov_b32 v49, 0
    v_mov_b32 v50, 0
    v_mov_b32 v51, 0
    s_add_u32 s60, s44, 8192
    buffer_store_dwordx4 v[48:51], v0, s[12:15], s44 offen sc1
    buffer_store_dwordx4 v[48:51], v0, s[12:15], s60 offen sc1
C_noflag:
    s_lshl_b32 s60, s10, 4
    v_add_u32 v20, s60, v78
    v_lshlrev_b32 v20, 13, v20
    v_lshlrev_b32 v21, 1, v78
    v_xor_b32 v21, v21, v77
    v_lshl_add_u32 v20, v21, 4, v20
    s_lshl_b32 s60, s9, 8
    v_add_u32 v16, s60, v20
    v_lshrrev_b32 v20, 3, v79
    v_and_b32 v21, 1, v20
    v_and_b32 v22, 4, v20
    v_lshl_add_u32 v21, v21, 1, v22
    v_and_b32 v22, 7, v79
    v_xor_b32 v21, v21, v22
    s_lshl_b32 s60, s10, 5
    v_add_u32 v20, s60, v20
    v_mul_u32_u24 v20, 1280, v20
    v_lshl_add_u32 v20, v21, 4, v20
    s_mul_i32 s60, s9, 163840
    s_mul_i32 s61, s8, 640
    s_add_u32 s60, s60, s61
    v_add_u32 v19, s60, v20
    s_mul_i32 s56, s8, 2621440
    s_sub_u32 s57, 2621440, s56
    s_and_b32 s60, s9, 3
    s_cmp_eq_u32 s60, 1
    s_cselect_b64 vcc, -1, 0
    s_add_u32 m0, s53, 0
    s_add_u32 s61, s56, 0
    buffer_load_dwordx4 v16, s[72:75], s61 offen  lds
    s_add_u32 m0, s53, 1024
    s_add_u32 s61, s56, 32768
    buffer_load_dwordx4 v16, s[72:75], s61 offen  lds
    s_add_u32 m0, s53, 2048
    s_add_u32 s61, s56, 65536
    buffer_load_dwordx4 v16, s[72:75], s61 offen  lds
    s_add_u32 m0, s53, 3072
    s_add_u32 s61, s56, 98304
    buffer_load_dwordx4 v16, s[72:75], s61 offen  lds
    s_add_u32 m0, s53, 4096
    s_add_u32 s61, s56, 524288
    buffer_load_dwordx4 v16, s[72:75], s61 offen  lds
    s_add_u32 m0, s53, 5120
    s_add_u32 s61, s56, 557056
    buffer_load_dwordx4 v16, s[72:75], s61 offen  lds
    s_add_u32 m0, s53, 6144
    s_add_u32 s61, s56, 589824
    buffer_load_dwordx4 v16, s[72:75], s61 offen  lds
    s_add_u32 m0, s53, 7168
    s_add_u32 s61, s56, 622592
    buffer_load_dwordx4 v16, s[72:75], s61 offen  lds
    s_add_u32 m0, s53, 8192
    s_add_u32 s61, s56, 1048576
    buffer_load_dwordx4 v16, s[72:75], s61 offen  lds
    s_add_u32 m0, s53, 9216
    s_add_u32 s61, s56, 1081344
    buffer_load_dwordx4 v16, s[72:75], s61 offen  lds
    s_add_u32 m0, s53, 10240
    s_add_u32 s61, s56, 1114112
    buffer_load_dwordx4 v16, s[72:75], s61 offen  lds
    s_add_u32 m0, s53, 11264
    s_add_u32 s61, s56, 1146880
    buffer_load_dwordx4 v16, s[72:75], s61 offen  lds
    s_cbranch_vccnz C_w0_3_0
    s_waitcnt vmcnt(11)
C_w0_3_0:
    s_add_u32 m0, s53, 12288
    s_add_u32 s61, s56, 1572864
    buffer_load_dwordx4 v16, s[72:75], s61 offen  lds
    s_cbranch_vccnz C_w0_3_1
    s_waitcnt vmcnt(11)
C_w0_3_1:
    s_add_u32 m0, s53, 13312
    s_add_u32 s61, s56, 1605632
    buffer_load_dwordx4 v16, s[72:75], s61 offen  lds
    s_cbranch_vccnz C_w0_3_2
    s_waitcnt vmcnt(11)
C_w0_3_2:
    s_add_u32 m0, s53, 14336
    s_add_u32 s61, s56, 1638400
    buffer_load_dwordx4 v16, s[72:75], s61 offen  lds
    s_cbranch_vccnz C_w0_3_3
    s_waitcnt vmcnt(11)
C_w0_3_3:
    s_add_u32 m0, s53, 15360
    s_add_u32 s61, s56, 1671168
    buffer_load_dwordx4 v16, s[72:75], s61 offen  lds
    s_and_b32 s60, s9, 3
    s_cmp_eq_u32 s60, 1
    s_cselect_b64 vcc, -1, 0
    s_cbranch_vccnz C_w1_0_0
    s_waitcnt vmcnt(7)
C_w1_0_0:
    s_add_u32 m0, s53, 16384
    s_add_u32 s61, s56, 2097152
    buffer_load_dwordx4 v16, s[72:75], s61 offen  lds
    s_cbranch_vccnz C_w1_0_1
    s_waitcnt vmcnt(7)
C_w1_0_1:
    s_add_u32 m0, s53, 17408
    s_add_u32 s61, s56, 2129920
    buffer_load_dwordx4 v16, s[72:75], s61 offen  lds
    s_cbranch_vccnz C_w1_0_2
    s_waitcnt vmcnt(7)
C_w1_0_2:
    s_add_u32 m0, s53, 18432
    s_add_u32 s61, s56, 2162688
    buffer_load_dwordx4 v16, s[72:75], s61 offen  lds
    s_cbranch_vccnz C_w1_0_3
    s_waitcnt vmcnt(7)
C_w1_0_3:
    s_add_u32 m0, s53, 19456
    s_add_u32 s61, s56, 2195456
    buffer_load_dwordx4 v16, s[72:75], s61 offen  lds
    s_cbranch_vccnz C_w1_1_0
    s_waitcnt vmcnt(7)
C_w1_1_0:
    s_add_u32 m0, s53, 20480
    s_add_u32 s61, s56, 2097152
    buffer_load_dwordx4 v16, s[76:79], s61 offen  lds
    s_cbranch_vccnz C_w1_1_1
    s_waitcnt vmcnt(7)
C_w1_1_1:
    s_add_u32 m0, s53, 21504
    s_add_u32 s61, s56, 2129920
    buffer_load_dwordx4 v16, s[76:79], s61 offen  lds
    s_cbranch_vccnz C_w1_1_2
    s_waitcnt vmcnt(7)
C_w1_1_2:
    s_add_u32 m0, s53, 22528
    s_add_u32 s61, s56, 2162688
    buffer_load_dwordx4 v16, s[76:79], s61 offen  lds
    s_cbranch_vccnz C_w1_1_3
    s_waitcnt vmcnt(7)
C_w1_1_3:
    s_add_u32 m0, s53, 23552
    s_add_u32 s61, s56, 2195456
    buffer_load_dwordx4 v16, s[76:79], s61 offen  lds
    s_cbranch_vccnz C_w1_2_0
    s_waitcnt vmcnt(7)
C_w1_2_0:
    s_add_u32 m0, s53, 24576
    s_mov_b32 s61, 128
    buffer_load_dwordx4 v19, s[84:87], s61 offen  lds
    s_cbranch_vccnz C_w1_2_1
    s_waitcnt vmcnt(7)
C_w1_2_1:
    s_add_u32 m0, s53, 25600
    s_mov_b32 s61, 10368
    buffer_load_dwordx4 v19, s[84:87], s61 offen  lds
    s_cbranch_vccnz C_w1_2_2
    s_waitcnt vmcnt(7)
C_w1_2_2:
    s_add_u32 m0, s53, 26624
    s_mov_b32 s61, 20608
    buffer_load_dwordx4 v19, s[84:87], s61 offen  lds
    s_cbranch_vccnz C_w1_2_3
    s_waitcnt vmcnt(7)
C_w1_2_3:
    s_add_u32 m0, s53, 27648
    s_mov_b32 s61, 30848
    buffer_load_dwordx4 v19, s[84:87], s61 offen  lds
    s_cbranch_vccnz C_w1_3_0
    s_waitcnt vmcnt(7)
C_w1_3_0:
    s_add_u32 m0, s53, 28672
    s_mov_b32 s61, 256
    buffer_load_dwordx4 v19, s[84:87], s61 offen  lds
    s_cbranch_vccnz C_w1_3_1
    s_waitcnt vmcnt(7)
C_w1_3_1:
    s_add_u32 m0, s53, 29696
    s_mov_b32 s61, 10496
    buffer_load_dwordx4 v19, s[84:87], s61 offen  lds
    s_cbranch_vccnz C_w1_3_2
    s_waitcnt vmcnt(7)
C_w1_3_2:
    s_add_u32 m0, s53, 30720
    s_mov_b32 s61, 20736
    buffer_load_dwordx4 v19, s[84:87], s61 offen  lds
    s_cbranch_vccnz C_w1_3_3
    s_waitcnt vmcnt(7)
C_w1_3_3:
    s_add_u32 m0, s53, 31744
    s_mov_b32 s61, 30976
    buffer_load_dwordx4 v19, s[84:87], s61 offen  lds
    v_lshrrev_b32 v20, 1, v78
    v_add_u32 v20, 1, v20
    v_lshlrev_b32 v20, 15, v20
    v_and_b32 v21, 1, v78
    v_lshl_add_u32 v21, v21, 3, v76
    v_lshl_add_u32 v20, v21, 8, v20
    v_lshrrev_b32 v21, 1, v75
    s_lshl_b32 s60, s10, 2
    v_add_u32 v22, s60, v21
    v_lshlrev_b32 v23, 1, v76
    v_xor_b32 v22, v22, v23
    v_lshl_add_u32 v20, v22, 4, v20
    v_and_b32 v22, 1, v79
    v_lshl_add_u32 v13, v22, 3, v20
    s_lshl_b32 s60, s10, 1
    v_add_u32 v21, s60, v21
    v_xor_b32 v21, v21, v23
    v_lshlrev_b32 v21, 4, v21
    v_lshl_add_u32 v21, v22, 3, v21
    v_bfe_u32 v22, v79, 4, 1
    v_lshl_add_u32 v21, v22, 11, v21
    v_bfe_u32 v22, v79, 5, 1
    v_lshl_add_u32 v21, v22, 10, v21
    v_bfe_u32 v22, v79, 3, 1
    v_lshl_add_u32 v21, v22, 9, v21
    v_bfe_u32 v22, v79, 2, 1
    v_lshl_add_u32 v21, v22, 7, v21
    v_add_u32 v24, 32768, v21
    v_add_u32 v25, 98304, v21
    v_bfe_u32 v20, v79, 3, 1
    v_mul_u32_u24 v20, 528, v20
    v_bfe_u32 v21, v79, 2, 1
    v_lshl_add_u32 v20, v21, 7, v20
    v_lshl_add_u32 v20, v75, 5, v20
    v_xor_b32 v21, v21, v78
    v_lshl_add_u32 v20, v21, 3, v20
    s_mul_i32 s60, s10, 1056
    s_add_u32 s60, s60, 10240
    v_add_u32 v7, s60, v20
    v_and_b32 v21, 1, v78
    v_xor_b32 v21, v21, v79
    v_lshlrev_b32 v21, 3, v21
    v_add_u32 v8, 10240, v21
    v_lshrrev_b32 v20, 1, v78
    v_lshlrev_b32 v20, 8, v20
    v_lshl_add_u32 v20, v76, 6, v20
    v_and_b32 v21, 1, v78
    v_lshl_add_u32 v20, v21, 5, v20
    v_and_b32 v21, 1, v79
    v_lshl_add_u32 v20, v21, 4, v20
    s_lshl_b32 s60, s10, 9
    v_add_u32 v9, s60, v20
    v_lshlrev_b32 v20, 11, v78
    v_lshl_add_u32 v20, v77, 2, v20
    s_lshl_b32 s61, s10, 13
    s_lshl_b32 s62, s9, 6
    s_add_u32 s61, s61, s62
    v_add_u32 v10, s61, v20
    v_lshl_add_u32 v11, v79, 3, s60
    v_mov_b32 v20, 0x88884444
    v_mov_b32 v21, 0x8888eeee
    s_mov_b64 vcc, s[46:47]
    v_cndmask_b32 v12, v20, v21
    v_bfe_u32 v20, v79, 3, 1
    v_mul_u32_u24 v20, 0x5555, v20
    v_lshl_or_b32 v12, v20, 16, v12
    v_lshlrev_b32 v20, 9, v78
    v_bfe_u32 v21, v79, 3, 1
    v_lshl_add_u32 v21, v21, 8, v20
    v_and_b32 v22, 7, v79
    v_lshl_add_u32 v21, v22, 4, v21
    v_lshl_add_u32 v20, v77, 4, v20
    v_add_u32 v20, 6144, v20
    v_bfe_u32 v22, v79, 4, 1
    v_lshlrev_b32 v22, 5, v22
    v_bfe_u32 v23, v79, 5, 1
    v_lshl_add_u32 v22, v23, 4, v22
    v_lshl_add_u32 v22, v75, 2, v22
    ds_write_b32 v0, v21 offset:14464
    ds_write_b32 v0, v20 offset:14468
    ds_write_b32 v0, v22 offset:14472
    v_and_b32 v21, 1, v79
    v_lshlrev_b32 v21, 4, v21
    v_mov_b32 v22, 0x3f80
    v_lshlrev_b32 v21, v21, v22
    v_bfe_u32 v20, v79, 2, 1
    v_cmp_eq_u32 vcc, 0, v20
    s_nop 1
    v_cndmask_b32 v28, 0, v21, vcc
    v_cmp_eq_u32 vcc, 1, v20
    s_nop 1
    v_cndmask_b32 v29, 0, v21, vcc
    ds_write_b64 v8, v[28:29] offset:5248
    s_waitcnt vmcnt(16)
    s_barrier
    s_cmp_eq_u32 s10, 3
    s_cbranch_scc0 C_noatom
    v_mov_b32 v20, s25
    v_mov_b32 v21, 192
    s_mov_b64 exec, 1
    global_atomic_add v21, v20, s[6:7]
    s_mov_b64 exec, -1
C_noatom:
    s_xor_b32 s60, s10, 0
    s_lshl_b32 s60, s60, 12
    v_add_u32 v14, s60, v13
    v_xor_b32 v15, 32, v14
    ds_read_b64_tr_b16 v[80:81], v14 offset:0
    ds_read_b64_tr_b16 v[82:83], v14 offset:1024
    ds_read_b64_tr_b16 v[88:89], v15 offset:0
    ds_read_b64_tr_b16 v[90:91], v15 offset:1024
    v_add_u32 v14, 0x10000, v14
    v_add_u32 v15, 0x10000, v15
    ds_read_b64_tr_b16 v[84:85], v14 offset:0
    ds_read_b64_tr_b16 v[86:87], v14 offset:1024
    ds_read_b64_tr_b16 v[92:93], v15 offset:0
    ds_read_b64_tr_b16 v[94:95], v15 offset:1024
    s_xor_b32 s60, s10, 1
    s_lshl_b32 s60, s60, 12
    v_add_u32 v14, s60, v13
    v_xor_b32 v15, 32, v14
    ds_read_b64_tr_b16 v[96:97], v14 offset:0
    ds_read_b64_tr_b16 v[98:99], v14 offset:1024
    ds_read_b64_tr_b16 v[104:105], v15 offset:0
    ds_read_b64_tr_b16 v[106:107], v15 offset:1024
    v_add_u32 v14, 0x10000, v14
    v_add_u32 v15, 0x10000, v15
    ds_read_b64_tr_b16 v[100:101], v14 offset:0
    ds_read_b64_tr_b16 v[102:103], v14 offset:1024
    ds_read_b64_tr_b16 v[108:109], v15 offset:0
    ds_read_b64_tr_b16 v[110:111], v15 offset:1024
    s_xor_b32 s60, s10, 2
    s_lshl_b32 s60, s60, 12
    v_add_u32 v14, s60, v13
    v_xor_b32 v15, 32, v14
    ds_read_b64_tr_b16 v[112:113], v14 offset:0
    ds_read_b64_tr_b16 v[114:115], v14 offset:1024
    ds_read_b64_tr_b16 v[120:121], v15 offset:0
    ds_read_b64_tr_b16 v[122:123], v15 offset:1024
    v_add_u32 v14, 0x10000, v14
    v_add_u32 v15, 0x10000, v15
    ds_read_b64_tr_b16 v[116:117], v14 offset:0
    ds_read_b64_tr_b16 v[118:119], v14 offset:1024
    ds_read_b64_tr_b16 v[124:125], v15 offset:0
    ds_read_b64_tr_b16 v[126:127], v15 offset:1024
    s_xor_b32 s60, s10, 3
    s_lshl_b32 s60, s60, 12
    v_add_u32 v14, s60, v13
    v_xor_b32 v15, 32, v14
    ds_read_b64_tr_b16 v[128:129], v14 offset:0
    ds_read_b64_tr_b16 v[130:131], v14 offset:1024
    ds_read_b64_tr_b16 v[136:137], v15 offset:0
    ds_read_b64_tr_b16 v[138:139], v15 offset:1024
    v_add_u32 v14, 0x10000, v14
    v_add_u32 v15, 0x10000, v15
    ds_read_b64_tr_b16 v[132:133], v14 offset:0
    ds_read_b64_tr_b16 v[134:135], v14 offset:1024
    ds_read_b64_tr_b16 v[140:141], v15 offset:0
    ds_read_b64_tr_b16 v[142:143], v15 offset:1024
    s_waitcnt lgkmcnt(0)
    s_barrier
    s_and_b32 s60, s9, 3
    s_cmp_eq_u32 s60, 1
    s_cselect_b64 vcc, -1, 0
    s_cbranch_vccnz C_w2_0_0
    s_waitcnt vmcnt(7)
C_w2_0_0:
    s_add_u32 m0, s53, 0
    s_add_u32 s61, s57, 0
    buffer_load_dwordx4 v16, s[72:75], s61 offen  lds
    s_cbranch_vccnz C_w2_0_1
    s_waitcnt vmcnt(7)
C_w2_0_1:
    s_add_u32 m0, s53, 1024
    s_add_u32 s61, s57, 32768
    buffer_load_dwordx4 v16, s[72:75], s61 offen  lds
    s_cbranch_vccnz C_w2_0_2
    s_waitcnt vmcnt(7)
C_w2_0_2:
    s_add_u32 m0, s53, 2048
    s_add_u32 s61, s57, 65536
    buffer_load_dwordx4 v16, s[72:75], s61 offen  lds
    s_cbranch_vccnz C_w2_0_3
    s_waitcnt vmcnt(7)
C_w2_0_3:
    s_add_u32 m0, s53, 3072
    s_add_u32 s61, s57, 98304
    buffer_load_dwordx4 v16, s[72:75], s61 offen  lds
    s_cbranch_vccnz C_w2_1_0
    s_waitcnt vmcnt(7)
C_w2_1_0:
    s_add_u32 m0, s53, 4096
    s_add_u32 s61, s57, 524288
    buffer_load_dwordx4 v16, s[72:75], s61 offen  lds
    s_cbranch_vccnz C_w2_1_1
    s_waitcnt vmcnt(7)
C_w2_1_1:
    s_add_u32 m0, s53, 5120
    s_add_u32 s61, s57, 557056
    buffer_load_dwordx4 v16, s[72:75], s61 offen  lds
    s_cbranch_vccnz C_w2_1_2
    s_waitcnt vmcnt(7)
C_w2_1_2:
    s_add_u32 m0, s53, 6144
    s_add_u32 s61, s57, 589824
    buffer_load_dwordx4 v16, s[72:75], s61 offen  lds
    s_cbranch_vccnz C_w2_1_3
    s_waitcnt vmcnt(7)
C_w2_1_3:
    s_add_u32 m0, s53, 7168
    s_add_u32 s61, s57, 622592
    buffer_load_dwordx4 v16, s[72:75], s61 offen  lds
    s_cbranch_vccnz C_w2_2_0
    s_waitcnt vmcnt(7)
C_w2_2_0:
    s_add_u32 m0, s53, 8192
    s_add_u32 s61, s57, 1048576
    buffer_load_dwordx4 v16, s[72:75], s61 offen  lds
    s_cbranch_vccnz C_w2_2_1
    s_waitcnt vmcnt(7)
C_w2_2_1:
    s_add_u32 m0, s53, 9216
    s_add_u32 s61, s57, 1081344
    buffer_load_dwordx4 v16, s[72:75], s61 offen  lds
    s_cbranch_vccnz C_w2_2_2
    s_waitcnt vmcnt(7)
C_w2_2_2:
    s_add_u32 m0, s53, 10240
    s_add_u32 s61, s57, 1114112
    buffer_load_dwordx4 v16, s[72:75], s61 offen  lds
    s_cbranch_vccnz C_w2_2_3
    s_waitcnt vmcnt(7)
C_w2_2_3:
    s_add_u32 m0, s53, 11264
    s_add_u32 s61, s57, 1146880
    buffer_load_dwordx4 v16, s[72:75], s61 offen  lds
    s_cbranch_vccnz C_w2_3_0
    s_waitcnt vmcnt(7)
C_w2_3_0:
    s_add_u32 m0, s53, 12288
    s_add_u32 s61, s57, 1572864
    buffer_load_dwordx4 v16, s[72:75], s61 offen  lds
    s_cbranch_vccnz C_w2_3_1
    s_waitcnt vmcnt(7)
C_w2_3_1:
    s_add_u32 m0, s53, 13312
    s_add_u32 s61, s57, 1605632
    buffer_load_dwordx4 v16, s[72:75], s61 offen  lds
    s_cbranch_vccnz C_w2_3_2
    s_waitcnt vmcnt(7)
C_w2_3_2:
    s_add_u32 m0, s53, 14336
    s_add_u32 s61, s57, 1638400
    buffer_load_dwordx4 v16, s[72:75], s61 offen  lds
    s_cbranch_vccnz C_w2_3_3
    s_waitcnt vmcnt(7)
C_w2_3_3:
    s_add_u32 m0, s53, 15360
    s_add_u32 s61, s57, 1671168
    buffer_load_dwordx4 v16, s[72:75], s61 offen  lds
    s_waitcnt vmcnt(16)
    s_barrier
    v_add_u32 v14, 0, v13
    v_xor_b32 v15, 32, v14
    ds_read_b64_tr_b16 v[144:145], v14 offset:16384
    ds_read_b64_tr_b16 v[146:147], v14 offset:17408
    ds_read_b64_tr_b16 v[152:153], v15 offset:16384
    ds_read_b64_tr_b16 v[154:155], v15 offset:17408
    v_add_u32 v14, 0x10000, v14
    v_add_u32 v15, 0x10000, v15
    ds_read_b64_tr_b16 v[148:149], v14 offset:16384
    ds_read_b64_tr_b16 v[150:151], v14 offset:17408
    ds_read_b64_tr_b16 v[156:157], v15 offset:16384
    ds_read_b64_tr_b16 v[158:159], v15 offset:17408
    v_add_u32 v14, 4096, v13
    v_xor_b32 v15, 32, v14
    ds_read_b64_tr_b16 v[224:225], v14 offset:16384
    ds_read_b64_tr_b16 v[226:227], v14 offset:17408
    ds_read_b64_tr_b16 v[232:233], v15 offset:16384
    ds_read_b64_tr_b16 v[234:235], v15 offset:17408
    v_add_u32 v14, 0x10000, v14
    v_add_u32 v15, 0x10000, v15
    ds_read_b64_tr_b16 v[228:229], v14 offset:16384
    ds_read_b64_tr_b16 v[230:231], v14 offset:17408
    ds_read_b64_tr_b16 v[236:237], v15 offset:16384
    ds_read_b64_tr_b16 v[238:239], v15 offset:17408
    ds_read_b64_tr_b16 a[208:209], v24 offset:24576
    ds_read_b64_tr_b16 a[210:211], v24 offset:24832
    ds_read_b64_tr_b16 a[212:213], v24 offset:57344
    ds_read_b64_tr_b16 a[214:215], v24 offset:57600
    ds_read_b64_tr_b16 a[216:217], v25 offset:24576
    ds_read_b64_tr_b16 a[218:219], v25 offset:24832
    ds_read_b64_tr_b16 a[220:221], v25 offset:57344
    ds_read_b64_tr_b16 a[222:223], v25 offset:57600
    ds_read_b64_tr_b16 a[224:225], v24 offset:28672
    ds_read_b64_tr_b16 a[226:227], v24 offset:28928
    ds_read_b64_tr_b16 a[228:229], v24 offset:61440
    ds_read_b64_tr_b16 a[230:231], v24 offset:61696
    ds_read_b64_tr_b16 a[232:233], v25 offset:28672
    ds_read_b64_tr_b16 a[234:235], v25 offset:28928
    ds_read_b64_tr_b16 a[236:237], v25 offset:61440
    ds_read_b64_tr_b16 a[238:239], v25 offset:61696
    s_waitcnt lgkmcnt(0)
    s_barrier
    s_and_b32 s60, s9, 3
    s_cmp_eq_u32 s60, 1
    s_cselect_b64 vcc, -1, 0
    s_cbranch_vccnz C_w3_0_0
    s_waitcnt vmcnt(7)
C_w3_0_0:
    s_add_u32 m0, s53, 16384
    s_add_u32 s61, s57, 2097152
    buffer_load_dwordx4 v16, s[72:75], s61 offen  lds
    s_cbranch_vccnz C_w3_0_1
    s_waitcnt vmcnt(7)
C_w3_0_1:
    s_add_u32 m0, s53, 17408
    s_add_u32 s61, s57, 2129920
    buffer_load_dwordx4 v16, s[72:75], s61 offen  lds
    s_cbranch_vccnz C_w3_0_2
    s_waitcnt vmcnt(7)
C_w3_0_2:
    s_add_u32 m0, s53, 18432
    s_add_u32 s61, s57, 2162688
    buffer_load_dwordx4 v16, s[72:75], s61 offen  lds
    s_cbranch_vccnz C_w3_0_3
    s_waitcnt vmcnt(7)
C_w3_0_3:
    s_add_u32 m0, s53, 19456
    s_add_u32 s61, s57, 2195456
    buffer_load_dwordx4 v16, s[72:75], s61 offen  lds
    s_cbranch_vccnz C_w3_1_0
    s_waitcnt vmcnt(7)
C_w3_1_0:
    s_add_u32 m0, s53, 20480
    s_add_u32 s61, s57, 2097152
    buffer_load_dwordx4 v16, s[76:79], s61 offen  lds
    s_cbranch_vccnz C_w3_1_1
    s_waitcnt vmcnt(7)
C_w3_1_1:
    s_add_u32 m0, s53, 21504
    s_add_u32 s61, s57, 2129920
    buffer_load_dwordx4 v16, s[76:79], s61 offen  lds
    s_cbranch_vccnz C_w3_1_2
    s_waitcnt vmcnt(7)
C_w3_1_2:
    s_add_u32 m0, s53, 22528
    s_add_u32 s61, s57, 2162688
    buffer_load_dwordx4 v16, s[76:79], s61 offen  lds
    s_cbranch_vccnz C_w3_1_3
    s_waitcnt vmcnt(7)
C_w3_1_3:
    s_add_u32 m0, s53, 23552
    s_add_u32 s61, s57, 2195456
    buffer_load_dwordx4 v16, s[76:79], s61 offen  lds
    s_cbranch_vccnz C_w3_2_0
    s_waitcnt vmcnt(7)
C_w3_2_0:
    s_add_u32 m0, s53, 24576
    s_add_u32 s61, s57, 2097152
    buffer_load_dwordx4 v16, s[80:83], s61 offen  lds
    s_cbranch_vccnz C_w3_2_1
    s_waitcnt vmcnt(7)
C_w3_2_1:
    s_add_u32 m0, s53, 25600
    s_add_u32 s61, s57, 2129920
    buffer_load_dwordx4 v16, s[80:83], s61 offen  lds
    s_cbranch_vccnz C_w3_2_2
    s_waitcnt vmcnt(7)
C_w3_2_2:
    s_add_u32 m0, s53, 26624
    s_add_u32 s61, s57, 2162688
    buffer_load_dwordx4 v16, s[80:83], s61 offen  lds
    s_cbranch_vccnz C_w3_2_3
    s_waitcnt vmcnt(7)
C_w3_2_3:
    s_add_u32 m0, s53, 27648
    s_add_u32 s61, s57, 2195456
    buffer_load_dwordx4 v16, s[80:83], s61 offen  lds
    s_cbranch_vccnz C_w3_3_0
    s_waitcnt vmcnt(7)
C_w3_3_0:
    s_add_u32 m0, s53, 28672
    s_mov_b32 s61, 384
    buffer_load_dwordx4 v19, s[84:87], s61 offen  lds
    s_cbranch_vccnz C_w3_3_1
    s_waitcnt vmcnt(7)
C_w3_3_1:
    s_add_u32 m0, s53, 29696
    s_mov_b32 s61, 10624
    buffer_load_dwordx4 v19, s[84:87], s61 offen  lds
    s_cbranch_vccnz C_w3_3_2
    s_waitcnt vmcnt(7)
C_w3_3_2:
    s_add_u32 m0, s53, 30720
    s_mov_b32 s61, 20864
    buffer_load_dwordx4 v19, s[84:87], s61 offen  lds
    s_cbranch_vccnz C_w3_3_3
    s_waitcnt vmcnt(7)
C_w3_3_3:
    s_add_u32 m0, s53, 31744
    s_mov_b32 s61, 31104
    buffer_load_dwordx4 v19, s[84:87], s61 offen  lds
    s_waitcnt vmcnt(16)
    s_barrier
    s_xor_b32 s60, s10, 0
    s_lshl_b32 s60, s60, 12
    v_add_u32 v14, s60, v13
    v_xor_b32 v15, 32, v14
    ds_read_b64_tr_b16 v[240:241], v14 offset:0
    ds_read_b64_tr_b16 v[242:243], v14 offset:1024
    ds_read_b64_tr_b16 v[248:249], v15 offset:0
    ds_read_b64_tr_b16 v[250:251], v15 offset:1024
    v_add_u32 v14, 0x10000, v14
    v_add_u32 v15, 0x10000, v15
    ds_read_b64_tr_b16 v[244:245], v14 offset:0
    ds_read_b64_tr_b16 v[246:247], v14 offset:1024
    ds_read_b64_tr_b16 v[252:253], v15 offset:0
    ds_read_b64_tr_b16 v[254:255], v15 offset:1024
    s_xor_b32 s60, s10, 1
    s_lshl_b32 s60, s60, 12
    v_add_u32 v14, s60, v13
    v_xor_b32 v15, 32, v14
    ds_read_b64_tr_b16 a[0:1], v14 offset:0
    ds_read_b64_tr_b16 a[2:3], v14 offset:1024
    ds_read_b64_tr_b16 a[8:9], v15 offset:0
    ds_read_b64_tr_b16 a[10:11], v15 offset:1024
    v_add_u32 v14, 0x10000, v14
    v_add_u32 v15, 0x10000, v15
    ds_read_b64_tr_b16 a[4:5], v14 offset:0
    ds_read_b64_tr_b16 a[6:7], v14 offset:1024
    ds_read_b64_tr_b16 a[12:13], v15 offset:0
    ds_read_b64_tr_b16 a[14:15], v15 offset:1024
    s_xor_b32 s60, s10, 2
    s_lshl_b32 s60, s60, 12
    v_add_u32 v14, s60, v13
    v_xor_b32 v15, 32, v14
    ds_read_b64_tr_b16 a[16:17], v14 offset:0
    ds_read_b64_tr_b16 a[18:19], v14 offset:1024
    ds_read_b64_tr_b16 a[24:25], v15 offset:0
    ds_read_b64_tr_b16 a[26:27], v15 offset:1024
    v_add_u32 v14, 0x10000, v14
    v_add_u32 v15, 0x10000, v15
    ds_read_b64_tr_b16 a[20:21], v14 offset:0
    ds_read_b64_tr_b16 a[22:23], v14 offset:1024
    ds_read_b64_tr_b16 a[28:29], v15 offset:0
    ds_read_b64_tr_b16 a[30:31], v15 offset:1024
    s_xor_b32 s60, s10, 3
    s_lshl_b32 s60, s60, 12
    v_add_u32 v14, s60, v13
    v_xor_b32 v15, 32, v14
    ds_read_b64_tr_b16 a[32:33], v14 offset:0
    ds_read_b64_tr_b16 a[34:35], v14 offset:1024
    ds_read_b64_tr_b16 a[40:41], v15 offset:0
    ds_read_b64_tr_b16 a[42:43], v15 offset:1024
    v_add_u32 v14, 0x10000, v14
    v_add_u32 v15, 0x10000, v15
    ds_read_b64_tr_b16 a[36:37], v14 offset:0
    ds_read_b64_tr_b16 a[38:39], v14 offset:1024
    ds_read_b64_tr_b16 a[44:45], v15 offset:0
    ds_read_b64_tr_b16 a[46:47], v15 offset:1024
    s_waitcnt lgkmcnt(0)
    s_barrier
    s_and_b32 s60, s9, 3
    s_cmp_eq_u32 s60, 1
    s_cselect_b64 vcc, -1, 0
    s_cbranch_vccnz C_w4_0_0
    s_waitcnt vmcnt(7)
C_w4_0_0:
    s_add_u32 m0, s53, 0
    s_add_u32 s61, s56, 0
    buffer_load_dwordx4 v16, s[76:79], s61 offen  lds
    s_cbranch_vccnz C_w4_0_1
    s_waitcnt vmcnt(7)
C_w4_0_1:
    s_add_u32 m0, s53, 1024
    s_add_u32 s61, s56, 32768
    buffer_load_dwordx4 v16, s[76:79], s61 offen  lds
    s_cbranch_vccnz C_w4_0_2
    s_waitcnt vmcnt(7)
C_w4_0_2:
    s_add_u32 m0, s53, 2048
    s_add_u32 s61, s56, 65536
    buffer_load_dwordx4 v16, s[76:79], s61 offen  lds
    s_cbranch_vccnz C_w4_0_3
    s_waitcnt vmcnt(7)
C_w4_0_3:
    s_add_u32 m0, s53, 3072
    s_add_u32 s61, s56, 98304
    buffer_load_dwordx4 v16, s[76:79], s61 offen  lds
    s_cbranch_vccnz C_w4_1_0
    s_waitcnt vmcnt(7)
C_w4_1_0:
    s_add_u32 m0, s53, 4096
    s_add_u32 s61, s56, 524288
    buffer_load_dwordx4 v16, s[76:79], s61 offen  lds
    s_cbranch_vccnz C_w4_1_1
    s_waitcnt vmcnt(7)
C_w4_1_1:
    s_add_u32 m0, s53, 5120
    s_add_u32 s61, s56, 557056
    buffer_load_dwordx4 v16, s[76:79], s61 offen  lds
    s_cbranch_vccnz C_w4_1_2
    s_waitcnt vmcnt(7)
C_w4_1_2:
    s_add_u32 m0, s53, 6144
    s_add_u32 s61, s56, 589824
    buffer_load_dwordx4 v16, s[76:79], s61 offen  lds
    s_cbranch_vccnz C_w4_1_3
    s_waitcnt vmcnt(7)
C_w4_1_3:
    s_add_u32 m0, s53, 7168
    s_add_u32 s61, s56, 622592
    buffer_load_dwordx4 v16, s[76:79], s61 offen  lds
    s_cbranch_vccnz C_w4_2_0
    s_waitcnt vmcnt(7)
C_w4_2_0:
    s_add_u32 m0, s53, 8192
    s_add_u32 s61, s56, 1048576
    buffer_load_dwordx4 v16, s[76:79], s61 offen  lds
    s_cbranch_vccnz C_w4_2_1
    s_waitcnt vmcnt(7)
C_w4_2_1:
    s_add_u32 m0, s53, 9216
    s_add_u32 s61, s56, 1081344
    buffer_load_dwordx4 v16, s[76:79], s61 offen  lds
    s_cbranch_vccnz C_w4_2_2
    s_waitcnt vmcnt(7)
C_w4_2_2:
    s_add_u32 m0, s53, 10240
    s_add_u32 s61, s56, 1114112
    buffer_load_dwordx4 v16, s[76:79], s61 offen  lds
    s_cbranch_vccnz C_w4_2_3
    s_waitcnt vmcnt(7)
C_w4_2_3:
    s_add_u32 m0, s53, 11264
    s_add_u32 s61, s56, 1146880
    buffer_load_dwordx4 v16, s[76:79], s61 offen  lds
    s_cbranch_vccnz C_w4_3_0
    s_waitcnt vmcnt(7)
C_w4_3_0:
    s_add_u32 m0, s53, 12288
    s_add_u32 s61, s56, 1572864
    buffer_load_dwordx4 v16, s[76:79], s61 offen  lds
    s_cbranch_vccnz C_w4_3_1
    s_waitcnt vmcnt(7)
C_w4_3_1:
    s_add_u32 m0, s53, 13312
    s_add_u32 s61, s56, 1605632
    buffer_load_dwordx4 v16, s[76:79], s61 offen  lds
    s_cbranch_vccnz C_w4_3_2
    s_waitcnt vmcnt(7)
C_w4_3_2:
    s_add_u32 m0, s53, 14336
    s_add_u32 s61, s56, 1638400
    buffer_load_dwordx4 v16, s[76:79], s61 offen  lds
    s_cbranch_vccnz C_w4_3_3
    s_waitcnt vmcnt(7)
C_w4_3_3:
    s_add_u32 m0, s53, 15360
    s_add_u32 s61, s56, 1671168
    buffer_load_dwordx4 v16, s[76:79], s61 offen  lds
    s_waitcnt vmcnt(16)
    s_barrier
    v_add_u32 v14, 0, v13
    v_xor_b32 v15, 32, v14
    ds_read_b64_tr_b16 a[48:49], v14 offset:16384
    ds_read_b64_tr_b16 a[50:51], v14 offset:17408
    ds_read_b64_tr_b16 a[56:57], v15 offset:16384
    ds_read_b64_tr_b16 a[58:59], v15 offset:17408
    v_add_u32 v14, 0x10000, v14
    v_add_u32 v15, 0x10000, v15
    ds_read_b64_tr_b16 a[52:53], v14 offset:16384
    ds_read_b64_tr_b16 a[54:55], v14 offset:17408
    ds_read_b64_tr_b16 a[60:61], v15 offset:16384
    ds_read_b64_tr_b16 a[62:63], v15 offset:17408
    v_add_u32 v14, 4096, v13
    v_xor_b32 v15, 32, v14
    ds_read_b64_tr_b16 a[112:113], v14 offset:16384
    ds_read_b64_tr_b16 a[114:115], v14 offset:17408
    ds_read_b64_tr_b16 a[120:121], v15 offset:16384
    ds_read_b64_tr_b16 a[122:123], v15 offset:17408
    v_add_u32 v14, 0x10000, v14
    v_add_u32 v15, 0x10000, v15
    ds_read_b64_tr_b16 a[116:117], v14 offset:16384
    ds_read_b64_tr_b16 a[118:119], v14 offset:17408
    ds_read_b64_tr_b16 a[124:125], v15 offset:16384
    ds_read_b64_tr_b16 a[126:127], v15 offset:17408
    v_add_u32 v14, 8192, v13
    v_xor_b32 v15, 32, v14
    ds_read_b64_tr_b16 a[192:193], v14 offset:16384
    ds_read_b64_tr_b16 a[194:195], v14 offset:17408
    ds_read_b64_tr_b16 a[200:201], v15 offset:16384
    ds_read_b64_tr_b16 a[202:203], v15 offset:17408
    v_add_u32 v14, 0x10000, v14
    v_add_u32 v15, 0x10000, v15
    ds_read_b64_tr_b16 a[196:197], v14 offset:16384
    ds_read_b64_tr_b16 a[198:199], v14 offset:17408
    ds_read_b64_tr_b16 a[204:205], v15 offset:16384
    ds_read_b64_tr_b16 a[206:207], v15 offset:17408
    ds_read_b64_tr_b16 a[240:241], v24 offset:28672
    ds_read_b64_tr_b16 a[242:243], v24 offset:28928
    ds_read_b64_tr_b16 a[244:245], v24 offset:61440
    ds_read_b64_tr_b16 a[246:247], v24 offset:61696
    ds_read_b64_tr_b16 a[248:249], v25 offset:28672
    ds_read_b64_tr_b16 a[250:251], v25 offset:28928
    ds_read_b64_tr_b16 a[252:253], v25 offset:61440
    ds_read_b64_tr_b16 a[254:255], v25 offset:61696
    s_waitcnt lgkmcnt(0)
    s_barrier
    s_and_b32 s60, s9, 3
    s_cmp_eq_u32 s60, 1
    s_cselect_b64 vcc, -1, 0
    s_cbranch_vccnz C_w5_0_0
    s_waitcnt vmcnt(7)
C_w5_0_0:
    s_add_u32 m0, s53, 16384
    s_add_u32 s61, s57, 0
    buffer_load_dwordx4 v16, s[80:83], s61 offen  lds
    s_cbranch_vccnz C_w5_0_1
    s_waitcnt vmcnt(7)
C_w5_0_1:
    s_add_u32 m0, s53, 17408
    s_add_u32 s61, s57, 32768
    buffer_load_dwordx4 v16, s[80:83], s61 offen  lds
    s_cbranch_vccnz C_w5_0_2
    s_waitcnt vmcnt(7)
C_w5_0_2:
    s_add_u32 m0, s53, 18432
    s_add_u32 s61, s57, 65536
    buffer_load_dwordx4 v16, s[80:83], s61 offen  lds
    s_cbranch_vccnz C_w5_0_3
    s_waitcnt vmcnt(7)
C_w5_0_3:
    s_add_u32 m0, s53, 19456
    s_add_u32 s61, s57, 98304
    buffer_load_dwordx4 v16, s[80:83], s61 offen  lds
    s_cbranch_vccnz C_w5_1_0
    s_waitcnt vmcnt(7)
C_w5_1_0:
    s_add_u32 m0, s53, 20480
    s_add_u32 s61, s57, 524288
    buffer_load_dwordx4 v16, s[80:83], s61 offen  lds
    s_cbranch_vccnz C_w5_1_1
    s_waitcnt vmcnt(7)
C_w5_1_1:
    s_add_u32 m0, s53, 21504
    s_add_u32 s61, s57, 557056
    buffer_load_dwordx4 v16, s[80:83], s61 offen  lds
    s_cbranch_vccnz C_w5_1_2
    s_waitcnt vmcnt(7)
C_w5_1_2:
    s_add_u32 m0, s53, 22528
    s_add_u32 s61, s57, 589824
    buffer_load_dwordx4 v16, s[80:83], s61 offen  lds
    s_cbranch_vccnz C_w5_1_3
    s_waitcnt vmcnt(7)
C_w5_1_3:
    s_add_u32 m0, s53, 23552
    s_add_u32 s61, s57, 622592
    buffer_load_dwordx4 v16, s[80:83], s61 offen  lds
    s_cbranch_vccnz C_w5_2_0
    s_waitcnt vmcnt(7)
C_w5_2_0:
    s_add_u32 m0, s53, 24576
    s_add_u32 s61, s57, 1048576
    buffer_load_dwordx4 v16, s[80:83], s61 offen  lds
    s_cbranch_vccnz C_w5_2_1
    s_waitcnt vmcnt(7)
C_w5_2_1:
    s_add_u32 m0, s53, 25600
    s_add_u32 s61, s57, 1081344
    buffer_load_dwordx4 v16, s[80:83], s61 offen  lds
    s_cbranch_vccnz C_w5_2_2
    s_waitcnt vmcnt(7)
C_w5_2_2:
    s_add_u32 m0, s53, 26624
    s_add_u32 s61, s57, 1114112
    buffer_load_dwordx4 v16, s[80:83], s61 offen  lds
    s_cbranch_vccnz C_w5_2_3
    s_waitcnt vmcnt(7)
C_w5_2_3:
    s_add_u32 m0, s53, 27648
    s_add_u32 s61, s57, 1146880
    buffer_load_dwordx4 v16, s[80:83], s61 offen  lds
    s_cbranch_vccnz C_w5_3_0
    s_waitcnt vmcnt(7)
C_w5_3_0:
    s_add_u32 m0, s53, 28672
    s_add_u32 s61, s57, 1572864
    buffer_load_dwordx4 v16, s[80:83], s61 offen  lds
    s_cbranch_vccnz C_w5_3_1
    s_waitcnt vmcnt(7)
C_w5_3_1:
    s_add_u32 m0, s53, 29696
    s_add_u32 s61, s57, 1605632
    buffer_load_dwordx4 v16, s[80:83], s61 offen  lds
    s_cbranch_vccnz C_w5_3_2
    s_waitcnt vmcnt(7)
C_w5_3_2:
    s_add_u32 m0, s53, 30720
    s_add_u32 s61, s57, 1638400
    buffer_load_dwordx4 v16, s[80:83], s61 offen  lds
    s_cbranch_vccnz C_w5_3_3
    s_waitcnt vmcnt(7)
C_w5_3_3:
    s_add_u32 m0, s53, 31744
    s_add_u32 s61, s57, 1671168
    buffer_load_dwordx4 v16, s[80:83], s61 offen  lds
    s_waitcnt vmcnt(16)
    s_barrier
    s_xor_b32 s60, s10, 0
    s_lshl_b32 s60, s60, 12
    v_add_u32 v14, s60, v13
    v_xor_b32 v15, 32, v14
    ds_read_b64_tr_b16 v[160:161], v14 offset:0
    ds_read_b64_tr_b16 v[162:163], v14 offset:1024
    ds_read_b64_tr_b16 v[168:169], v15 offset:0
    ds_read_b64_tr_b16 v[170:171], v15 offset:1024
    v_add_u32 v14, 0x10000, v14
    v_add_u32 v15, 0x10000, v15
    ds_read_b64_tr_b16 v[164:165], v14 offset:0
    ds_read_b64_tr_b16 v[166:167], v14 offset:1024
    ds_read_b64_tr_b16 v[172:173], v15 offset:0
    ds_read_b64_tr_b16 v[174:175], v15 offset:1024
    s_xor_b32 s60, s10, 1
    s_lshl_b32 s60, s60, 12
    v_add_u32 v14, s60, v13
    v_xor_b32 v15, 32, v14
    ds_read_b64_tr_b16 v[176:177], v14 offset:0
    ds_read_b64_tr_b16 v[178:179], v14 offset:1024
    ds_read_b64_tr_b16 v[184:185], v15 offset:0
    ds_read_b64_tr_b16 v[186:187], v15 offset:1024
    v_add_u32 v14, 0x10000, v14
    v_add_u32 v15, 0x10000, v15
    ds_read_b64_tr_b16 v[180:181], v14 offset:0
    ds_read_b64_tr_b16 v[182:183], v14 offset:1024
    ds_read_b64_tr_b16 v[188:189], v15 offset:0
    ds_read_b64_tr_b16 v[190:191], v15 offset:1024
    s_xor_b32 s60, s10, 2
    s_lshl_b32 s60, s60, 12
    v_add_u32 v14, s60, v13
    v_xor_b32 v15, 32, v14
    ds_read_b64_tr_b16 v[192:193], v14 offset:0
    ds_read_b64_tr_b16 v[194:195], v14 offset:1024
    ds_read_b64_tr_b16 v[200:201], v15 offset:0
    ds_read_b64_tr_b16 v[202:203], v15 offset:1024
    v_add_u32 v14, 0x10000, v14
    v_add_u32 v15, 0x10000, v15
    ds_read_b64_tr_b16 v[196:197], v14 offset:0
    ds_read_b64_tr_b16 v[198:199], v14 offset:1024
    ds_read_b64_tr_b16 v[204:205], v15 offset:0
    ds_read_b64_tr_b16 v[206:207], v15 offset:1024
    s_xor_b32 s60, s10, 3
    s_lshl_b32 s60, s60, 12
    v_add_u32 v14, s60, v13
    v_xor_b32 v15, 32, v14
    ds_read_b64_tr_b16 v[208:209], v14 offset:0
    ds_read_b64_tr_b16 v[210:211], v14 offset:1024
    ds_read_b64_tr_b16 v[216:217], v15 offset:0
    ds_read_b64_tr_b16 v[218:219], v15 offset:1024
    v_add_u32 v14, 0x10000, v14
    v_add_u32 v15, 0x10000, v15
    ds_read_b64_tr_b16 v[212:213], v14 offset:0
    ds_read_b64_tr_b16 v[214:215], v14 offset:1024
    ds_read_b64_tr_b16 v[220:221], v15 offset:0
    ds_read_b64_tr_b16 v[222:223], v15 offset:1024
    s_waitcnt lgkmcnt(0)
    s_barrier
    s_and_b32 s60, s9, 3
    s_cmp_eq_u32 s60, 1
    s_cselect_b64 vcc, -1, 0
    s_cbranch_vccnz C_w6_0_0
    s_waitcnt vmcnt(7)
C_w6_0_0:
    s_add_u32 m0, s53, 0
    s_add_u32 s61, s57, 0
    buffer_load_dwordx4 v16, s[76:79], s61 offen  lds
    s_cbranch_vccnz C_w6_0_1
    s_waitcnt vmcnt(7)
C_w6_0_1:
    s_add_u32 m0, s53, 1024
    s_add_u32 s61, s57, 32768
    buffer_load_dwordx4 v16, s[76:79], s61 offen  lds
    s_cbranch_vccnz C_w6_0_2
    s_waitcnt vmcnt(7)
C_w6_0_2:
    s_add_u32 m0, s53, 2048
    s_add_u32 s61, s57, 65536
    buffer_load_dwordx4 v16, s[76:79], s61 offen  lds
    s_cbranch_vccnz C_w6_0_3
    s_waitcnt vmcnt(7)
C_w6_0_3:
    s_add_u32 m0, s53, 3072
    s_add_u32 s61, s57, 98304
    buffer_load_dwordx4 v16, s[76:79], s61 offen  lds
    s_cbranch_vccnz C_w6_1_0
    s_waitcnt vmcnt(7)
C_w6_1_0:
    s_add_u32 m0, s53, 4096
    s_add_u32 s61, s57, 524288
    buffer_load_dwordx4 v16, s[76:79], s61 offen  lds
    s_cbranch_vccnz C_w6_1_1
    s_waitcnt vmcnt(7)
C_w6_1_1:
    s_add_u32 m0, s53, 5120
    s_add_u32 s61, s57, 557056
    buffer_load_dwordx4 v16, s[76:79], s61 offen  lds
    s_cbranch_vccnz C_w6_1_2
    s_waitcnt vmcnt(7)
C_w6_1_2:
    s_add_u32 m0, s53, 6144
    s_add_u32 s61, s57, 589824
    buffer_load_dwordx4 v16, s[76:79], s61 offen  lds
    s_cbranch_vccnz C_w6_1_3
    s_waitcnt vmcnt(7)
C_w6_1_3:
    s_add_u32 m0, s53, 7168
    s_add_u32 s61, s57, 622592
    buffer_load_dwordx4 v16, s[76:79], s61 offen  lds
    s_cbranch_vccnz C_w6_2_0
    s_waitcnt vmcnt(7)
C_w6_2_0:
    s_add_u32 m0, s53, 8192
    s_add_u32 s61, s57, 1048576
    buffer_load_dwordx4 v16, s[76:79], s61 offen  lds
    s_cbranch_vccnz C_w6_2_1
    s_waitcnt vmcnt(7)
C_w6_2_1:
    s_add_u32 m0, s53, 9216
    s_add_u32 s61, s57, 1081344
    buffer_load_dwordx4 v16, s[76:79], s61 offen  lds
    s_cbranch_vccnz C_w6_2_2
    s_waitcnt vmcnt(7)
C_w6_2_2:
    s_add_u32 m0, s53, 10240
    s_add_u32 s61, s57, 1114112
    buffer_load_dwordx4 v16, s[76:79], s61 offen  lds
    s_cbranch_vccnz C_w6_2_3
    s_waitcnt vmcnt(7)
C_w6_2_3:
    s_add_u32 m0, s53, 11264
    s_add_u32 s61, s57, 1146880
    buffer_load_dwordx4 v16, s[76:79], s61 offen  lds
    s_cbranch_vccnz C_w6_3_0
    s_waitcnt vmcnt(7)
C_w6_3_0:
    s_add_u32 m0, s53, 12288
    s_add_u32 s61, s57, 1572864
    buffer_load_dwordx4 v16, s[76:79], s61 offen  lds
    s_cbranch_vccnz C_w6_3_1
    s_waitcnt vmcnt(7)
C_w6_3_1:
    s_add_u32 m0, s53, 13312
    s_add_u32 s61, s57, 1605632
    buffer_load_dwordx4 v16, s[76:79], s61 offen  lds
    s_cbranch_vccnz C_w6_3_2
    s_waitcnt vmcnt(7)
C_w6_3_2:
    s_add_u32 m0, s53, 14336
    s_add_u32 s61, s57, 1638400
    buffer_load_dwordx4 v16, s[76:79], s61 offen  lds
    s_cbranch_vccnz C_w6_3_3
    s_waitcnt vmcnt(7)
C_w6_3_3:
    s_add_u32 m0, s53, 15360
    s_add_u32 s61, s57, 1671168
    buffer_load_dwordx4 v16, s[76:79], s61 offen  lds
    s_waitcnt vmcnt(16)
    s_barrier
    s_xor_b32 s60, s10, 0
    s_lshl_b32 s60, s60, 12
    v_add_u32 v14, s60, v13
    v_xor_b32 v15, 32, v14
    ds_read_b64_tr_b16 a[128:129], v14 offset:16384
    ds_read_b64_tr_b16 a[130:131], v14 offset:17408
    ds_read_b64_tr_b16 a[136:137], v15 offset:16384
    ds_read_b64_tr_b16 a[138:139], v15 offset:17408
    v_add_u32 v14, 0x10000, v14
    v_add_u32 v15, 0x10000, v15
    ds_read_b64_tr_b16 a[132:133], v14 offset:16384
    ds_read_b64_tr_b16 a[134:135], v14 offset:17408
    ds_read_b64_tr_b16 a[140:141], v15 offset:16384
    ds_read_b64_tr_b16 a[142:143], v15 offset:17408
    s_xor_b32 s60, s10, 1
    s_lshl_b32 s60, s60, 12
    v_add_u32 v14, s60, v13
    v_xor_b32 v15, 32, v14
    ds_read_b64_tr_b16 a[144:145], v14 offset:16384
    ds_read_b64_tr_b16 a[146:147], v14 offset:17408
    ds_read_b64_tr_b16 a[152:153], v15 offset:16384
    ds_read_b64_tr_b16 a[154:155], v15 offset:17408
    v_add_u32 v14, 0x10000, v14
    v_add_u32 v15, 0x10000, v15
    ds_read_b64_tr_b16 a[148:149], v14 offset:16384
    ds_read_b64_tr_b16 a[150:151], v14 offset:17408
    ds_read_b64_tr_b16 a[156:157], v15 offset:16384
    ds_read_b64_tr_b16 a[158:159], v15 offset:17408
    s_xor_b32 s60, s10, 2
    s_lshl_b32 s60, s60, 12
    v_add_u32 v14, s60, v13
    v_xor_b32 v15, 32, v14
    ds_read_b64_tr_b16 a[160:161], v14 offset:16384
    ds_read_b64_tr_b16 a[162:163], v14 offset:17408
    ds_read_b64_tr_b16 a[168:169], v15 offset:16384
    ds_read_b64_tr_b16 a[170:171], v15 offset:17408
    v_add_u32 v14, 0x10000, v14
    v_add_u32 v15, 0x10000, v15
    ds_read_b64_tr_b16 a[164:165], v14 offset:16384
    ds_read_b64_tr_b16 a[166:167], v14 offset:17408
    ds_read_b64_tr_b16 a[172:173], v15 offset:16384
    ds_read_b64_tr_b16 a[174:175], v15 offset:17408
    s_xor_b32 s60, s10, 3
    s_lshl_b32 s60, s60, 12
    v_add_u32 v14, s60, v13
    v_xor_b32 v15, 32, v14
    ds_read_b64_tr_b16 a[176:177], v14 offset:16384
    ds_read_b64_tr_b16 a[178:179], v14 offset:17408
    ds_read_b64_tr_b16 a[184:185], v15 offset:16384
    ds_read_b64_tr_b16 a[186:187], v15 offset:17408
    v_add_u32 v14, 0x10000, v14
    v_add_u32 v15, 0x10000, v15
    ds_read_b64_tr_b16 a[180:181], v14 offset:16384
    ds_read_b64_tr_b16 a[182:183], v14 offset:17408
    ds_read_b64_tr_b16 a[188:189], v15 offset:16384
    ds_read_b64_tr_b16 a[190:191], v15 offset:17408
    s_waitcnt lgkmcnt(0)
    s_barrier
    s_and_b32 s60, s9, 3
    s_cmp_eq_u32 s60, 1
    s_cselect_b64 vcc, -1, 0
    s_cbranch_vccnz C_w7_0_0
    s_waitcnt vmcnt(7)
C_w7_0_0:
    s_add_u32 m0, s53, 16384
    s_add_u32 s61, s56, 2097152
    buffer_load_dwordx4 v16, s[80:83], s61 offen  lds
    s_cbranch_vccnz C_w7_0_1
    s_waitcnt vmcnt(7)
C_w7_0_1:
    s_add_u32 m0, s53, 17408
    s_add_u32 s61, s56, 2129920
    buffer_load_dwordx4 v16, s[80:83], s61 offen  lds
    s_cbranch_vccnz C_w7_0_2
    s_waitcnt vmcnt(7)
C_w7_0_2:
    s_add_u32 m0, s53, 18432
    s_add_u32 s61, s56, 2162688
    buffer_load_dwordx4 v16, s[80:83], s61 offen  lds
    s_cbranch_vccnz C_w7_0_3
    s_waitcnt vmcnt(7)
C_w7_0_3:
    s_add_u32 m0, s53, 19456
    s_add_u32 s61, s56, 2195456
    buffer_load_dwordx4 v16, s[80:83], s61 offen  lds
    s_cbranch_vccnz C_w7_1_0
    s_waitcnt vmcnt(7)
C_w7_1_0:
    s_add_u32 m0, s53, 20480
    s_mov_b32 s61, 0
    buffer_load_dwordx4 v19, s[84:87], s61 offen  lds
    s_cbranch_vccnz C_w7_1_1
    s_waitcnt vmcnt(7)
C_w7_1_1:
    s_add_u32 m0, s53, 21504
    s_mov_b32 s61, 10240
    buffer_load_dwordx4 v19, s[84:87], s61 offen  lds
    s_cbranch_vccnz C_w7_1_2
    s_waitcnt vmcnt(7)
C_w7_1_2:
    s_add_u32 m0, s53, 22528
    s_mov_b32 s61, 20480
    buffer_load_dwordx4 v19, s[84:87], s61 offen  lds
    s_cbranch_vccnz C_w7_1_3
    s_waitcnt vmcnt(7)
C_w7_1_3:
    s_add_u32 m0, s53, 23552
    s_mov_b32 s61, 30720
    buffer_load_dwordx4 v19, s[84:87], s61 offen  lds
    s_cbranch_vccnz C_w7_2_0
    s_waitcnt vmcnt(7)
C_w7_2_0:
    s_add_u32 m0, s53, 24576
    s_mov_b32 s61, 512
    buffer_load_dwordx4 v19, s[84:87], s61 offen  lds
    s_cbranch_vccnz C_w7_2_1
    s_waitcnt vmcnt(7)
C_w7_2_1:
    s_add_u32 m0, s53, 25600
    s_mov_b32 s61, 10752
    buffer_load_dwordx4 v19, s[84:87], s61 offen  lds
    s_cbranch_vccnz C_w7_2_2
    s_waitcnt vmcnt(7)
C_w7_2_2:
    s_add_u32 m0, s53, 26624
    s_mov_b32 s61, 20992
    buffer_load_dwordx4 v19, s[84:87], s61 offen  lds
    s_cbranch_vccnz C_w7_2_3
    s_waitcnt vmcnt(7)
C_w7_2_3:
    s_add_u32 m0, s53, 27648
    s_mov_b32 s61, 31232
    buffer_load_dwordx4 v19, s[84:87], s61 offen  lds
    s_waitcnt vmcnt(12)
    s_barrier
    s_xor_b32 s60, s10, 0
    s_lshl_b32 s60, s60, 12
    v_add_u32 v14, s60, v13
    v_xor_b32 v15, 32, v14
    ds_read_b64_tr_b16 v[64:65], v14 offset:0
    ds_read_b64_tr_b16 v[66:67], v14 offset:1024
    ds_read_b64_tr_b16 v[72:73], v15 offset:0
    ds_read_b64_tr_b16 v[74:75], v15 offset:1024
    v_add_u32 v14, 0x10000, v14
    v_add_u32 v15, 0x10000, v15
    ds_read_b64_tr_b16 v[68:69], v14 offset:0
    ds_read_b64_tr_b16 v[70:71], v14 offset:1024
    ds_read_b64_tr_b16 v[76:77], v15 offset:0
    ds_read_b64_tr_b16 v[78:79], v15 offset:1024
    s_xor_b32 s60, s10, 1
    s_lshl_b32 s60, s60, 12
    v_add_u32 v14, s60, v13
    v_xor_b32 v15, 32, v14
    ds_read_b64_tr_b16 a[64:65], v14 offset:0
    ds_read_b64_tr_b16 a[66:67], v14 offset:1024
    ds_read_b64_tr_b16 a[72:73], v15 offset:0
    ds_read_b64_tr_b16 a[74:75], v15 offset:1024
    v_add_u32 v14, 0x10000, v14
    v_add_u32 v15, 0x10000, v15
    ds_read_b64_tr_b16 a[68:69], v14 offset:0
    ds_read_b64_tr_b16 a[70:71], v14 offset:1024
    ds_read_b64_tr_b16 a[76:77], v15 offset:0
    ds_read_b64_tr_b16 a[78:79], v15 offset:1024
    s_xor_b32 s60, s10, 2
    s_lshl_b32 s60, s60, 12
    v_add_u32 v14, s60, v13
    v_xor_b32 v15, 32, v14
    ds_read_b64_tr_b16 a[80:81], v14 offset:0
    ds_read_b64_tr_b16 a[82:83], v14 offset:1024
    ds_read_b64_tr_b16 a[88:89], v15 offset:0
    ds_read_b64_tr_b16 a[90:91], v15 offset:1024
    v_add_u32 v14, 0x10000, v14
    v_add_u32 v15, 0x10000, v15
    ds_read_b64_tr_b16 a[84:85], v14 offset:0
    ds_read_b64_tr_b16 a[86:87], v14 offset:1024
    ds_read_b64_tr_b16 a[92:93], v15 offset:0
    ds_read_b64_tr_b16 a[94:95], v15 offset:1024
    s_xor_b32 s60, s10, 3
    s_lshl_b32 s60, s60, 12
    v_add_u32 v14, s60, v13
    v_xor_b32 v15, 32, v14
    ds_read_b64_tr_b16 a[96:97], v14 offset:0
    ds_read_b64_tr_b16 a[98:99], v14 offset:1024
    ds_read_b64_tr_b16 a[104:105], v15 offset:0
    ds_read_b64_tr_b16 a[106:107], v15 offset:1024
    v_add_u32 v14, 0x10000, v14
    v_add_u32 v15, 0x10000, v15
    ds_read_b64_tr_b16 a[100:101], v14 offset:0
    ds_read_b64_tr_b16 a[102:103], v14 offset:1024
    ds_read_b64_tr_b16 a[108:109], v15 offset:0
    ds_read_b64_tr_b16 a[110:111], v15 offset:1024
    s_waitcnt lgkmcnt(0)
    s_barrier
    s_and_b32 s60, s9, 3
    s_cmp_eq_u32 s60, 1
    s_cselect_b64 vcc, -1, 0
    s_cbranch_vccnz C_w8_0_0
    s_waitcnt vmcnt(7)
C_w8_0_0:
    s_add_u32 m0, s53, 0
    s_add_u32 s61, s56, 0
    buffer_load_dwordx4 v16, s[80:83], s61 offen  lds
    s_cbranch_vccnz C_w8_0_1
    s_waitcnt vmcnt(7)
C_w8_0_1:
    s_add_u32 m0, s53, 1024
    s_add_u32 s61, s56, 32768
    buffer_load_dwordx4 v16, s[80:83], s61 offen  lds
    s_cbranch_vccnz C_w8_0_2
    s_waitcnt vmcnt(7)
C_w8_0_2:
    s_add_u32 m0, s53, 2048
    s_add_u32 s61, s56, 65536
    buffer_load_dwordx4 v16, s[80:83], s61 offen  lds
    s_cbranch_vccnz C_w8_0_3
    s_waitcnt vmcnt(7)
C_w8_0_3:
    s_add_u32 m0, s53, 3072
    s_add_u32 s61, s56, 98304
    buffer_load_dwordx4 v16, s[80:83], s61 offen  lds
    s_cbranch_vccnz C_w8_1_0
    s_waitcnt vmcnt(7)
C_w8_1_0:
    s_add_u32 m0, s53, 4096
    s_add_u32 s61, s56, 524288
    buffer_load_dwordx4 v16, s[80:83], s61 offen  lds
    s_cbranch_vccnz C_w8_1_1
    s_waitcnt vmcnt(7)
C_w8_1_1:
    s_add_u32 m0, s53, 5120
    s_add_u32 s61, s56, 557056
    buffer_load_dwordx4 v16, s[80:83], s61 offen  lds
    s_cbranch_vccnz C_w8_1_2
    s_waitcnt vmcnt(7)
C_w8_1_2:
    s_add_u32 m0, s53, 6144
    s_add_u32 s61, s56, 589824
    buffer_load_dwordx4 v16, s[80:83], s61 offen  lds
    s_cbranch_vccnz C_w8_1_3
    s_waitcnt vmcnt(7)
C_w8_1_3:
    s_add_u32 m0, s53, 7168
    s_add_u32 s61, s56, 622592
    buffer_load_dwordx4 v16, s[80:83], s61 offen  lds
    s_cbranch_vccnz C_w8_2_0
    s_waitcnt vmcnt(7)
C_w8_2_0:
    s_add_u32 m0, s53, 8192
    s_add_u32 s61, s56, 1048576
    buffer_load_dwordx4 v16, s[80:83], s61 offen  lds
    s_cbranch_vccnz C_w8_2_1
    s_waitcnt vmcnt(7)
C_w8_2_1:
    s_add_u32 m0, s53, 9216
    s_add_u32 s61, s56, 1081344
    buffer_load_dwordx4 v16, s[80:83], s61 offen  lds
    s_cbranch_vccnz C_w8_2_2
    s_waitcnt vmcnt(7)
C_w8_2_2:
    s_add_u32 m0, s53, 10240
    s_add_u32 s61, s56, 1114112
    buffer_load_dwordx4 v16, s[80:83], s61 offen  lds
    s_cbranch_vccnz C_w8_2_3
    s_waitcnt vmcnt(7)
C_w8_2_3:
    s_add_u32 m0, s53, 11264
    s_add_u32 s61, s56, 1146880
    buffer_load_dwordx4 v16, s[80:83], s61 offen  lds
    s_cbranch_vccnz C_w8_3_0
    s_waitcnt vmcnt(7)
C_w8_3_0:
    s_add_u32 m0, s53, 12288
    s_add_u32 s61, s56, 1572864
    buffer_load_dwordx4 v16, s[80:83], s61 offen  lds
    s_cbranch_vccnz C_w8_3_1
    s_waitcnt vmcnt(7)
C_w8_3_1:
    s_add_u32 m0, s53, 13312
    s_add_u32 s61, s56, 1605632
    buffer_load_dwordx4 v16, s[80:83], s61 offen  lds
    s_cbranch_vccnz C_w8_3_2
    s_waitcnt vmcnt(7)
C_w8_3_2:
    s_add_u32 m0, s53, 14336
    s_add_u32 s61, s56, 1638400
    buffer_load_dwordx4 v16, s[80:83], s61 offen  lds
    s_cbranch_vccnz C_w8_3_3
    s_waitcnt vmcnt(7)
C_w8_3_3:
    s_add_u32 m0, s53, 15360
    s_add_u32 s61, s56, 1671168
    buffer_load_dwordx4 v16, s[80:83], s61 offen  lds
    ds_write_b128 v6, v[64:67] offset:28672
    ds_write_b128 v6, v[68:71] offset:29696
    ds_write_b128 v6, v[72:75] offset:30720
    ds_write_b128 v6, v[76:79] offset:31744
    s_waitcnt vmcnt(16)
    s_barrier
    v_add_u32 v14, 0, v13
    v_xor_b32 v15, 32, v14
    ds_read_b64_tr_b16 v[64:65], v14 offset:16384
    ds_read_b64_tr_b16 v[66:67], v14 offset:17408
    ds_read_b64_tr_b16 v[72:73], v15 offset:16384
    ds_read_b64_tr_b16 v[74:75], v15 offset:17408
    v_add_u32 v14, 0x10000, v14
    v_add_u32 v15, 0x10000, v15
    ds_read_b64_tr_b16 v[68:69], v14 offset:16384
    ds_read_b64_tr_b16 v[70:71], v14 offset:17408
    ds_read_b64_tr_b16 v[76:77], v15 offset:16384
    ds_read_b64_tr_b16 v[78:79], v15 offset:17408
    ds_read_b64_tr_b16 v[48:49], v24 offset:20480
    ds_read_b64_tr_b16 v[50:51], v24 offset:20736
    ds_read_b64_tr_b16 v[52:53], v24 offset:53248
    ds_read_b64_tr_b16 v[54:55], v24 offset:53504
    ds_read_b64_tr_b16 v[56:57], v25 offset:20480
    ds_read_b64_tr_b16 v[58:59], v25 offset:20736
    ds_read_b64_tr_b16 v[60:61], v25 offset:53248
    ds_read_b64_tr_b16 v[62:63], v25 offset:53504
    ds_read_b64_tr_b16 v[32:33], v24 offset:24576
    ds_read_b64_tr_b16 v[34:35], v24 offset:24832
    ds_read_b64_tr_b16 v[36:37], v24 offset:57344
    ds_read_b64_tr_b16 v[38:39], v24 offset:57600
    ds_read_b64_tr_b16 v[40:41], v25 offset:24576
    ds_read_b64_tr_b16 v[42:43], v25 offset:24832
    ds_read_b64_tr_b16 v[44:45], v25 offset:57344
    ds_read_b64_tr_b16 v[46:47], v25 offset:57600
    s_waitcnt lgkmcnt(0)
    s_barrier
    ds_write_b128 v6, v[64:67] offset:16384
    ds_write_b128 v6, v[68:71] offset:17408
    ds_write_b128 v6, v[72:75] offset:18432
    ds_write_b128 v6, v[76:79] offset:19456
    ds_write_b128 v6, v[48:51] offset:20480
    ds_write_b128 v6, v[52:55] offset:21504
    ds_write_b128 v6, v[56:59] offset:22528
    ds_write_b128 v6, v[60:63] offset:23552
    ds_write_b128 v6, v[32:35] offset:24576
    ds_write_b128 v6, v[36:39] offset:25600
    ds_write_b128 v6, v[40:43] offset:26624
    ds_write_b128 v6, v[44:47] offset:27648
    s_waitcnt vmcnt(0)
    s_barrier
    s_xor_b32 s60, s10, 0
    s_lshl_b32 s60, s60, 12
    v_add_u32 v14, s60, v13
    v_xor_b32 v15, 32, v14
    ds_read_b64_tr_b16 v[64:65], v14 offset:0
    ds_read_b64_tr_b16 v[66:67], v14 offset:1024
    ds_read_b64_tr_b16 v[72:73], v15 offset:0
    ds_read_b64_tr_b16 v[74:75], v15 offset:1024
    v_add_u32 v14, 0x10000, v14
    v_add_u32 v15, 0x10000, v15
    ds_read_b64_tr_b16 v[68:69], v14 offset:0
    ds_read_b64_tr_b16 v[70:71], v14 offset:1024
    ds_read_b64_tr_b16 v[76:77], v15 offset:0
    ds_read_b64_tr_b16 v[78:79], v15 offset:1024
    s_xor_b32 s60, s10, 1
    s_lshl_b32 s60, s60, 12
    v_add_u32 v14, s60, v13
    v_xor_b32 v15, 32, v14
    ds_read_b64_tr_b16 v[48:49], v14 offset:0
    ds_read_b64_tr_b16 v[50:51], v14 offset:1024
    ds_read_b64_tr_b16 v[56:57], v15 offset:0
    ds_read_b64_tr_b16 v[58:59], v15 offset:1024
    v_add_u32 v14, 0x10000, v14
    v_add_u32 v15, 0x10000, v15
    ds_read_b64_tr_b16 v[52:53], v14 offset:0
    ds_read_b64_tr_b16 v[54:55], v14 offset:1024
    ds_read_b64_tr_b16 v[60:61], v15 offset:0
    ds_read_b64_tr_b16 v[62:63], v15 offset:1024
    s_xor_b32 s60, s10, 2
    s_lshl_b32 s60, s60, 12
    v_add_u32 v14, s60, v13
    v_xor_b32 v15, 32, v14
    ds_read_b64_tr_b16 v[32:33], v14 offset:0
    ds_read_b64_tr_b16 v[34:35], v14 offset:1024
    ds_read_b64_tr_b16 v[40:41], v15 offset:0
    ds_read_b64_tr_b16 v[42:43], v15 offset:1024
    v_add_u32 v14, 0x10000, v14
    v_add_u32 v15, 0x10000, v15
    ds_read_b64_tr_b16 v[36:37], v14 offset:0
    ds_read_b64_tr_b16 v[38:39], v14 offset:1024
    ds_read_b64_tr_b16 v[44:45], v15 offset:0
    ds_read_b64_tr_b16 v[46:47], v15 offset:1024
    s_xor_b32 s60, s10, 3
    s_lshl_b32 s60, s60, 12
    v_add_u32 v14, s60, v13
    v_xor_b32 v15, 32, v14
    ds_read_b64_tr_b16 v[16:17], v14 offset:0
    ds_read_b64_tr_b16 v[18:19], v14 offset:1024
    ds_read_b64_tr_b16 v[24:25], v15 offset:0
    ds_read_b64_tr_b16 v[26:27], v15 offset:1024
    v_add_u32 v14, 0x10000, v14
    v_add_u32 v15, 0x10000, v15
    ds_read_b64_tr_b16 v[20:21], v14 offset:0
    ds_read_b64_tr_b16 v[22:23], v14 offset:1024
    ds_read_b64_tr_b16 v[28:29], v15 offset:0
    ds_read_b64_tr_b16 v[30:31], v15 offset:1024
    s_waitcnt lgkmcnt(0)
    s_barrier
    ds_write_b128 v6, v[64:67] offset:0
    ds_write_b128 v6, v[68:71] offset:1024
    ds_write_b128 v6, v[72:75] offset:2048
    ds_write_b128 v6, v[76:79] offset:3072
    ds_write_b128 v6, v[48:51] offset:4096
    ds_write_b128 v6, v[52:55] offset:5120
    ds_write_b128 v6, v[56:59] offset:6144
    ds_write_b128 v6, v[60:63] offset:7168
    ds_write_b128 v6, v[32:35] offset:8192
    ds_write_b128 v6, v[36:39] offset:9216
    ds_write_b128 v6, v[40:43] offset:10240
    ds_write_b128 v6, v[44:47] offset:11264
    ds_write_b128 v6, v[16:19] offset:12288
    ds_write_b128 v6, v[20:23] offset:13312
    ds_write_b128 v6, v[24:27] offset:14336
    ds_write_b128 v6, v[28:31] offset:15360
    s_waitcnt lgkmcnt(0)
    s_mov_b32 s22, 262144
    v_mov_b32 v21, 192
C_wi:
    global_load_dword v20, v21, s[6:7] sc1
    s_sub_u32 s22, s22, 1
    s_cbranch_scc1 C_fail
    s_waitcnt vmcnt(0)
    v_readfirstlane_b32 s60, v20
    s_and_b32 s61, s60, 0x3ff
    s_cmp_lt_u32 s61, 256
    s_cbranch_scc1 C_wi
    s_cmp_gt_i32 s60, 0x3ff
    s_cselect_b32 s60, 8192, 0
    s_add_u32 s39, s39, s60
    s_add_u32 s37, s37, s60
    s_add_u32 s44, s44, s60
    s_lshl_b32 s58, s10, 12
    s_add_u32 s58, s58, 16384
    s_mov_b32 s62, 3
    s_cmp_lt_u32 s62, s43
    s_cbranch_scc1 C_kv0_ok
    s_mov_b32 s22, 262144
    v_mov_b32 v15, 0
C_kv0_p:
    buffer_load_dwordx4 v[56:59], v15, s[12:15], s44 offen offset:768 sc1
    s_sub_u32 s22, s22, 1
    s_cbranch_scc1 C_fail
    s_waitcnt vmcnt(0)
    v_min3_u32 v14, v56, v57, v58
    v_min_u32 v14, v14, v59
    s_nop 0
    v_readfirstlane_b32 s43, v14
    s_cmp_lt_u32 s62, s43
    s_cbranch_scc0 C_kv0_p
C_kv0_ok:
    s_cmp_ge_u32 s43, 64
    s_cselect_b32 s43, 64, 4
    s_barrier
    ds_read_b64 v[14:15], v0 offset:14464
    s_mov_b32 s56, 0x3f803f80
    s_waitcnt lgkmcnt(0)
    s_mov_b32 s36, s54
    s_mov_b32 s59, 0
    s_mov_b32 s62, 1
    s_mul_i32 s24, s9, 160
    s_add_u32 s40, s54, s24
    s_add_u32 s40, s40, 0x6000
    s_sub_u32 s37, s37, 0x8000
    s_sub_u32 s42, s42, 4096
    s_mov_b32 s25, 0
    s_xor_b32 s42, s42, s25
    s_xor_b32 s61, s30, 0x40000
    s_lshl_b32 s18, s18, 11
    s_add_u32 s18, s18, s61
    s_lshl_b32 s19, s19, 11
    s_add_u32 s19, s19, s61
    s_add_u32 s23, s19, 98304
    s_lshl_b32 s45, s8, 2
    s_add_u32 s45, s45, s44
    s_add_u32 s45, s45, 256
    s_add_u32 s57, s44, 512
    s_cmp_eq_u32 s10, 3
    s_cselect_b32 s2, s14, 0
    s_mov_b64 s[0:1], s[12:13]
    s_mov_b32 s3, 0x00020000
    s_cmp_eq_u32 s21, 1
    s_cselect_b64 s[50:51], s[50:51], 0
    s_mov_b64 s[4:5], 0
    v_mov_b32 v13, 0
    s_cmp_eq_u32 s8, 1
    s_cselect_b64 s[48:49], -1, 0
    s_mov_b32 s22, 262144
    s_mov_b32 s27, 0
    s_mov_b32 s28, 0
    s_mov_b32 s29, 0
    s_lshl_b32 s60, s10, 8
    s_sub_u32 s53, s44, s60
    s_sub_u32 s53, s53, 3584
    s_sub_u32 s92, s43, 1
    s_lshl_b32 s26, s10, 11
    s_mov_b32 m0, s58
    s_sub_u32 s16, s41, 896
    s_sub_u32 s17, s41, 768
    buffer_load_dwordx4 v15, s[12:15], s41 offen offset:2048 lds
    buffer_load_dwordx4 v15, s[12:15], s17 offen offset:3072 lds
    v_lshlrev_b32 v44, 3, v2
    buffer_load_dword v44, v44, s[12:15], s54 offen sc1
    ds_read_b128 v[56:59], v6 offset:0
    ds_read_b128 v[60:63], v6 offset:1024
    ds_read_b128 v[64:67], v6 offset:2048
    ds_read_b128 v[68:71], v6 offset:3072
    ds_read_b64 v[54:55], v0 offset:14464
    v_mov_b32 v16, 0
    v_mov_b32 v17, 0
    v_mov_b32 v18, 0
    v_mov_b32 v19, 0
    v_mov_b32 v20, 0
    v_mov_b32 v21, 0
    v_mov_b32 v22, 0
    v_mov_b32 v23, 0
    v_mov_b32 v24, 0
    v_mov_b32 v25, 0
    v_mov_b32 v26, 0
    v_mov_b32 v27, 0
C_loop:
    s_barrier
    s_cmp_lt_u32 s62, s43
    s_cbranch_scc0 C_kvslow
C_kvback:
    s_add_u32 s37, s37, 0x8000
    s_add_u32 s42, s42, 4096
    s_xor_b32 s18, s18, 0x40000
    s_xor_b32 s19, s19, 0x40000
    s_xor_b32 s23, s23, 0x40000
    v_mov_b32 v28, 0
    v_mov_b32 v29, 0
    v_mov_b32 v30, 0
    v_mov_b32 v31, 0
    v_mov_b32 v32, 0
    v_mov_b32 v33, 0
    v_mov_b32 v34, 0
    v_mov_b32 v35, 0
    v_mov_b32 v36, 0
    v_mov_b32 v37, 0
    v_mov_b32 v38, 0
    v_mov_b32 v39, 0
    buffer_load_dwordx4 v[40:43], v2, s[12:15], s36 offen sc1
    buffer_load_dword v14, v1, s[12:15], s36 offen sc1
    ds_read_b128 v[72:75], v6 offset:4096
    ds_read_b128 v[76:79], v6 offset:5120
    s_add_u32 s45, s45, 128
    s_cmp_ge_u32 s45, s57
    s_cselect_b32 s60, 512, 0
    s_sub_u32 s45, s45, s60
    s_xor_b32 s30, s30, 0x40000
    s_xor_b32 s31, s31, 0x40000
    s_xor_b32 s32, s32, 0x40000
    s_xor_b32 s33, s33, 0x40000
    s_xor_b32 s34, s34, 0x40000
    s_barrier
    s_waitcnt lgkmcnt(2)
    buffer_load_dwordx4 v54, s[12:15], s41 offen offset:0 lds
    buffer_load_dwordx4 v54, s[12:15], s16 offen offset:1024 lds
    buffer_load_dwordx4 v[44:47], v2, s[12:15], s36 offen sc1
    buffer_load_dword v13, v1, s[12:15], s36 offen sc1
    s_waitcnt vmcnt(4)
C_lgo:
    ds_write_b128 v2, v[40:43] offset:0
    v_smfmac_f32_16x16x64_bf16 v[16:19], v[40:43], v[80:87], v12
    ds_write_b32 v1, v14 offset:0
    v_cmp_u_f32 vcc, v40, v14
    v_smfmac_f32_16x16x64_bf16 v[24:27], v[40:43], v[160:167], v12
    s_cbranch_vccnz C_lf
    v_smfmac_f32_16x16x64_bf16 v[20:23], v[40:43], v[88:95], v12
    buffer_load_dwordx4 v[44:47], v2, s[12:15], s37 offen sc1
    v_smfmac_f32_16x16x64_bf16 v[28:31], v[40:43], v[168:175], v12
    s_waitcnt lgkmcnt(0)
    s_barrier
    ds_read_b128 v[48:51], v3 offset:0
    v_smfmac_f32_16x16x64_bf16 v[32:35], v[40:43], v[56:63], v12
    ds_read_b128 v[52:55], v4 offset:0
    buffer_load_dword v13, v1, s[12:15], s37 offen sc1
    v_smfmac_f32_16x16x64_bf16 v[36:39], v[40:43], v[64:71], v12
    ds_read_b128 v[56:59], v6 offset:6144
    s_waitcnt lgkmcnt(2)
    v_smfmac_f32_16x16x64_bf16 v[16:19], v[48:51], v[96:103], v12
    ds_read_b128 v[60:63], v6 offset:7168
    v_smfmac_f32_16x16x64_bf16 v[24:27], v[48:51], v[176:183], v12
    ds_read_b128 v[64:67], v6 offset:8192
    s_xor_b32 s35, s35, 0x40000
    v_smfmac_f32_16x16x64_bf16 v[32:35], v[48:51], v[72:79], v12
    ds_read_b128 v[68:71], v6 offset:9216
    s_add_u32 s41, s41, 524288
    v_smfmac_f32_16x16x64_bf16 v[20:23], v[48:51], v[104:111], v12
    ds_read_b128 v[72:75], v6 offset:10240
    s_sub_u32 s63, s41, s26
    v_smfmac_f32_16x16x64_bf16 v[28:31], v[48:51], v[184:191], v12
    ds_read_b128 v[76:79], v6 offset:11264
    s_waitcnt lgkmcnt(4)
    v_smfmac_f32_16x16x64_bf16 v[36:39], v[48:51], v[56:63], v12
    ds_read_b128 v[48:51], v5 offset:0
    s_mov_b32 m0, 16000
    v_smfmac_f32_16x16x64_bf16 v[16:19], v[52:55], v[112:119], v12
    ds_read_b128 v[56:59], v6 offset:12288
    s_sub_u32 s16, s41, 896
    v_smfmac_f32_16x16x64_bf16 v[24:27], v[52:55], v[192:199], v12
    ds_read_b128 v[60:63], v6 offset:13312
    s_waitcnt lgkmcnt(5)
    v_smfmac_f32_16x16x64_bf16 v[32:35], v[52:55], v[64:71], v12
    ds_read_b128 v[64:67], v6 offset:14336
    s_sub_u32 s17, s41, 768
    v_smfmac_f32_16x16x64_bf16 v[20:23], v[52:55], v[120:127], v12
    ds_read_b128 v[68:71], v6 offset:15360
    s_mov_b64 s[4:5], s[50:51]
    v_smfmac_f32_16x16x64_bf16 v[28:31], v[52:55], v[200:207], v12
    v_lshlrev_b32 v15, 2, v2
    s_waitcnt lgkmcnt(5)
    v_smfmac_f32_16x16x64_bf16 v[36:39], v[52:55], v[72:79], v12
    ds_read_b128 v[52:55], v0 offset:4096
    s_waitcnt lgkmcnt(5)
    v_smfmac_f32_16x16x64_bf16 v[16:19], v[48:51], v[128:135], v12
    ds_read_b128 v[72:75], v6 offset:16384
    v_mov_b32 v14, s20
    v_smfmac_f32_16x16x64_bf16 v[24:27], v[48:51], v[208:215], v12
    ds_read_b128 v[76:79], v6 offset:17408
    s_waitcnt lgkmcnt(5)
    v_smfmac_f32_16x16x64_bf16 v[32:35], v[48:51], v[56:63], v12
    ds_read_b128 v[56:59], v6 offset:18432
    v_smfmac_f32_16x16x64_bf16 v[20:23], v[48:51], v[136:143], v12
    ds_read_b128 v[60:63], v6 offset:19456
    v_smfmac_f32_16x16x64_bf16 v[28:31], v[48:51], v[216:223], v12
    s_waitcnt lgkmcnt(5)
    v_smfmac_f32_16x16x64_bf16 v[36:39], v[48:51], v[64:71], v12
    ds_read_b128 v[64:67], v6 offset:28672
    s_waitcnt lgkmcnt(5)
    v_smfmac_f32_16x16x64_bf16 v[16:19], v[52:55], v[144:151], v12
    ds_read_b128 v[68:71], v6 offset:29696
    v_smfmac_f32_16x16x64_bf16 v[24:27], v[52:55], v[224:231], v12
    s_waitcnt vmcnt(0) lgkmcnt(4)
    ds_write_b128 v2, v[44:47] offset:5120
    v_smfmac_f32_16x16x64_bf16 v[32:35], v[52:55], v[72:79], v12
    ds_write_b32 v1, v13 offset:5120
    v_cmp_u_f32 vcc, v44, v13
    v_smfmac_f32_16x16x64_bf16 v[20:23], v[52:55], v[152:159], v12
    ds_read_b128 v[72:75], v6 offset:30720
    s_cbranch_vccnz C_rf
C_rgo:
    v_smfmac_f32_16x16x64_bf16 v[28:31], v[52:55], v[232:239], v12
    ds_read_b128 v[76:79], v6 offset:31744
    s_waitcnt lgkmcnt(6)
    v_smfmac_f32_16x16x64_bf16 v[36:39], v[52:55], v[56:63], v12
    v_smfmac_f32_16x16x64_bf16 v[16:19], v[44:47], v[240:247], v12
    buffer_load_dword v15, s[12:15], s63 offen lds
    s_waitcnt lgkmcnt(4)
    v_smfmac_f32_16x16x64_bf16 v[24:27], v[44:47], v[64:71], v12
    s_waitcnt lgkmcnt(2)
    s_barrier
    ds_read_b128 v[40:43], v3 offset:5120
    v_smfmac_f32_16x16x64_bf16 v[20:23], v[44:47], v[248:255], v12
    ds_read_b128 v[48:51], v4 offset:5120
    s_waitcnt lgkmcnt(2)
    v_smfmac_f32_16x16x64_bf16 v[28:31], v[44:47], v[72:79], v12
    ds_read_b128 v[52:55], v5 offset:5120
    v_smfmac_f32_16x16x64_bf16 v[32:35], v[44:47], a[128:135], v12
    ds_read_b128 v[56:59], v0 offset:9216
    s_waitcnt lgkmcnt(3)
    v_smfmac_f32_16x16x64_bf16 v[16:19], v[40:43], a[0:7], v12
    ds_read_b128 v[64:67], v0 offset:16384
    v_smfmac_f32_16x16x64_bf16 v[24:27], v[40:43], a[64:71], v12
    ds_read_b128 v[68:71], v0 offset:17408
    buffer_store_dword v14, off, s[0:3], s45 sc1
    v_smfmac_f32_16x16x64_bf16 v[20:23], v[40:43], a[8:15], v12
    ds_read_b128 v[72:75], v0 offset:20480
    v_smfmac_f32_16x16x64_bf16 v[28:31], v[40:43], a[72:79], v12
    ds_read_b128 v[76:79], v0 offset:21504
    s_waitcnt lgkmcnt(6)
    v_smfmac_f32_16x16x64_bf16 v[16:19], v[48:51], a[16:23], v12
    ds_read_b128 v[60:63], v0 offset:25600
    s_waitcnt lgkmcnt(6)
    v_smfmac_f32_16x16x64_bf16 v[16:19], v[52:55], a[32:39], v12
    s_mov_b32 m0, s58
    s_waitcnt lgkmcnt(5)
    v_smfmac_f32_16x16x64_bf16 v[16:19], v[56:59], a[48:55], v12
    s_cmp_eq_u32 s20, 63
    v_mov_b64 v[14:15], -1
    v_smfmac_f32_16x16x64_bf16 v[24:27], v[48:51], a[80:87], v12
    buffer_store_dwordx2 v[14:15], v11, s[12:15], s18 offen
    v_add_u32 v13, s58, v0
    v_smfmac_f32_16x16x64_bf16 v[24:27], v[52:55], a[96:103], v12
    v_add_f32 v16, v16, v18
    v_smfmac_f32_16x16x64_bf16 v[24:27], v[56:59], a[112:119], v12
    v_add_f32 v17, v17, v19
    v_smfmac_f32_16x16x64_bf16 v[20:23], v[48:51], a[24:31], v12
    buffer_store_dwordx2 v[14:15], v11, s[12:15], s19 offen
    v_cvt_pk_bf16_f32 v19, v16, v17
    v_smfmac_f32_16x16x64_bf16 v[20:23], v[52:55], a[40:47], v12
    v_add_f32 v24, v24, v26
    v_smfmac_f32_16x16x64_bf16 v[20:23], v[56:59], a[56:63], v12
    v_add_f32 v25, v25, v27
    v_smfmac_f32_16x16x64_bf16 v[28:31], v[48:51], a[88:95], v12
    buffer_store_dwordx2 v[14:15], v11, s[12:15], s23 offen
    v_cvt_pk_bf16_f32 v14, v24, v25
    v_smfmac_f32_16x16x64_bf16 v[28:31], v[52:55], a[104:111], v12
    ds_write2_b32 v7, v14, v19 offset0:0 offset1:1
    v_add_f32 v20, v20, v22
    v_smfmac_f32_16x16x64_bf16 v[28:31], v[56:59], a[120:127], v12
    v_add_f32 v21, v21, v23
    v_smfmac_f32_16x16x64_bf16 v[36:39], v[44:47], a[136:143], v12
    v_cvt_pk_bf16_f32 v23, v20, v21
    s_nop 0
    v_add_f32 v28, v28, v30
    v_add_f32 v29, v29, v31
    v_cvt_pk_bf16_f32 v15, v28, v29
    ds_write2_b32 v7, v15, v23 offset0:64 offset1:65
    v_smfmac_f32_16x16x64_bf16 v[32:35], v[40:43], a[144:151], v12
    s_cbranch_scc1 C_final
    v_smfmac_f32_16x16x64_bf16 v[36:39], v[40:43], a[152:159], v12
    ds_read_b128 v[40:43], v0 offset:24576
    v_smfmac_f32_16x16x64_bf16 v[32:35], v[48:51], a[160:167], v12
    v_smfmac_f32_16x16x64_bf16 v[36:39], v[48:51], a[168:175], v12
    s_waitcnt lgkmcnt(1)
    s_barrier
    ds_read_b64_tr_b16 v[16:17], v8 offset:0
    ds_read_b64_tr_b16 v[18:19], v8 offset:528
    ds_read_b64_tr_b16 v[20:21], v8 offset:1056
    ds_read_b64_tr_b16 v[22:23], v8 offset:1584
    v_smfmac_f32_16x16x64_bf16 v[32:35], v[52:55], a[176:183], v12
    ds_read_b64_tr_b16 v[24:25], v8 offset:2112
    ds_read_b64_tr_b16 v[26:27], v8 offset:2640
    ds_read_b64_tr_b16 v[28:29], v8 offset:3168
    ds_read_b64_tr_b16 v[30:31], v8 offset:3696
    v_smfmac_f32_16x16x64_bf16 v[36:39], v[52:55], a[184:191], v12
    v_smfmac_f32_16x16x64_bf16 v[32:35], v[56:59], a[192:199], v12
    v_smfmac_f32_16x16x64_bf16 v[36:39], v[56:59], a[200:207], v12
    s_waitcnt lgkmcnt(6)
    v_mfma_f32_16x16x32_bf16 v[44:47], v[64:67], v[16:19], 0
    ds_read_b128 v[64:67], v0 offset:28672
    s_waitcnt lgkmcnt(1)
    v_mfma_f32_16x16x32_bf16 v[52:55], v[16:19], v[16:19], 0
    v_mfma_f32_16x16x32_bf16 v[48:51], v[68:71], v[16:19], 0
    ds_read_b128 v[68:71], v0 offset:29696
    v_mfma_f32_16x16x32_bf16 v[44:47], v[72:75], v[20:23], v[44:47]
    ds_read_b128 v[72:75], v13 offset:2048
    v_add_f32 v32, v32, v34
    v_mfma_f32_16x16x32_bf16 v[52:55], v[20:23], v[20:23], v[52:55]
    v_add_f32 v33, v33, v35
    v_add_f32 v36, v36, v38
    v_mfma_f32_16x16x32_bf16 v[48:51], v[76:79], v[20:23], v[48:51]
    ds_read_b128 v[76:79], v13 offset:3072
    v_add_f32 v37, v37, v39
    v_mfma_f32_16x16x32_bf16 v[52:55], v[24:27], v[24:27], v[52:55]
    v_cvt_pk_bf16_f32 v32, v32, v33
    v_cvt_pk_bf16_f32 v36, v36, v37
    v_mfma_f32_16x16x32_bf16 v[52:55], v[28:31], v[28:31], v[52:55]
    v_cndmask_b32 v14, v14, v32, s[48:49]
    v_cndmask_b32 v15, v15, v36, s[48:49]
    v_mfma_f32_16x16x32_bf16 v[44:47], v[40:43], v[24:27], v[44:47]
    v_mov_b32 v33, 0
    s_waitcnt lgkmcnt(0)
    v_mfma_f32_16x16x32_bf16 v[44:47], v[64:67], v[28:31], v[44:47]
    v_permlane16_swap_b32 v14, v15
    v_max_f32 v34, v52, v53
    v_mfma_f32_16x16x32_bf16 v[48:51], v[60:63], v[24:27], v[48:51]
    buffer_store_dwordx2 v[14:15], v11, s[12:15], s42 offen sc1
    v_mov_b32 v37, 0
    v_mfma_f32_16x16x32_bf16 v[48:51], v[68:71], v[28:31], v[48:51]
    ds_read_b64 v[14:15], v0 offset:14464
    v_mov_b32 v55, 0
    v_max3_f32 v34, v34, v44, v45
    v_max3_f32 v34, v34, v46, v47
    v_mov_b32 v40, s56
    v_mov_b32 v41, s56
    s_nop 1
    v_max3_f32 v34, v34, v48, v49
    v_max3_f32 v35, v34, v50, v51
    v_max3_f32 v34, v34, v50, v51
    v_mov_b32 v42, s56
    v_mov_b32 v43, s56
    v_permlane16_swap_b32 v34, v35
    v_max_f32 v38, v34, v35
    v_max_f32 v34, v34, v35
    v_mov_b64 v[28:29], 0
    v_mov_b64 v[30:31], 0
    v_permlane32_swap_b32 v34, v38
    v_max_f32 v34, v34, v38
    v_mul_f32 v34, s52, v34
    v_pk_fma_f32 v[52:53], v[52:53], s[52:53], v[34:35] op_sel_hi:[1,0,0] neg_lo:[0,0,1] neg_hi:[0,0,1]
    v_pk_fma_f32 v[44:45], v[44:45], s[52:53], v[34:35] op_sel_hi:[1,0,0] neg_lo:[0,0,1] neg_hi:[0,0,1]
    v_pk_fma_f32 v[46:47], v[46:47], s[52:53], v[34:35] op_sel_hi:[1,0,0] neg_lo:[0,0,1] neg_hi:[0,0,1]
    v_pk_fma_f32 v[48:49], v[48:49], s[52:53], v[34:35] op_sel_hi:[1,0,0] neg_lo:[0,0,1] neg_hi:[0,0,1]
    v_pk_fma_f32 v[50:51], v[50:51], s[52:53], v[34:35] op_sel_hi:[1,0,0] neg_lo:[0,0,1] neg_hi:[0,0,1]
    v_exp_f32 v52, v52
    v_exp_f32 v53, v53
    v_exp_f32 v44, v44
    v_cvt_pk_bf16_f32 v54, v52, v53
    v_exp_f32 v45, v45
    v_exp_f32 v46, v46
    v_mfma_f32_16x16x16_bf16 v[16:19], v[32:33], v[54:55], 0
    v_exp_f32 v47, v47
    v_cvt_pk_bf16_f32 v24, v44, v45
    v_mfma_f32_16x16x16_bf16 v[20:23], v[36:37], v[54:55], 0
    v_exp_f32 v48, v48
    v_cvt_pk_bf16_f32 v25, v46, v47
    v_exp_f32 v49, v49
    v_exp_f32 v50, v50
    v_exp_f32 v51, v51
    v_cvt_pk_bf16_f32 v26, v48, v49
    v_cvt_pk_bf16_f32 v27, v50, v51
    v_mov_b64 v[32:33], 0
    v_mov_b64 v[34:35], 0
    v_mfma_f32_16x16x32_bf16 v[16:19], v[72:75], v[24:27], v[16:19]
    v_mov_b64 v[44:45], 0
    v_mov_b64 v[46:47], 0
    v_mfma_f32_16x16x32_bf16 v[20:23], v[76:79], v[24:27], v[20:23]
    s_mov_b64 exec, s[46:47]
    s_nop 2
    v_cvt_pk_bf16_f32 v16, v16, v17
    v_cvt_pk_bf16_f32 v17, v18, v19
    ds_write_b64 v9, v[16:17] offset:0
    s_nop 0
    v_cvt_pk_bf16_f32 v18, v20, v21
    v_cvt_pk_bf16_f32 v19, v22, v23
    ds_write_b64 v9, v[18:19] offset:8
    s_mov_b64 exec, -1
    s_waitcnt lgkmcnt(2)
    buffer_load_dwordx4 v15, s[12:15], s41 offen offset:2048 lds
    buffer_load_dwordx4 v15, s[12:15], s17 offen offset:3072 lds
    ds_read_b128 v[56:59], v6 offset:24576
    ds_read_b128 v[60:63], v6 offset:25600
    ds_read_b128 v[64:67], v6 offset:26624
    ds_read_b128 v[68:71], v6 offset:27648
    v_mov_b32 v20, 0
    v_mov_b32 v21, 0
    v_mov_b32 v22, 0
    v_mov_b32 v23, 0
    v_mfma_f32_16x16x32_bf16 v[36:39], v[24:27], v[40:43], 0
    v_mfma_f32_16x16x16_bf16 v[36:39], v[54:55], v[40:41], v[36:39]
    ds_read_b32 v13, v0 offset:14472
    s_waitcnt lgkmcnt(5)
    s_barrier
    ds_read_b128 v[48:51], v0 offset:0
    ds_read_b128 v[52:55], v0 offset:1024
    v_mov_b64 v[24:25], 0
    v_mov_b64 v[26:27], 0
    s_nop 0
    v_rcp_f32 v38, v38
    v_rcp_f32 v39, v39
    s_waitcnt lgkmcnt(1)
    v_smfmac_f32_16x16x64_bf16 v[28:31], v[48:51], v[56:63], v12
    ds_read_b128 v[56:59], v6 offset:20480
    s_waitcnt lgkmcnt(1)
    v_smfmac_f32_16x16x64_bf16 v[28:31], v[52:55], v[64:71], v12
    ds_read_b128 v[60:63], v6 offset:21504
    v_smfmac_f32_16x16x64_bf16 v[32:35], v[48:51], a[208:215], v12
    ds_read_b128 v[64:67], v6 offset:22528
    s_cmp_lg_u32 s10, 0
    v_smfmac_f32_16x16x64_bf16 v[32:35], v[52:55], a[216:223], v12
    ds_read_b128 v[68:71], v6 offset:23552
    v_add_f32 v28, v28, v30
    v_smfmac_f32_16x16x64_bf16 v[44:47], v[48:51], a[224:231], v12
    ds_read_b64 v[72:73], v8 offset:5248
    v_add_f32 v29, v29, v31
    v_mul_f32 v28, v28, v38
    v_smfmac_f32_16x16x64_bf16 v[44:47], v[52:55], a[232:239], v12
    ds_read_b64 v[74:75], v8 offset:5248
    v_mul_f32 v29, v29, v39
    v_cvt_pk_bf16_f32 v28, v28, v29
    v_smfmac_f32_16x16x64_bf16 v[20:23], v[48:51], a[240:247], v12
    buffer_store_dword v28, v10, s[12:15], s34 offen
    v_add_f32 v32, v32, v34
    v_add_f32 v33, v33, v35
    v_smfmac_f32_16x16x64_bf16 v[20:23], v[52:55], a[248:255], v12
    v_mul_f32 v32, v32, v38
    v_mul_f32 v33, v33, v39
    s_waitcnt lgkmcnt(2)
    v_smfmac_f32_16x16x64_bf16 v[24:27], v[48:51], v[56:63], v12
    v_cvt_pk_bf16_f32 v32, v32, v33
    v_smfmac_f32_16x16x64_bf16 v[24:27], v[52:55], v[64:71], v12
    buffer_store_dword v32, v10, s[12:15], s31 offen
    v_add_f32 v44, v44, v46
    v_add_f32 v45, v45, v47
    v_mul_f32 v44, v44, v38
    v_mul_f32 v45, v45, v39
    v_cvt_pk_bf16_f32 v44, v44, v45
    buffer_store_dword v44, v10, s[12:15], s32 offen
    v_add_f32 v20, v20, v22
    v_add_f32 v21, v21, v23
    v_mul_f32 v20, v20, v38
    v_mul_f32 v21, v21, v39
    v_cvt_pk_bf16_f32 v20, v20, v21
    buffer_store_dword v20, v10, s[12:15], s33 offen
    v_pk_add_f32 v[24:25], v[24:25], v[26:27]
    v_pk_mul_f32 v[24:25], v[24:25], v[38:39]
    s_waitcnt vmcnt(7)
    v_cvt_pk_bf16_f32 v24, v24, v25
    buffer_store_dword v24, v10, s[12:15], s30 offen
    s_cbranch_scc1 C_notw0
    v_mov_b64 v[76:77], 0
    v_mov_b64 v[78:79], 0
    ds_read_b128 v[56:59], v6 offset:0
    ds_read_b128 v[60:63], v6 offset:1024
    ds_read_b128 v[64:67], v6 offset:2048
    ds_read_b128 v[68:71], v6 offset:3072
    ds_read_b64 v[54:55], v0 offset:14464
    s_add_u32 s40, s36, s24
    s_add_u32 s59, s59, 0x2000
    s_and_b32 s59, s59, 0x6000
    s_add_u32 s36, s54, s59
    s_add_u32 s38, s36, s55
    s_add_u32 s39, s39, 0x8000
    s_add_u32 s20, s20, 1
    s_add_u32 s62, s20, 1
    buffer_load_dwordx4 v[40:43], v0, s[12:15], s35 offen sc1
    buffer_load_dwordx4 v[44:47], v0, s[12:15], s35 offen offset:1024 sc1
    v_mov_b32 v16, 0
    v_mov_b32 v17, 0
    v_mov_b32 v18, 0
    v_mov_b32 v19, 0
    v_mov_b32 v20, 0
    v_mov_b32 v21, 0
    buffer_load_dwordx4 v[40:43], v0, s[12:15], s35 offen sc1
    buffer_load_dwordx4 v[44:47], v0, s[12:15], s35 offen offset:1024 sc1
    v_mov_b32 v22, 0
    v_mov_b32 v23, 0
    v_mov_b32 v24, 0
    v_mov_b32 v25, 0
    v_mov_b32 v26, 0
    v_mov_b32 v27, 0
    buffer_load_dwordx4 v[40:43], v0, s[12:15], s35 offen sc1
    buffer_load_dwordx4 v[44:47], v0, s[12:15], s35 offen offset:1024 sc1
    s_waitcnt lgkmcnt(5)
C_rp0:
    s_waitcnt vmcnt(4)
C_rp0x:
    v_cmp_u_f32 vcc, v43, v47
    v_smfmac_f32_16x16x64_bf16 v[76:79], v[72:75], v[40:47], v12 abid:1
    s_cbranch_vccz C_red0
    buffer_load_dwordx4 v[40:43], v0, s[12:15], s35 offen sc1
    buffer_load_dwordx4 v[44:47], v0, s[12:15], s35 offen offset:1024 sc1
    v_mov_b64 v[48:49], 0
    v_mov_b64 v[50:51], 0
    s_waitcnt vmcnt(4)
    v_cmp_u_f32 vcc, v43, v47
    v_smfmac_f32_16x16x64_bf16 v[48:51], v[72:75], v[40:47], v12 abid:1
    s_cbranch_vccz C_red1
    buffer_load_dwordx4 v[40:43], v0, s[12:15], s35 offen sc1
    buffer_load_dwordx4 v[44:47], v0, s[12:15], s35 offen offset:1024 sc1
    v_mov_b64 v[76:77], 0
    v_mov_b64 v[78:79], 0
    s_sub_u32 s22, s22, 1
    s_cbranch_scc0 C_rp0
    s_branch C_fail
C_red0:
    s_nop 2
    v_cmp_u_f32 vcc, v76, v77
    v_add_f32_dpp v76, v76, v76 row_ror:4 row_mask:0xf bank_mask:0xf
    v_add_f32_dpp v77, v77, v77 row_ror:4 row_mask:0xf bank_mask:0xf
    s_cmp_eq_u64 vcc, 0
    v_add_f32_dpp v76, v76, v76 row_ror:8 row_mask:0xf bank_mask:0xf
    v_add_f32_dpp v77, v77, v77 row_ror:8 row_mask:0xf bank_mask:0xf
    s_cselect_b64 exec, s[50:51], 0
    v_cvt_pk_bf16_f32 v39, v76, v77
    buffer_store_dword v39, v13, s[12:15], s38 offen
    buffer_store_dword v39, v13, s[12:15], s39 offen sc1
    s_mov_b64 exec, -1
    s_cbranch_scc1 C_loop
    s_branch C_rsx
C_red1:
    s_nop 2
    v_cmp_u_f32 vcc, v48, v49
    v_add_f32_dpp v48, v48, v48 row_ror:4 row_mask:0xf bank_mask:0xf
    v_add_f32_dpp v49, v49, v49 row_ror:4 row_mask:0xf bank_mask:0xf
    s_cmp_eq_u64 vcc, 0
    v_add_f32_dpp v48, v48, v48 row_ror:8 row_mask:0xf bank_mask:0xf
    v_add_f32_dpp v49, v49, v49 row_ror:8 row_mask:0xf bank_mask:0xf
    s_cselect_b64 exec, s[50:51], 0
    v_cvt_pk_bf16_f32 v39, v48, v49
    buffer_store_dword v39, v13, s[12:15], s38 offen
    buffer_store_dword v39, v13, s[12:15], s39 offen sc1
    s_mov_b64 exec, -1
    s_cbranch_scc1 C_loop
    s_branch C_rsx
C_notw0:
    s_cmp_eq_u32 s21, 0
    s_cbranch_scc1 C_nored
    v_mov_b64 v[76:77], 0
    v_mov_b64 v[78:79], 0
    ds_read_b128 v[56:59], v6 offset:0
    ds_read_b128 v[60:63], v6 offset:1024
    ds_read_b128 v[64:67], v6 offset:2048
    ds_read_b128 v[68:71], v6 offset:3072
    buffer_load_dwordx4 v[40:43], v0, s[12:15], s35 offen sc1
    buffer_load_dwordx4 v[44:47], v0, s[12:15], s35 offen offset:1024 sc1
    ds_read_b64 v[54:55], v0 offset:14464
    s_add_u32 s40, s36, s24
    s_add_u32 s59, s59, 0x2000
    s_and_b32 s59, s59, 0x6000
    s_add_u32 s36, s54, s59
    s_add_u32 s38, s36, s55
    s_add_u32 s39, s39, 0x8000
    s_add_u32 s20, s20, 1
    s_add_u32 s62, s20, 1
    v_mov_b32 v16, 0
    v_mov_b32 v17, 0
    v_mov_b32 v18, 0
    v_mov_b32 v19, 0
    v_mov_b32 v20, 0
    v_mov_b32 v21, 0
    v_mov_b32 v22, 0
    v_mov_b32 v23, 0
    v_mov_b32 v24, 0
    v_mov_b32 v25, 0
    v_mov_b32 v26, 0
    v_mov_b32 v27, 0
    buffer_load_dwordx4 v[40:43], v0, s[12:15], s35 offen sc1
    buffer_load_dwordx4 v[44:47], v0, s[12:15], s35 offen offset:1024 sc1
    s_waitcnt lgkmcnt(5)
C_rp1:
    s_waitcnt vmcnt(2)
C_rp1x:
    v_cmp_u_f32 vcc, v43, v47
    v_smfmac_f32_16x16x64_bf16 v[76:79], v[72:75], v[40:47], v12 abid:1
    s_cbranch_vccz C_red0
    buffer_load_dwordx4 v[40:43], v0, s[12:15], s35 offen sc1
    buffer_load_dwordx4 v[44:47], v0, s[12:15], s35 offen offset:1024 sc1
    v_mov_b64 v[48:49], 0
    v_mov_b64 v[50:51], 0
    s_waitcnt vmcnt(2)
    v_cmp_u_f32 vcc, v43, v47
    v_smfmac_f32_16x16x64_bf16 v[48:51], v[72:75], v[40:47], v12 abid:1
    s_cbranch_vccz C_red1
    buffer_load_dwordx4 v[40:43], v0, s[12:15], s35 offen sc1
    buffer_load_dwordx4 v[44:47], v0, s[12:15], s35 offen offset:1024 sc1
    v_mov_b64 v[76:77], 0
    v_mov_b64 v[78:79], 0
    s_sub_u32 s22, s22, 1
    s_cbranch_scc0 C_rp1
    s_branch C_fail
C_nored:
    v_mov_b64 v[40:41], -1
    v_mov_b64 v[42:43], -1
    s_mov_b64 exec, 0x3ff
    buffer_store_dwordx4 v[40:43], v0, s[12:15], s40 offen
    s_mov_b64 exec, -1
    ds_read_b128 v[56:59], v6 offset:0
    ds_read_b128 v[60:63], v6 offset:1024
    ds_read_b128 v[64:67], v6 offset:2048
    ds_read_b128 v[68:71], v6 offset:3072
    ds_read_b64 v[54:55], v0 offset:14464
    s_add_u32 s40, s36, s24
    s_add_u32 s59, s59, 0x2000
    s_and_b32 s59, s59, 0x6000
    s_add_u32 s36, s54, s59
    s_add_u32 s38, s36, s55
    s_add_u32 s39, s39, 0x8000
    s_add_u32 s20, s20, 1
    s_add_u32 s62, s20, 1
    v_mov_b32 v16, 0
    v_mov_b32 v17, 0
    v_mov_b32 v18, 0
    v_mov_b32 v19, 0
    v_mov_b32 v20, 0
    v_mov_b32 v21, 0
    v_mov_b32 v22, 0
    v_mov_b32 v23, 0
    v_mov_b32 v24, 0
    v_mov_b32 v25, 0
    v_mov_b32 v26, 0
    v_mov_b32 v27, 0
    s_waitcnt lgkmcnt(5)
    s_branch C_loop
C_rsx:
    v_mov_b64 v[76:77], 0
    v_mov_b64 v[78:79], 0
    s_sub_u32 s22, s22, 1
    s_cbranch_scc1 C_fail
    s_branch C_rp1x
C_lf:
    v_mov_b64 v[16:17], 0
    v_mov_b64 v[18:19], 0
    s_nop 0
    v_mov_b64 v[24:25], 0
    v_mov_b64 v[26:27], 0
    s_waitcnt vmcnt(0)
    v_cmp_u_f32 vcc, v44, v13
    v_mov_b64 v[40:41], v[44:45]
    v_mov_b64 v[42:43], v[46:47]
    v_mov_b32 v14, v13
    s_cbranch_vccz C_lgo
C_lf2:
    buffer_load_dwordx4 v[40:43], v2, s[12:15], s36 offen sc1
    buffer_load_dword v14, v1, s[12:15], s36 offen sc1
    s_sub_u32 s22, s22, 1
    s_cbranch_scc1 C_fail
    s_waitcnt vmcnt(0)
    v_cmp_u_f32 vcc, v40, v14
    s_cbranch_vccz C_lgo
    s_branch C_lf2
C_rf:
    buffer_load_dwordx4 v[44:47], v2, s[12:15], s37 offen sc1
    buffer_load_dword v13, v1, s[12:15], s37 offen sc1
    s_sub_u32 s22, s22, 1
    s_cbranch_scc1 C_fail
    s_waitcnt vmcnt(0)
    v_cmp_u_f32 vcc, v44, v13
    ds_write_b128 v2, v[44:47] offset:5120
    ds_write_b32 v1, v13 offset:5120
    s_cbranch_vccnz C_rf
    s_waitcnt lgkmcnt(0)
    s_branch C_rgo
C_kvslow:
    s_cmp_ge_u32 s62, 64
    s_cbranch_scc1 C_kvback
C_kvs_p:
    v_lshrrev_b32 v72, 2, v0
    s_mov_b64 exec, 15
    buffer_load_dword v72, v72, s[12:15], s44 offen offset:768 sc1
    s_mov_b64 exec, -1
    s_sub_u32 s22, s22, 1
    s_cbranch_scc1 C_fail
    s_waitcnt vmcnt(0)
C_kvs_r:
    v_readlane_b32 s43, v72, 0
    v_readlane_b32 s60, v72, 1
    s_min_u32 s43, s43, s60
    v_readlane_b32 s60, v72, 2
    s_min_u32 s43, s43, s60
    v_readlane_b32 s60, v72, 3
    s_min_u32 s43, s43, s60
    s_cmp_lt_u32 s62, s43
    s_cbranch_scc0 C_kvs_p
    s_add_u32 s60, s62, 12
    s_min_u32 s60, s60, s43
    s_cmp_ge_u32 s43, 64
    s_cselect_b32 s43, 64, s60
    s_sub_u32 s92, s43, 1
    s_branch C_kvback
C_final:
    s_waitcnt lgkmcnt(0)
    v_smfmac_f32_16x16x64_bf16 v[36:39], v[40:43], a[152:159], v12
    v_smfmac_f32_16x16x64_bf16 v[32:35], v[48:51], a[160:167], v12
    v_smfmac_f32_16x16x64_bf16 v[36:39], v[48:51], a[168:175], v12
    v_smfmac_f32_16x16x64_bf16 v[32:35], v[52:55], a[176:183], v12
    v_smfmac_f32_16x16x64_bf16 v[36:39], v[52:55], a[184:191], v12
    v_smfmac_f32_16x16x64_bf16 v[32:35], v[56:59], a[192:199], v12
    v_smfmac_f32_16x16x64_bf16 v[36:39], v[56:59], a[200:207], v12
    s_nop 3
    v_add_f32 v32, v32, v34
    v_add_f32 v33, v33, v35
    v_cvt_pk_bf16_f32 v32, v32, v33
    s_nop 0
    v_add_f32 v36, v36, v38
    v_add_f32 v37, v37, v39
    v_cvt_pk_bf16_f32 v36, v36, v37
    v_cndmask_b32 v14, v14, v32, s[48:49]
    v_cndmask_b32 v15, v15, v36, s[48:49]
    s_nop 1
    v_permlane16_swap_b32 v14, v15
    buffer_store_dwordx2 v[14:15], v11, s[12:15], s42 offen sc1
    s_waitcnt vmcnt(0)
    s_barrier
    s_cmp_eq_u32 s10, 3
    s_cbranch_scc0 C_done
    s_lshl_b32 s61, s8, 2
    v_mov_b32 v14, 64
    v_mov_b32 v15, s61
    s_mov_b64 exec, 1
    buffer_store_dword v14, v15, s[12:15], s44 offen offset:384 sc1
    s_mov_b64 exec, -1
C_done:
    s_endpgm
C_fail:
    s_mov_b64 exec, 1
    v_mov_b32 v14, s20
    v_add_u32 v14, 0x1000, v14
    v_mov_b32 v15, 252
    global_store_dword v15, v14, s[6:7]
    s_endpgm
P_end:
    s_waitcnt vmcnt(0)
    s_endpgm
P_worker:
    s_load_dwordx2 s[72:73], s[0:1], 0
    s_mov_b32 s74, 2621440
    s_mov_b32 s75, 0x00020000
    s_load_dwordx2 s[76:77], s[0:1], 24
    s_mov_b32 s78, 5242880
    s_mov_b32 s79, 0x00020000
    s_load_dwordx2 s[80:81], s[0:1], 32
    s_mov_b32 s82, 5242880
    s_mov_b32 s83, 0x00020000
    s_load_dwordx2 s[84:85], s[0:1], 16
    s_mov_b32 s86, 5242880
    s_mov_b32 s87, 0x00020000
    s_load_dwordx2 s[88:89], s[0:1], 64
    s_mov_b32 s90, 2211840
    s_mov_b32 s91, 0x00020000
    s_sub_u32 s50, s8, 2
    s_mov_b32 s51, s9
    s_lshl_b32 s60, s50, 5
    s_add_u32 s60, s60, s51
    s_mul_i32 s9, s60, 171
    s_lshr_b32 s9, s9, 10
    s_mul_i32 s61, s9, 6
    s_sub_u32 s8, s60, s61
    s_mov_b32 s52, s60
    v_lshlrev_b32 v1, 4, v0
    v_lshlrev_b32 v2, 2, v0
    s_sub_u32 s26, s50, 1
    s_lshl_b32 s26, s26, 10
    s_cmp_lt_u32 s50, 2
    s_cselect_b32 s26, 0, s26
    s_cselect_b32 s61, s52, s51
    s_add_u32 s26, s26, 3080192
    s_lshl_b32 s61, s61, 2
    s_add_u32 s20, s26, s61
    s_mul_i32 s28, s10, 20480
    s_add_u32 s28, s28, 81920
    s_lshl_b32 s29, s10, 10
    s_mul_i32 s60, s10, 6
    s_add_u32 s60, s60, s8
    s_lshl_b32 s60, s60, 5
    s_add_u32 s60, s60, s9
    s_mul_i32 s60, s60, 1280
    s_add_u32 s61, s60, 983040
    s_add_u32 s62, s61, 983040
    s_waitcnt lgkmcnt(0)
    buffer_load_dword v16, v2, s[72:75], s60 offen offset:0
    buffer_load_dword v17, v2, s[72:75], s60 offen offset:256
    buffer_load_dword v18, v2, s[72:75], s60 offen offset:512
    buffer_load_dword v19, v2, s[72:75], s60 offen offset:768
    buffer_load_dword v20, v2, s[72:75], s60 offen offset:1024
    buffer_load_dword v21, v2, s[72:75], s61 offen offset:0
    buffer_load_dword v22, v2, s[72:75], s61 offen offset:256
    buffer_load_dword v23, v2, s[72:75], s61 offen offset:512
    buffer_load_dword v24, v2, s[72:75], s61 offen offset:768
    buffer_load_dword v25, v2, s[72:75], s61 offen offset:1024
    buffer_load_dword v26, v2, s[72:75], s62 offen offset:0
    buffer_load_dword v27, v2, s[72:75], s62 offen offset:256
    buffer_load_dword v28, v2, s[72:75], s62 offen offset:512
    buffer_load_dword v29, v2, s[72:75], s62 offen offset:768
    buffer_load_dword v30, v2, s[72:75], s62 offen offset:1024
    s_mul_i32 s63, s51, 266240
    s_add_u32 s59, s50, 1
    s_cmp_eq_u32 s59, 6
    s_cselect_b32 s59, 0, s59
    s_mul_i32 s59, s59, 4096
    s_add_u32 s63, s63, s59
    s_add_u32 s63, s63, s29
    s_add_u32 s63, s63, 7577600
    v_mov_b64 v[36:37], -1
    v_mov_b64 v[38:39], -1
    buffer_store_dwordx4 v[36:39], v1, s[12:15], s63 offen sc1
    s_cmp_eq_u32 s10, 0
    s_cbranch_scc0 W_nz
    v_lshlrev_b32 v3, 8, v0
    v_mov_b32 v4, 0
    s_mov_b64 exec, 3
    buffer_store_dword v4, v3, s[12:15], s20 offen sc1
    s_mov_b64 exec, -1
W_nz:
    s_lshl_b32 s18, s10, 7
    s_add_u32 s18, s18, s20
    v_mov_b32 v4, 0
    s_mov_b64 exec, 1
    buffer_store_dword v4, off, s[12:15], s18 offset:512 sc1
    s_mov_b64 exec, -1
    s_waitcnt vmcnt(2)
    v_lshlrev_b32 v32, 16, v16
    v_and_b32 v33, 0xffff0000, v16
    v_lshlrev_b32 v34, 16, v17
    v_and_b32 v35, 0xffff0000, v17
    v_lshlrev_b32 v36, 16, v18
    v_and_b32 v37, 0xffff0000, v18
    v_lshlrev_b32 v38, 16, v19
    v_and_b32 v39, 0xffff0000, v19
    v_lshlrev_b32 v40, 16, v20
    v_and_b32 v41, 0xffff0000, v20
    v_add_f32 v64, v32, v33
    v_add_f32 v64, v64, v34
    v_add_f32 v64, v64, v35
    v_add_f32 v64, v64, v36
    v_add_f32 v64, v64, v37
    v_add_f32 v64, v64, v38
    v_add_f32 v64, v64, v39
    v_add_f32 v64, v64, v40
    v_add_f32 v64, v64, v41
    v_lshlrev_b32 v42, 16, v21
    v_and_b32 v43, 0xffff0000, v21
    v_lshlrev_b32 v44, 16, v22
    v_and_b32 v45, 0xffff0000, v22
    v_lshlrev_b32 v46, 16, v23
    v_and_b32 v47, 0xffff0000, v23
    v_lshlrev_b32 v48, 16, v24
    v_and_b32 v49, 0xffff0000, v24
    v_lshlrev_b32 v50, 16, v25
    v_and_b32 v51, 0xffff0000, v25
    v_add_f32 v65, v42, v43
    v_add_f32 v65, v65, v44
    v_add_f32 v65, v65, v45
    v_add_f32 v65, v65, v46
    v_add_f32 v65, v65, v47
    v_add_f32 v65, v65, v48
    v_add_f32 v65, v65, v49
    v_add_f32 v65, v65, v50
    v_add_f32 v65, v65, v51
    v_lshlrev_b32 v52, 16, v26
    v_and_b32 v53, 0xffff0000, v26
    v_lshlrev_b32 v54, 16, v27
    v_and_b32 v55, 0xffff0000, v27
    v_lshlrev_b32 v56, 16, v28
    v_and_b32 v57, 0xffff0000, v28
    v_lshlrev_b32 v58, 16, v29
    v_and_b32 v59, 0xffff0000, v29
    v_lshlrev_b32 v60, 16, v30
    v_and_b32 v61, 0xffff0000, v30
    v_add_f32 v66, v52, v53
    v_add_f32 v66, v66, v54
    v_add_f32 v66, v66, v55
    v_add_f32 v66, v66, v56
    v_add_f32 v66, v66, v57
    v_add_f32 v66, v66, v58
    v_add_f32 v66, v66, v59
    v_add_f32 v66, v66, v60
    v_add_f32 v66, v66, v61
    v_add_f32_dpp v64, v64, v64 row_ror:1 row_mask:0xf bank_mask:0xf
    v_add_f32_dpp v65, v65, v65 row_ror:1 row_mask:0xf bank_mask:0xf
    v_add_f32_dpp v66, v66, v66 row_ror:1 row_mask:0xf bank_mask:0xf
    v_add_f32_dpp v64, v64, v64 row_ror:2 row_mask:0xf bank_mask:0xf
    v_add_f32_dpp v65, v65, v65 row_ror:2 row_mask:0xf bank_mask:0xf
    v_add_f32_dpp v66, v66, v66 row_ror:2 row_mask:0xf bank_mask:0xf
    v_add_f32_dpp v64, v64, v64 row_ror:4 row_mask:0xf bank_mask:0xf
    v_add_f32_dpp v65, v65, v65 row_ror:4 row_mask:0xf bank_mask:0xf
    v_add_f32_dpp v66, v66, v66 row_ror:4 row_mask:0xf bank_mask:0xf
    v_add_f32_dpp v64, v64, v64 row_ror:8 row_mask:0xf bank_mask:0xf
    v_add_f32_dpp v65, v65, v65 row_ror:8 row_mask:0xf bank_mask:0xf
    v_add_f32_dpp v66, v66, v66 row_ror:8 row_mask:0xf bank_mask:0xf
    v_mov_b32 v67, v64
    v_mov_b32 v68, v65
    v_mov_b32 v69, v66
    v_permlane16_swap_b32 v64, v67
    v_permlane16_swap_b32 v65, v68
    v_permlane16_swap_b32 v66, v69
    v_add_f32 v64, v64, v67
    v_add_f32 v65, v65, v68
    v_add_f32 v66, v66, v69
    v_mov_b32 v67, v64
    v_mov_b32 v68, v65
    v_mov_b32 v69, v66
    v_permlane32_swap_b32 v64, v67
    v_permlane32_swap_b32 v65, v68
    v_permlane32_swap_b32 v66, v69
    v_add_f32 v64, v64, v67
    v_add_f32 v65, v65, v68
    v_add_f32 v66, v66, v69
    s_mov_b32 s63, 0x3acccccd
    v_mul_f32 v64, s63, v64
    v_sub_f32 v76, v32, v64
    v_mul_f32 v70, v76, v76
    v_sub_f32 v76, v33, v64
    v_fma_f32 v70, v76, v76, v70
    v_sub_f32 v76, v34, v64
    v_fma_f32 v70, v76, v76, v70
    v_sub_f32 v76, v35, v64
    v_fma_f32 v70, v76, v76, v70
    v_sub_f32 v76, v36, v64
    v_fma_f32 v70, v76, v76, v70
    v_sub_f32 v76, v37, v64
    v_fma_f32 v70, v76, v76, v70
    v_sub_f32 v76, v38, v64
    v_fma_f32 v70, v76, v76, v70
    v_sub_f32 v76, v39, v64
    v_fma_f32 v70, v76, v76, v70
    v_sub_f32 v76, v40, v64
    v_fma_f32 v70, v76, v76, v70
    v_sub_f32 v76, v41, v64
    v_fma_f32 v70, v76, v76, v70
    v_mul_f32 v65, s63, v65
    v_sub_f32 v76, v42, v65
    v_mul_f32 v71, v76, v76
    v_sub_f32 v76, v43, v65
    v_fma_f32 v71, v76, v76, v71
    v_sub_f32 v76, v44, v65
    v_fma_f32 v71, v76, v76, v71
    v_sub_f32 v76, v45, v65
    v_fma_f32 v71, v76, v76, v71
    v_sub_f32 v76, v46, v65
    v_fma_f32 v71, v76, v76, v71
    v_sub_f32 v76, v47, v65
    v_fma_f32 v71, v76, v76, v71
    v_sub_f32 v76, v48, v65
    v_fma_f32 v71, v76, v76, v71
    v_sub_f32 v76, v49, v65
    v_fma_f32 v71, v76, v76, v71
    v_sub_f32 v76, v50, v65
    v_fma_f32 v71, v76, v76, v71
    v_sub_f32 v76, v51, v65
    v_fma_f32 v71, v76, v76, v71
    v_mul_f32 v66, s63, v66
    v_sub_f32 v76, v52, v66
    v_mul_f32 v72, v76, v76
    v_sub_f32 v76, v53, v66
    v_fma_f32 v72, v76, v76, v72
    v_sub_f32 v76, v54, v66
    v_fma_f32 v72, v76, v76, v72
    v_sub_f32 v76, v55, v66
    v_fma_f32 v72, v76, v76, v72
    v_sub_f32 v76, v56, v66
    v_fma_f32 v72, v76, v76, v72
    v_sub_f32 v76, v57, v66
    v_fma_f32 v72, v76, v76, v72
    v_sub_f32 v76, v58, v66
    v_fma_f32 v72, v76, v76, v72
    v_sub_f32 v76, v59, v66
    v_fma_f32 v72, v76, v76, v72
    v_sub_f32 v76, v60, v66
    v_fma_f32 v72, v76, v76, v72
    v_sub_f32 v76, v61, v66
    v_fma_f32 v72, v76, v76, v72
    v_add_f32_dpp v70, v70, v70 row_ror:1 row_mask:0xf bank_mask:0xf
    v_add_f32_dpp v71, v71, v71 row_ror:1 row_mask:0xf bank_mask:0xf
    v_add_f32_dpp v72, v72, v72 row_ror:1 row_mask:0xf bank_mask:0xf
    v_add_f32_dpp v70, v70, v70 row_ror:2 row_mask:0xf bank_mask:0xf
    v_add_f32_dpp v71, v71, v71 row_ror:2 row_mask:0xf bank_mask:0xf
    v_add_f32_dpp v72, v72, v72 row_ror:2 row_mask:0xf bank_mask:0xf
    v_add_f32_dpp v70, v70, v70 row_ror:4 row_mask:0xf bank_mask:0xf
    v_add_f32_dpp v71, v71, v71 row_ror:4 row_mask:0xf bank_mask:0xf
    v_add_f32_dpp v72, v72, v72 row_ror:4 row_mask:0xf bank_mask:0xf
    v_add_f32_dpp v70, v70, v70 row_ror:8 row_mask:0xf bank_mask:0xf
    v_add_f32_dpp v71, v71, v71 row_ror:8 row_mask:0xf bank_mask:0xf
    v_add_f32_dpp v72, v72, v72 row_ror:8 row_mask:0xf bank_mask:0xf
    v_mov_b32 v73, v70
    v_mov_b32 v74, v71
    v_mov_b32 v75, v72
    v_permlane16_swap_b32 v70, v73
    v_permlane16_swap_b32 v71, v74
    v_permlane16_swap_b32 v72, v75
    v_add_f32 v70, v70, v73
    v_add_f32 v71, v71, v74
    v_add_f32 v72, v72, v75
    v_mov_b32 v73, v70
    v_mov_b32 v74, v71
    v_mov_b32 v75, v72
    v_permlane32_swap_b32 v70, v73
    v_permlane32_swap_b32 v71, v74
    v_permlane32_swap_b32 v72, v75
    v_add_f32 v70, v70, v73
    v_add_f32 v71, v71, v74
    v_add_f32 v72, v72, v75
    v_mul_f32 v70, s63, v70
    v_cvt_pk_bf16_f32 v70, v70, v70
    v_lshlrev_b32 v70, 16, v70
    v_add_f32 v70, 0x3727c5ac, v70
    v_cvt_pk_bf16_f32 v70, v70, v70
    v_lshlrev_b32 v70, 16, v70
    v_sqrt_f32 v70, v70
    s_nop 0
    v_cvt_pk_bf16_f32 v70, v70, v70
    v_lshlrev_b32 v70, 16, v70
    v_rcp_f32 v73, v70
    v_cvt_pk_bf16_f32 v64, v64, v64
    v_lshlrev_b32 v64, 16, v64
    s_add_u32 s60, s60, 4194304
    v_sub_f32 v32, v32, v64
    v_sub_f32 v33, v33, v64
    v_cvt_pk_bf16_f32 v33, v32, v33
    v_lshlrev_b32 v32, 16, v33
    v_and_b32 v33, 0xffff0000, v33
    v_mul_f32 v76, v32, v73
    v_mul_f32 v77, v33, v73
    v_fma_f32 v32, -v76, v70, v32
    v_fma_f32 v33, -v77, v70, v33
    v_fma_f32 v76, v32, v73, v76
    v_fma_f32 v77, v33, v73, v77
    v_cvt_pk_bf16_f32 v32, v76, v77
    buffer_store_dword v32, v2, s[12:15], s60 offen offset:0 sc1
    v_sub_f32 v34, v34, v64
    v_sub_f32 v35, v35, v64
    v_cvt_pk_bf16_f32 v35, v34, v35
    v_lshlrev_b32 v34, 16, v35
    v_and_b32 v35, 0xffff0000, v35
    v_mul_f32 v76, v34, v73
    v_mul_f32 v77, v35, v73
    v_fma_f32 v34, -v76, v70, v34
    v_fma_f32 v35, -v77, v70, v35
    v_fma_f32 v76, v34, v73, v76
    v_fma_f32 v77, v35, v73, v77
    v_cvt_pk_bf16_f32 v34, v76, v77
    buffer_store_dword v34, v2, s[12:15], s60 offen offset:256 sc1
    v_sub_f32 v36, v36, v64
    v_sub_f32 v37, v37, v64
    v_cvt_pk_bf16_f32 v37, v36, v37
    v_lshlrev_b32 v36, 16, v37
    v_and_b32 v37, 0xffff0000, v37
    v_mul_f32 v76, v36, v73
    v_mul_f32 v77, v37, v73
    v_fma_f32 v36, -v76, v70, v36
    v_fma_f32 v37, -v77, v70, v37
    v_fma_f32 v76, v36, v73, v76
    v_fma_f32 v77, v37, v73, v77
    v_cvt_pk_bf16_f32 v36, v76, v77
    buffer_store_dword v36, v2, s[12:15], s60 offen offset:512 sc1
    v_sub_f32 v38, v38, v64
    v_sub_f32 v39, v39, v64
    v_cvt_pk_bf16_f32 v39, v38, v39
    v_lshlrev_b32 v38, 16, v39
    v_and_b32 v39, 0xffff0000, v39
    v_mul_f32 v76, v38, v73
    v_mul_f32 v77, v39, v73
    v_fma_f32 v38, -v76, v70, v38
    v_fma_f32 v39, -v77, v70, v39
    v_fma_f32 v76, v38, v73, v76
    v_fma_f32 v77, v39, v73, v77
    v_cvt_pk_bf16_f32 v38, v76, v77
    buffer_store_dword v38, v2, s[12:15], s60 offen offset:768 sc1
    v_sub_f32 v40, v40, v64
    v_sub_f32 v41, v41, v64
    v_cvt_pk_bf16_f32 v41, v40, v41
    v_lshlrev_b32 v40, 16, v41
    v_and_b32 v41, 0xffff0000, v41
    v_mul_f32 v76, v40, v73
    v_mul_f32 v77, v41, v73
    v_fma_f32 v40, -v76, v70, v40
    v_fma_f32 v41, -v77, v70, v41
    v_fma_f32 v76, v40, v73, v76
    v_fma_f32 v77, v41, v73, v77
    v_cvt_pk_bf16_f32 v40, v76, v77
    buffer_store_dword v40, v2, s[12:15], s60 offen offset:1024 sc1
    v_mul_f32 v71, s63, v71
    v_cvt_pk_bf16_f32 v71, v71, v71
    v_lshlrev_b32 v71, 16, v71
    v_add_f32 v71, 0x3727c5ac, v71
    v_cvt_pk_bf16_f32 v71, v71, v71
    v_lshlrev_b32 v71, 16, v71
    v_sqrt_f32 v71, v71
    s_nop 0
    v_cvt_pk_bf16_f32 v71, v71, v71
    v_lshlrev_b32 v71, 16, v71
    v_rcp_f32 v74, v71
    v_cvt_pk_bf16_f32 v65, v65, v65
    v_lshlrev_b32 v65, 16, v65
    s_add_u32 s61, s61, 4194304
    v_sub_f32 v42, v42, v65
    v_sub_f32 v43, v43, v65
    v_cvt_pk_bf16_f32 v43, v42, v43
    v_lshlrev_b32 v42, 16, v43
    v_and_b32 v43, 0xffff0000, v43
    v_mul_f32 v76, v42, v74
    v_mul_f32 v77, v43, v74
    v_fma_f32 v42, -v76, v71, v42
    v_fma_f32 v43, -v77, v71, v43
    v_fma_f32 v76, v42, v74, v76
    v_fma_f32 v77, v43, v74, v77
    v_cvt_pk_bf16_f32 v42, v76, v77
    buffer_store_dword v42, v2, s[12:15], s61 offen offset:0 sc1
    v_sub_f32 v44, v44, v65
    v_sub_f32 v45, v45, v65
    v_cvt_pk_bf16_f32 v45, v44, v45
    v_lshlrev_b32 v44, 16, v45
    v_and_b32 v45, 0xffff0000, v45
    v_mul_f32 v76, v44, v74
    v_mul_f32 v77, v45, v74
    v_fma_f32 v44, -v76, v71, v44
    v_fma_f32 v45, -v77, v71, v45
    v_fma_f32 v76, v44, v74, v76
    v_fma_f32 v77, v45, v74, v77
    v_cvt_pk_bf16_f32 v44, v76, v77
    buffer_store_dword v44, v2, s[12:15], s61 offen offset:256 sc1
    v_sub_f32 v46, v46, v65
    v_sub_f32 v47, v47, v65
    v_cvt_pk_bf16_f32 v47, v46, v47
    v_lshlrev_b32 v46, 16, v47
    v_and_b32 v47, 0xffff0000, v47
    v_mul_f32 v76, v46, v74
    v_mul_f32 v77, v47, v74
    v_fma_f32 v46, -v76, v71, v46
    v_fma_f32 v47, -v77, v71, v47
    v_fma_f32 v76, v46, v74, v76
    v_fma_f32 v77, v47, v74, v77
    v_cvt_pk_bf16_f32 v46, v76, v77
    buffer_store_dword v46, v2, s[12:15], s61 offen offset:512 sc1
    v_sub_f32 v48, v48, v65
    v_sub_f32 v49, v49, v65
    v_cvt_pk_bf16_f32 v49, v48, v49
    v_lshlrev_b32 v48, 16, v49
    v_and_b32 v49, 0xffff0000, v49
    v_mul_f32 v76, v48, v74
    v_mul_f32 v77, v49, v74
    v_fma_f32 v48, -v76, v71, v48
    v_fma_f32 v49, -v77, v71, v49
    v_fma_f32 v76, v48, v74, v76
    v_fma_f32 v77, v49, v74, v77
    v_cvt_pk_bf16_f32 v48, v76, v77
    buffer_store_dword v48, v2, s[12:15], s61 offen offset:768 sc1
    v_sub_f32 v50, v50, v65
    v_sub_f32 v51, v51, v65
    v_cvt_pk_bf16_f32 v51, v50, v51
    v_lshlrev_b32 v50, 16, v51
    v_and_b32 v51, 0xffff0000, v51
    v_mul_f32 v76, v50, v74
    v_mul_f32 v77, v51, v74
    v_fma_f32 v50, -v76, v71, v50
    v_fma_f32 v51, -v77, v71, v51
    v_fma_f32 v76, v50, v74, v76
    v_fma_f32 v77, v51, v74, v77
    v_cvt_pk_bf16_f32 v50, v76, v77
    buffer_store_dword v50, v2, s[12:15], s61 offen offset:1024 sc1
    v_mul_f32 v72, s63, v72
    v_cvt_pk_bf16_f32 v72, v72, v72
    v_lshlrev_b32 v72, 16, v72
    v_add_f32 v72, 0x3727c5ac, v72
    v_cvt_pk_bf16_f32 v72, v72, v72
    v_lshlrev_b32 v72, 16, v72
    v_sqrt_f32 v72, v72
    s_nop 0
    v_cvt_pk_bf16_f32 v72, v72, v72
    v_lshlrev_b32 v72, 16, v72
    v_rcp_f32 v75, v72
    v_cvt_pk_bf16_f32 v66, v66, v66
    v_lshlrev_b32 v66, 16, v66
    s_add_u32 s62, s62, 4194304
    v_sub_f32 v52, v52, v66
    v_sub_f32 v53, v53, v66
    v_cvt_pk_bf16_f32 v53, v52, v53
    v_lshlrev_b32 v52, 16, v53
    v_and_b32 v53, 0xffff0000, v53
    v_mul_f32 v76, v52, v75
    v_mul_f32 v77, v53, v75
    v_fma_f32 v52, -v76, v72, v52
    v_fma_f32 v53, -v77, v72, v53
    v_fma_f32 v76, v52, v75, v76
    v_fma_f32 v77, v53, v75, v77
    v_cvt_pk_bf16_f32 v52, v76, v77
    buffer_store_dword v52, v2, s[12:15], s62 offen offset:0 sc1
    v_sub_f32 v54, v54, v66
    v_sub_f32 v55, v55, v66
    v_cvt_pk_bf16_f32 v55, v54, v55
    v_lshlrev_b32 v54, 16, v55
    v_and_b32 v55, 0xffff0000, v55
    v_mul_f32 v76, v54, v75
    v_mul_f32 v77, v55, v75
    v_fma_f32 v54, -v76, v72, v54
    v_fma_f32 v55, -v77, v72, v55
    v_fma_f32 v76, v54, v75, v76
    v_fma_f32 v77, v55, v75, v77
    v_cvt_pk_bf16_f32 v54, v76, v77
    buffer_store_dword v54, v2, s[12:15], s62 offen offset:256 sc1
    v_sub_f32 v56, v56, v66
    v_sub_f32 v57, v57, v66
    v_cvt_pk_bf16_f32 v57, v56, v57
    v_lshlrev_b32 v56, 16, v57
    v_and_b32 v57, 0xffff0000, v57
    v_mul_f32 v76, v56, v75
    v_mul_f32 v77, v57, v75
    v_fma_f32 v56, -v76, v72, v56
    v_fma_f32 v57, -v77, v72, v57
    v_fma_f32 v76, v56, v75, v76
    v_fma_f32 v77, v57, v75, v77
    v_cvt_pk_bf16_f32 v56, v76, v77
    buffer_store_dword v56, v2, s[12:15], s62 offen offset:512 sc1
    v_sub_f32 v58, v58, v66
    v_sub_f32 v59, v59, v66
    v_cvt_pk_bf16_f32 v59, v58, v59
    v_lshlrev_b32 v58, 16, v59
    v_and_b32 v59, 0xffff0000, v59
    v_mul_f32 v76, v58, v75
    v_mul_f32 v77, v59, v75
    v_fma_f32 v58, -v76, v72, v58
    v_fma_f32 v59, -v77, v72, v59
    v_fma_f32 v76, v58, v75, v76
    v_fma_f32 v77, v59, v75, v77
    v_cvt_pk_bf16_f32 v58, v76, v77
    buffer_store_dword v58, v2, s[12:15], s62 offen offset:768 sc1
    v_sub_f32 v60, v60, v66
    v_sub_f32 v61, v61, v66
    v_cvt_pk_bf16_f32 v61, v60, v61
    v_lshlrev_b32 v60, 16, v61
    v_and_b32 v61, 0xffff0000, v61
    v_mul_f32 v76, v60, v75
    v_mul_f32 v77, v61, v75
    v_fma_f32 v60, -v76, v72, v60
    v_fma_f32 v61, -v77, v72, v61
    v_fma_f32 v76, v60, v75, v76
    v_fma_f32 v77, v61, v75, v77
    v_cvt_pk_bf16_f32 v60, v76, v77
    buffer_store_dword v60, v2, s[12:15], s62 offen offset:1024 sc1
    s_waitcnt vmcnt(0)
    s_barrier
    s_cmp_eq_u32 s10, 0
    s_cbranch_scc0 W_na
    v_mov_b32 v20, 1
    v_mov_b32 v21, 192
    s_mov_b64 exec, 1
    global_atomic_add v21, v20, s[6:7]
    s_mov_b64 exec, -1
W_na:
    v_lshrrev_b32 v16, 5, v0
    v_bfe_u32 v17, v0, 2, 2
    v_bfe_u32 v18, v0, 4, 1
    v_and_b32 v19, 3, v0
    v_lshlrev_b32 v20, 6, v17
    v_lshl_add_u32 v20, v18, 5, v20
    v_lshl_add_u32 v20, v19, 3, v20
    v_add_u32 v20, s28, v20
    v_lshl_add_u32 v3, v16, 9, v20
    v_lshl_add_u32 v4, v16, 8, v20
    v_lshrrev_b32 v16, 2, v0
    v_lshlrev_b32 v19, 4, v19
    v_lshl_add_u32 v5, v16, 13, v19
    v_mul_u32_u24 v6, 3456, v16
    v_add_u32 v6, v6, v19
    v_mul_u32_u24 v7, 1280, v16
    v_add_u32 v7, v7, v19
    v_lshrrev_b32 v16, 3, v0
    s_lshl_b32 s60, s10, 3
    v_add_u32 v16, s60, v16
    v_bfe_u32 v17, v16, 1, 3
    v_and_b32 v18, 7, v0
    v_xor_b32 v17, v17, v18
    v_mul_u32_u24 v16, 1280, v16
    v_lshl_add_u32 v8, v17, 4, v16
    v_and_b32 v16, 31, v0
    v_bfe_u32 v17, v0, 1, 3
    v_lshrrev_b32 v18, 5, v0
    v_xor_b32 v17, v17, v18
    v_lshlrev_b32 v17, 4, v17
    v_lshl_add_u32 v10, v16, 7, v17
    v_xor_b32 v11, 32, v10
    v_xor_b32 v12, 64, v10
    v_xor_b32 v13, 96, v10
    s_mov_b32 s39, 3216550459
    s_cmp_eq_u32 s10, 0
    s_cselect_b64 s[54:55], 1, 0
    s_cmp_lt_u32 s50, 2
    s_cbranch_scc0 W_main
    s_mul_i32 s8, s52, 37
    s_lshr_b32 s8, s8, 8
    s_mul_i32 s60, s8, 7
    s_sub_u32 s60, s52, s60
    s_lshl_b32 s60, s60, 2
    s_add_u32 s60, s60, s10
    s_lshl_b32 s37, s60, 1
    s_mul_i32 s34, s8, 0
    s_lshl_b32 s60, s37, 11
    s_add_u32 s34, s34, s60
    s_add_u32 s34, s34, 67108864
    s_mov_b32 s35, s34
    s_mov_b64 s[92:93], s[12:13]
    s_mov_b32 s94, 0
    s_mov_b32 s95, 0x00020000
    s_cmp_ge_u32 s37, 54
    s_cselect_b32 s37, 0, s37
    s_cselect_b32 s36, 0, s14
    s_lshl_b32 s38, s37, 6
    s_cmp_eq_u32 s8, 0
    s_cselect_b32 s24, 8, 7
    s_cmp_eq_u32 s8, 9
    s_cbranch_scc1 H_f1e
    s_add_u32 m0, s28, 0
    s_add_u32 s61, s38, 0
    buffer_load_dwordx4 v6, s[88:91], s61 offen  lds
    s_add_u32 m0, s28, 1024
    s_add_u32 s61, s38, 64
    buffer_load_dwordx4 v6, s[88:91], s61 offen  lds
    s_add_u32 m0, s28, 2048
    s_add_u32 s61, s38, 55296
    buffer_load_dwordx4 v6, s[88:91], s61 offen  lds
    s_add_u32 m0, s28, 3072
    s_add_u32 s61, s38, 55360
    buffer_load_dwordx4 v6, s[88:91], s61 offen  lds
    s_add_u32 m0, s28, 4096
    s_add_u32 s61, s38, 110592
    buffer_load_dwordx4 v6, s[88:91], s61 offen  lds
    s_add_u32 m0, s28, 5120
    s_add_u32 s61, s38, 110656
    buffer_load_dwordx4 v6, s[88:91], s61 offen  lds
    s_add_u32 m0, s28, 6144
    s_add_u32 s61, s38, 165888
    buffer_load_dwordx4 v6, s[88:91], s61 offen  lds
    s_add_u32 m0, s28, 7168
    s_add_u32 s61, s38, 165952
    buffer_load_dwordx4 v6, s[88:91], s61 offen  lds
    s_add_u32 m0, s28, 8192
    s_add_u32 s61, s38, 221184
    buffer_load_dwordx4 v6, s[88:91], s61 offen  lds
    s_add_u32 m0, s28, 9216
    s_add_u32 s61, s38, 221248
    buffer_load_dwordx4 v6, s[88:91], s61 offen  lds
    s_add_u32 m0, s28, 10240
    s_add_u32 s61, s38, 276480
    buffer_load_dwordx4 v6, s[88:91], s61 offen  lds
    s_add_u32 m0, s28, 11264
    s_add_u32 s61, s38, 276544
    buffer_load_dwordx4 v6, s[88:91], s61 offen  lds
    s_add_u32 m0, s28, 12288
    s_add_u32 s61, s38, 331776
    buffer_load_dwordx4 v6, s[88:91], s61 offen  lds
    s_add_u32 m0, s28, 13312
    s_add_u32 s61, s38, 331840
    buffer_load_dwordx4 v6, s[88:91], s61 offen  lds
    s_add_u32 m0, s28, 14336
    s_add_u32 s61, s38, 387072
    buffer_load_dwordx4 v6, s[88:91], s61 offen  lds
    s_add_u32 m0, s28, 15360
    s_add_u32 s61, s38, 387136
    buffer_load_dwordx4 v6, s[88:91], s61 offen  lds
    s_add_u32 m0, s28, 16384
    s_add_u32 s61, s38, 442368
    buffer_load_dwordx4 v6, s[88:91], s61 offen  lds
    s_add_u32 m0, s28, 17408
    s_add_u32 s61, s38, 442432
    buffer_load_dwordx4 v6, s[88:91], s61 offen  lds
    s_add_u32 m0, s28, 18432
    s_add_u32 s61, s38, 497664
    buffer_load_dwordx4 v6, s[88:91], s61 offen  lds
    s_add_u32 m0, s28, 19456
    s_add_u32 s61, s38, 497728
    buffer_load_dwordx4 v6, s[88:91], s61 offen  lds
    s_waitcnt vmcnt(16)
    ds_read_b64_tr_b16 a[0:1], v3 offset:0
    ds_read_b64_tr_b16 a[2:3], v3 offset:256
    ds_read_b64_tr_b16 a[4:5], v3 offset:1024
    ds_read_b64_tr_b16 a[6:7], v3 offset:1280
    ds_read_b64_tr_b16 a[8:9], v3 offset:2048
    ds_read_b64_tr_b16 a[10:11], v3 offset:2304
    ds_read_b64_tr_b16 a[12:13], v3 offset:3072
    ds_read_b64_tr_b16 a[14:15], v3 offset:3328
    s_waitcnt lgkmcnt(0)
    s_add_u32 m0, s28, 0
    s_add_u32 s61, s38, 552960
    buffer_load_dwordx4 v6, s[88:91], s61 offen  lds
    s_add_u32 m0, s28, 1024
    s_add_u32 s61, s38, 553024
    buffer_load_dwordx4 v6, s[88:91], s61 offen  lds
    s_add_u32 m0, s28, 2048
    s_add_u32 s61, s38, 608256
    buffer_load_dwordx4 v6, s[88:91], s61 offen  lds
    s_add_u32 m0, s28, 3072
    s_add_u32 s61, s38, 608320
    buffer_load_dwordx4 v6, s[88:91], s61 offen  lds
    s_waitcnt vmcnt(16)
    ds_read_b64_tr_b16 a[16:17], v3 offset:4096
    ds_read_b64_tr_b16 a[18:19], v3 offset:4352
    ds_read_b64_tr_b16 a[20:21], v3 offset:5120
    ds_read_b64_tr_b16 a[22:23], v3 offset:5376
    ds_read_b64_tr_b16 a[24:25], v3 offset:6144
    ds_read_b64_tr_b16 a[26:27], v3 offset:6400
    ds_read_b64_tr_b16 a[28:29], v3 offset:7168
    ds_read_b64_tr_b16 a[30:31], v3 offset:7424
    s_waitcnt lgkmcnt(0)
    s_add_u32 m0, s28, 4096
    s_add_u32 s61, s38, 663552
    buffer_load_dwordx4 v6, s[88:91], s61 offen  lds
    s_add_u32 m0, s28, 5120
    s_add_u32 s61, s38, 663616
    buffer_load_dwordx4 v6, s[88:91], s61 offen  lds
    s_add_u32 m0, s28, 6144
    s_add_u32 s61, s38, 718848
    buffer_load_dwordx4 v6, s[88:91], s61 offen  lds
    s_add_u32 m0, s28, 7168
    s_add_u32 s61, s38, 718912
    buffer_load_dwordx4 v6, s[88:91], s61 offen  lds
    s_waitcnt vmcnt(16)
    ds_read_b64_tr_b16 a[32:33], v3 offset:8192
    ds_read_b64_tr_b16 a[34:35], v3 offset:8448
    ds_read_b64_tr_b16 a[36:37], v3 offset:9216
    ds_read_b64_tr_b16 a[38:39], v3 offset:9472
    ds_read_b64_tr_b16 a[40:41], v3 offset:10240
    ds_read_b64_tr_b16 a[42:43], v3 offset:10496
    ds_read_b64_tr_b16 a[44:45], v3 offset:11264
    ds_read_b64_tr_b16 a[46:47], v3 offset:11520
    s_waitcnt lgkmcnt(0)
    s_add_u32 m0, s28, 8192
    s_add_u32 s61, s38, 774144
    buffer_load_dwordx4 v6, s[88:91], s61 offen  lds
    s_add_u32 m0, s28, 9216
    s_add_u32 s61, s38, 774208
    buffer_load_dwordx4 v6, s[88:91], s61 offen  lds
    s_add_u32 m0, s28, 10240
    s_add_u32 s61, s38, 829440
    buffer_load_dwordx4 v6, s[88:91], s61 offen  lds
    s_add_u32 m0, s28, 11264
    s_add_u32 s61, s38, 829504
    buffer_load_dwordx4 v6, s[88:91], s61 offen  lds
    s_waitcnt vmcnt(16)
    ds_read_b64_tr_b16 a[48:49], v3 offset:12288
    ds_read_b64_tr_b16 a[50:51], v3 offset:12544
    ds_read_b64_tr_b16 a[52:53], v3 offset:13312
    ds_read_b64_tr_b16 a[54:55], v3 offset:13568
    ds_read_b64_tr_b16 a[56:57], v3 offset:14336
    ds_read_b64_tr_b16 a[58:59], v3 offset:14592
    ds_read_b64_tr_b16 a[60:61], v3 offset:15360
    ds_read_b64_tr_b16 a[62:63], v3 offset:15616
    s_waitcnt lgkmcnt(0)
    s_add_u32 m0, s28, 12288
    s_add_u32 s61, s38, 884736
    buffer_load_dwordx4 v6, s[88:91], s61 offen  lds
    s_add_u32 m0, s28, 13312
    s_add_u32 s61, s38, 884800
    buffer_load_dwordx4 v6, s[88:91], s61 offen  lds
    s_add_u32 m0, s28, 14336
    s_add_u32 s61, s38, 940032
    buffer_load_dwordx4 v6, s[88:91], s61 offen  lds
    s_add_u32 m0, s28, 15360
    s_add_u32 s61, s38, 940096
    buffer_load_dwordx4 v6, s[88:91], s61 offen  lds
    s_waitcnt vmcnt(16)
    ds_read_b64_tr_b16 a[64:65], v3 offset:16384
    ds_read_b64_tr_b16 a[66:67], v3 offset:16640
    ds_read_b64_tr_b16 a[68:69], v3 offset:17408
    ds_read_b64_tr_b16 a[70:71], v3 offset:17664
    ds_read_b64_tr_b16 a[72:73], v3 offset:18432
    ds_read_b64_tr_b16 a[74:75], v3 offset:18688
    ds_read_b64_tr_b16 a[76:77], v3 offset:19456
    ds_read_b64_tr_b16 a[78:79], v3 offset:19712
    s_waitcnt lgkmcnt(0)
    s_add_u32 m0, s28, 16384
    s_add_u32 s61, s38, 995328
    buffer_load_dwordx4 v6, s[88:91], s61 offen  lds
    s_add_u32 m0, s28, 17408
    s_add_u32 s61, s38, 995392
    buffer_load_dwordx4 v6, s[88:91], s61 offen  lds
    s_add_u32 m0, s28, 18432
    s_add_u32 s61, s38, 1050624
    buffer_load_dwordx4 v6, s[88:91], s61 offen  lds
    s_add_u32 m0, s28, 19456
    s_add_u32 s61, s38, 1050688
    buffer_load_dwordx4 v6, s[88:91], s61 offen  lds
    s_waitcnt vmcnt(16)
    ds_read_b64_tr_b16 a[80:81], v3 offset:0
    ds_read_b64_tr_b16 a[82:83], v3 offset:256
    ds_read_b64_tr_b16 a[84:85], v3 offset:1024
    ds_read_b64_tr_b16 a[86:87], v3 offset:1280
    ds_read_b64_tr_b16 a[88:89], v3 offset:2048
    ds_read_b64_tr_b16 a[90:91], v3 offset:2304
    ds_read_b64_tr_b16 a[92:93], v3 offset:3072
    ds_read_b64_tr_b16 a[94:95], v3 offset:3328
    s_waitcnt lgkmcnt(0)
    s_add_u32 m0, s28, 0
    s_add_u32 s61, s38, 1105920
    buffer_load_dwordx4 v6, s[88:91], s61 offen  lds
    s_add_u32 m0, s28, 1024
    s_add_u32 s61, s38, 1105984
    buffer_load_dwordx4 v6, s[88:91], s61 offen  lds
    s_add_u32 m0, s28, 2048
    s_add_u32 s61, s38, 1161216
    buffer_load_dwordx4 v6, s[88:91], s61 offen  lds
    s_add_u32 m0, s28, 3072
    s_add_u32 s61, s38, 1161280
    buffer_load_dwordx4 v6, s[88:91], s61 offen  lds
    s_waitcnt vmcnt(16)
    ds_read_b64_tr_b16 a[96:97], v3 offset:4096
    ds_read_b64_tr_b16 a[98:99], v3 offset:4352
    ds_read_b64_tr_b16 a[100:101], v3 offset:5120
    ds_read_b64_tr_b16 a[102:103], v3 offset:5376
    ds_read_b64_tr_b16 a[104:105], v3 offset:6144
    ds_read_b64_tr_b16 a[106:107], v3 offset:6400
    ds_read_b64_tr_b16 a[108:109], v3 offset:7168
    ds_read_b64_tr_b16 a[110:111], v3 offset:7424
    s_waitcnt lgkmcnt(0)
    s_add_u32 m0, s28, 4096
    s_add_u32 s61, s38, 1216512
    buffer_load_dwordx4 v6, s[88:91], s61 offen  lds
    s_add_u32 m0, s28, 5120
    s_add_u32 s61, s38, 1216576
    buffer_load_dwordx4 v6, s[88:91], s61 offen  lds
    s_add_u32 m0, s28, 6144
    s_add_u32 s61, s38, 1271808
    buffer_load_dwordx4 v6, s[88:91], s61 offen  lds
    s_add_u32 m0, s28, 7168
    s_add_u32 s61, s38, 1271872
    buffer_load_dwordx4 v6, s[88:91], s61 offen  lds
    s_waitcnt vmcnt(16)
    ds_read_b64_tr_b16 a[112:113], v3 offset:8192
    ds_read_b64_tr_b16 a[114:115], v3 offset:8448
    ds_read_b64_tr_b16 a[116:117], v3 offset:9216
    ds_read_b64_tr_b16 a[118:119], v3 offset:9472
    ds_read_b64_tr_b16 a[120:121], v3 offset:10240
    ds_read_b64_tr_b16 a[122:123], v3 offset:10496
    ds_read_b64_tr_b16 a[124:125], v3 offset:11264
    ds_read_b64_tr_b16 a[126:127], v3 offset:11520
    s_waitcnt lgkmcnt(0)
    s_add_u32 m0, s28, 8192
    s_add_u32 s61, s38, 1327104
    buffer_load_dwordx4 v6, s[88:91], s61 offen  lds
    s_add_u32 m0, s28, 9216
    s_add_u32 s61, s38, 1327168
    buffer_load_dwordx4 v6, s[88:91], s61 offen  lds
    s_add_u32 m0, s28, 10240
    s_add_u32 s61, s38, 1382400
    buffer_load_dwordx4 v6, s[88:91], s61 offen  lds
    s_add_u32 m0, s28, 11264
    s_add_u32 s61, s38, 1382464
    buffer_load_dwordx4 v6, s[88:91], s61 offen  lds
    s_waitcnt vmcnt(16)
    ds_read_b64_tr_b16 a[128:129], v3 offset:12288
    ds_read_b64_tr_b16 a[130:131], v3 offset:12544
    ds_read_b64_tr_b16 a[132:133], v3 offset:13312
    ds_read_b64_tr_b16 a[134:135], v3 offset:13568
    ds_read_b64_tr_b16 a[136:137], v3 offset:14336
    ds_read_b64_tr_b16 a[138:139], v3 offset:14592
    ds_read_b64_tr_b16 a[140:141], v3 offset:15360
    ds_read_b64_tr_b16 a[142:143], v3 offset:15616
    s_waitcnt lgkmcnt(0)
    s_add_u32 m0, s28, 12288
    s_add_u32 s61, s38, 1437696
    buffer_load_dwordx4 v6, s[88:91], s61 offen  lds
    s_add_u32 m0, s28, 13312
    s_add_u32 s61, s38, 1437760
    buffer_load_dwordx4 v6, s[88:91], s61 offen  lds
    s_add_u32 m0, s28, 14336
    s_add_u32 s61, s38, 1492992
    buffer_load_dwordx4 v6, s[88:91], s61 offen  lds
    s_add_u32 m0, s28, 15360
    s_add_u32 s61, s38, 1493056
    buffer_load_dwordx4 v6, s[88:91], s61 offen  lds
    s_waitcnt vmcnt(16)
    ds_read_b64_tr_b16 a[144:145], v3 offset:16384
    ds_read_b64_tr_b16 a[146:147], v3 offset:16640
    ds_read_b64_tr_b16 a[148:149], v3 offset:17408
    ds_read_b64_tr_b16 a[150:151], v3 offset:17664
    ds_read_b64_tr_b16 a[152:153], v3 offset:18432
    ds_read_b64_tr_b16 a[154:155], v3 offset:18688
    ds_read_b64_tr_b16 a[156:157], v3 offset:19456
    ds_read_b64_tr_b16 a[158:159], v3 offset:19712
    s_waitcnt lgkmcnt(0)
    s_add_u32 m0, s28, 16384
    s_add_u32 s61, s38, 1548288
    buffer_load_dwordx4 v6, s[88:91], s61 offen  lds
    s_add_u32 m0, s28, 17408
    s_add_u32 s61, s38, 1548352
    buffer_load_dwordx4 v6, s[88:91], s61 offen  lds
    s_add_u32 m0, s28, 18432
    s_add_u32 s61, s38, 1603584
    buffer_load_dwordx4 v6, s[88:91], s61 offen  lds
    s_add_u32 m0, s28, 19456
    s_add_u32 s61, s38, 1603648
    buffer_load_dwordx4 v6, s[88:91], s61 offen  lds
    s_waitcnt vmcnt(16)
    ds_read_b64_tr_b16 a[160:161], v3 offset:0
    ds_read_b64_tr_b16 a[162:163], v3 offset:256
    ds_read_b64_tr_b16 a[164:165], v3 offset:1024
    ds_read_b64_tr_b16 a[166:167], v3 offset:1280
    ds_read_b64_tr_b16 a[168:169], v3 offset:2048
    ds_read_b64_tr_b16 a[170:171], v3 offset:2304
    ds_read_b64_tr_b16 a[172:173], v3 offset:3072
    ds_read_b64_tr_b16 a[174:175], v3 offset:3328
    s_waitcnt lgkmcnt(0)
    s_add_u32 m0, s28, 0
    s_add_u32 s61, s38, 1658880
    buffer_load_dwordx4 v6, s[88:91], s61 offen  lds
    s_add_u32 m0, s28, 1024
    s_add_u32 s61, s38, 1658944
    buffer_load_dwordx4 v6, s[88:91], s61 offen  lds
    s_add_u32 m0, s28, 2048
    s_add_u32 s61, s38, 1714176
    buffer_load_dwordx4 v6, s[88:91], s61 offen  lds
    s_add_u32 m0, s28, 3072
    s_add_u32 s61, s38, 1714240
    buffer_load_dwordx4 v6, s[88:91], s61 offen  lds
    s_waitcnt vmcnt(16)
    ds_read_b64_tr_b16 a[176:177], v3 offset:4096
    ds_read_b64_tr_b16 a[178:179], v3 offset:4352
    ds_read_b64_tr_b16 a[180:181], v3 offset:5120
    ds_read_b64_tr_b16 a[182:183], v3 offset:5376
    ds_read_b64_tr_b16 a[184:185], v3 offset:6144
    ds_read_b64_tr_b16 a[186:187], v3 offset:6400
    ds_read_b64_tr_b16 a[188:189], v3 offset:7168
    ds_read_b64_tr_b16 a[190:191], v3 offset:7424
    s_waitcnt lgkmcnt(0)
    s_add_u32 m0, s28, 4096
    s_add_u32 s61, s38, 1769472
    buffer_load_dwordx4 v6, s[88:91], s61 offen  lds
    s_add_u32 m0, s28, 5120
    s_add_u32 s61, s38, 1769536
    buffer_load_dwordx4 v6, s[88:91], s61 offen  lds
    s_add_u32 m0, s28, 6144
    s_add_u32 s61, s38, 1824768
    buffer_load_dwordx4 v6, s[88:91], s61 offen  lds
    s_add_u32 m0, s28, 7168
    s_add_u32 s61, s38, 1824832
    buffer_load_dwordx4 v6, s[88:91], s61 offen  lds
    s_waitcnt vmcnt(16)
    ds_read_b64_tr_b16 a[192:193], v3 offset:8192
    ds_read_b64_tr_b16 a[194:195], v3 offset:8448
    ds_read_b64_tr_b16 a[196:197], v3 offset:9216
    ds_read_b64_tr_b16 a[198:199], v3 offset:9472
    ds_read_b64_tr_b16 a[200:201], v3 offset:10240
    ds_read_b64_tr_b16 a[202:203], v3 offset:10496
    ds_read_b64_tr_b16 a[204:205], v3 offset:11264
    ds_read_b64_tr_b16 a[206:207], v3 offset:11520
    s_waitcnt lgkmcnt(0)
    s_add_u32 m0, s28, 8192
    s_add_u32 s61, s38, 1880064
    buffer_load_dwordx4 v6, s[88:91], s61 offen  lds
    s_add_u32 m0, s28, 9216
    s_add_u32 s61, s38, 1880128
    buffer_load_dwordx4 v6, s[88:91], s61 offen  lds
    s_add_u32 m0, s28, 10240
    s_add_u32 s61, s38, 1935360
    buffer_load_dwordx4 v6, s[88:91], s61 offen  lds
    s_add_u32 m0, s28, 11264
    s_add_u32 s61, s38, 1935424
    buffer_load_dwordx4 v6, s[88:91], s61 offen  lds
    s_waitcnt vmcnt(16)
    ds_read_b64_tr_b16 a[208:209], v3 offset:12288
    ds_read_b64_tr_b16 a[210:211], v3 offset:12544
    ds_read_b64_tr_b16 a[212:213], v3 offset:13312
    ds_read_b64_tr_b16 a[214:215], v3 offset:13568
    ds_read_b64_tr_b16 a[216:217], v3 offset:14336
    ds_read_b64_tr_b16 a[218:219], v3 offset:14592
    ds_read_b64_tr_b16 a[220:221], v3 offset:15360
    ds_read_b64_tr_b16 a[222:223], v3 offset:15616
    s_waitcnt lgkmcnt(0)
    s_add_u32 m0, s28, 12288
    s_add_u32 s61, s38, 1990656
    buffer_load_dwordx4 v6, s[88:91], s61 offen  lds
    s_add_u32 m0, s28, 13312
    s_add_u32 s61, s38, 1990720
    buffer_load_dwordx4 v6, s[88:91], s61 offen  lds
    s_add_u32 m0, s28, 14336
    s_add_u32 s61, s38, 2045952
    buffer_load_dwordx4 v6, s[88:91], s61 offen  lds
    s_add_u32 m0, s28, 15360
    s_add_u32 s61, s38, 2046016
    buffer_load_dwordx4 v6, s[88:91], s61 offen  lds
    s_waitcnt vmcnt(16)
    ds_read_b64_tr_b16 a[224:225], v3 offset:16384
    ds_read_b64_tr_b16 a[226:227], v3 offset:16640
    ds_read_b64_tr_b16 a[228:229], v3 offset:17408
    ds_read_b64_tr_b16 a[230:231], v3 offset:17664
    ds_read_b64_tr_b16 a[232:233], v3 offset:18432
    ds_read_b64_tr_b16 a[234:235], v3 offset:18688
    ds_read_b64_tr_b16 a[236:237], v3 offset:19456
    ds_read_b64_tr_b16 a[238:239], v3 offset:19712
    s_waitcnt lgkmcnt(0)
    s_add_u32 m0, s28, 16384
    s_add_u32 s61, s38, 2101248
    buffer_load_dwordx4 v6, s[88:91], s61 offen  lds
    s_add_u32 m0, s28, 17408
    s_add_u32 s61, s38, 2101312
    buffer_load_dwordx4 v6, s[88:91], s61 offen  lds
    s_add_u32 m0, s28, 18432
    s_add_u32 s61, s38, 2156544
    buffer_load_dwordx4 v6, s[88:91], s61 offen  lds
    s_add_u32 m0, s28, 19456
    s_add_u32 s61, s38, 2156608
    buffer_load_dwordx4 v6, s[88:91], s61 offen  lds
    s_waitcnt vmcnt(16)
    ds_read_b64_tr_b16 a[240:241], v3 offset:0
    ds_read_b64_tr_b16 a[242:243], v3 offset:256
    ds_read_b64_tr_b16 a[244:245], v3 offset:1024
    ds_read_b64_tr_b16 a[246:247], v3 offset:1280
    ds_read_b64_tr_b16 a[248:249], v3 offset:2048
    ds_read_b64_tr_b16 a[250:251], v3 offset:2304
    ds_read_b64_tr_b16 a[252:253], v3 offset:3072
    ds_read_b64_tr_b16 a[254:255], v3 offset:3328
    s_waitcnt lgkmcnt(0)
    s_waitcnt vmcnt(12)
    ds_read_b64_tr_b16 v[192:193], v3 offset:4096
    ds_read_b64_tr_b16 v[194:195], v3 offset:4352
    ds_read_b64_tr_b16 v[196:197], v3 offset:5120
    ds_read_b64_tr_b16 v[198:199], v3 offset:5376
    ds_read_b64_tr_b16 v[200:201], v3 offset:6144
    ds_read_b64_tr_b16 v[202:203], v3 offset:6400
    ds_read_b64_tr_b16 v[204:205], v3 offset:7168
    ds_read_b64_tr_b16 v[206:207], v3 offset:7424
    s_waitcnt lgkmcnt(0)
    s_waitcnt vmcnt(8)
    ds_read_b64_tr_b16 v[208:209], v3 offset:8192
    ds_read_b64_tr_b16 v[210:211], v3 offset:8448
    ds_read_b64_tr_b16 v[212:213], v3 offset:9216
    ds_read_b64_tr_b16 v[214:215], v3 offset:9472
    ds_read_b64_tr_b16 v[216:217], v3 offset:10240
    ds_read_b64_tr_b16 v[218:219], v3 offset:10496
    ds_read_b64_tr_b16 v[220:221], v3 offset:11264
    ds_read_b64_tr_b16 v[222:223], v3 offset:11520
    s_waitcnt lgkmcnt(0)
    s_waitcnt vmcnt(4)
    ds_read_b64_tr_b16 v[224:225], v3 offset:12288
    ds_read_b64_tr_b16 v[226:227], v3 offset:12544
    ds_read_b64_tr_b16 v[228:229], v3 offset:13312
    ds_read_b64_tr_b16 v[230:231], v3 offset:13568
    ds_read_b64_tr_b16 v[232:233], v3 offset:14336
    ds_read_b64_tr_b16 v[234:235], v3 offset:14592
    ds_read_b64_tr_b16 v[236:237], v3 offset:15360
    ds_read_b64_tr_b16 v[238:239], v3 offset:15616
    s_waitcnt lgkmcnt(0)
    s_waitcnt vmcnt(0)
    ds_read_b64_tr_b16 v[240:241], v3 offset:16384
    ds_read_b64_tr_b16 v[242:243], v3 offset:16640
    ds_read_b64_tr_b16 v[244:245], v3 offset:17408
    ds_read_b64_tr_b16 v[246:247], v3 offset:17664
    ds_read_b64_tr_b16 v[248:249], v3 offset:18432
    ds_read_b64_tr_b16 v[250:251], v3 offset:18688
    ds_read_b64_tr_b16 v[252:253], v3 offset:19456
    ds_read_b64_tr_b16 v[254:255], v3 offset:19712
    s_waitcnt lgkmcnt(0)
    s_mov_b32 s22, 262144
    v_mov_b32 v21, 192
H_wi:
    global_load_dword v20, v21, s[6:7] sc1
    s_sub_u32 s22, s22, 1
    s_cbranch_scc1 W_fail
    s_waitcnt vmcnt(0)
    v_readfirstlane_b32 s21, v20
    s_and_b32 s61, s21, 0x3ff
    s_cmp_lt_u32 s61, 256
    s_cbranch_scc1 H_wi
    s_cmp_gt_i32 s21, 0x3ff
    s_cselect_b32 s21, 8192, 0
    s_mov_b32 s23, s8
    s_mov_b32 s25, 0
    s_mul_i32 s31, s8, 40960
    s_add_u32 s31, s31, 4194304
    s_mov_b32 s32, s29
    s_mov_b32 s33, 40960
    s_add_u32 m0, s32, 0
    s_nop 0
    buffer_load_dwordx4 v8, s[12:15], s31 offen offset:0 lds
    s_add_u32 m0, s32, 3968
    s_nop 0
    buffer_load_dwordx4 v8, s[12:15], s31 offen offset:128 lds
    s_add_u32 m0, s32, 7936
    s_nop 0
    buffer_load_dwordx4 v8, s[12:15], s31 offen offset:256 lds
    s_add_u32 m0, s32, 11904
    s_nop 0
    buffer_load_dwordx4 v8, s[12:15], s31 offen offset:384 lds
    s_add_u32 m0, s32, 15872
    s_nop 0
    buffer_load_dwordx4 v8, s[12:15], s31 offen offset:512 lds
    s_add_u32 m0, s32, 19840
    s_nop 0
    buffer_load_dwordx4 v8, s[12:15], s31 offen offset:640 lds
    s_add_u32 m0, s32, 23808
    s_nop 0
    buffer_load_dwordx4 v8, s[12:15], s31 offen offset:768 lds
    s_add_u32 m0, s32, 27776
    s_nop 0
    buffer_load_dwordx4 v8, s[12:15], s31 offen offset:896 lds
    s_add_u32 m0, s32, 31744
    s_nop 0
    buffer_load_dwordx4 v8, s[12:15], s31 offen offset:1024 lds
    s_add_u32 m0, s32, 35712
    s_nop 0
    buffer_load_dwordx4 v8, s[12:15], s31 offen offset:1152 lds
    s_waitcnt vmcnt(0)
H_f1:
    s_barrier
    ds_read_b128 v[16:19], v10 offset:0
    ds_read_b128 v[20:23], v11 offset:0
    ds_read_b128 v[24:27], v12 offset:0
    ds_read_b128 v[28:31], v13 offset:0
    ds_read_b128 v[32:35], v10 offset:4096
    s_add_u32 s31, s31, 368640
    s_add_u32 s32, s32, s33
    s_min_u32 s31, s31, 6774784
    s_waitcnt lgkmcnt(4)
    v_mfma_f32_32x32x16_bf16 v[40:55], a[0:3], v[16:19], 0
    ds_read_b128 v[36:39], v11 offset:4096
    v_exp_f32 v120, v88
    v_exp_f32 v121, v89
    v_exp_f32 v122, v90
    v_mfma_f32_32x32x16_bf16 v[56:71], a[4:7], v[16:19], 0
    v_exp_f32 v123, v91
    v_exp_f32 v124, v92
    v_exp_f32 v125, v93
    s_waitcnt lgkmcnt(4)
    v_mfma_f32_32x32x16_bf16 v[40:55], a[8:11], v[20:23], v[40:55]
    ds_read_b128 v[16:19], v12 offset:4096
    v_exp_f32 v126, v94
    v_exp_f32 v127, v95
    v_exp_f32 v128, v96
    v_mfma_f32_32x32x16_bf16 v[56:71], a[12:15], v[20:23], v[56:71]
    v_exp_f32 v129, v97
    v_exp_f32 v130, v98
    v_exp_f32 v131, v99
    s_add_u32 m0, s32, 0
    s_nop 0
    buffer_load_dwordx4 v8, s[12:15], s31 offen offset:0 lds
    s_waitcnt lgkmcnt(4)
    v_mfma_f32_32x32x16_bf16 v[40:55], a[16:19], v[24:27], v[40:55]
    ds_read_b128 v[20:23], v13 offset:4096
    v_exp_f32 v132, v100
    v_exp_f32 v133, v101
    v_exp_f32 v134, v102
    v_mfma_f32_32x32x16_bf16 v[56:71], a[20:23], v[24:27], v[56:71]
    v_exp_f32 v135, v103
    v_exp_f32 v136, v104
    v_exp_f32 v137, v105
    s_waitcnt lgkmcnt(4)
    v_mfma_f32_32x32x16_bf16 v[40:55], a[24:27], v[28:31], v[40:55]
    ds_read_b128 v[24:27], v10 offset:8192
    v_exp_f32 v138, v106
    v_exp_f32 v139, v107
    v_exp_f32 v140, v108
    v_mfma_f32_32x32x16_bf16 v[56:71], a[28:31], v[28:31], v[56:71]
    v_exp_f32 v141, v109
    v_exp_f32 v142, v110
    v_exp_f32 v143, v111
    s_add_u32 m0, s32, 3968
    s_nop 0
    buffer_load_dwordx4 v8, s[12:15], s31 offen offset:128 lds
    s_waitcnt lgkmcnt(4)
    v_mfma_f32_32x32x16_bf16 v[40:55], a[32:35], v[32:35], v[40:55]
    ds_read_b128 v[28:31], v11 offset:8192
    v_exp_f32 v144, v112
    v_exp_f32 v145, v113
    v_exp_f32 v146, v114
    v_mfma_f32_32x32x16_bf16 v[56:71], a[36:39], v[32:35], v[56:71]
    v_exp_f32 v147, v115
    v_exp_f32 v148, v116
    v_exp_f32 v149, v117
    s_waitcnt lgkmcnt(4)
    v_mfma_f32_32x32x16_bf16 v[40:55], a[40:43], v[36:39], v[40:55]
    ds_read_b128 v[32:35], v12 offset:8192
    v_exp_f32 v150, v118
    v_exp_f32 v151, v119
    v_fma_f32 v120, v120, s39, s39
    v_mfma_f32_32x32x16_bf16 v[56:71], a[44:47], v[36:39], v[56:71]
    v_fma_f32 v121, v121, s39, s39
    v_fma_f32 v122, v122, s39, s39
    v_fma_f32 v123, v123, s39, s39
    s_add_u32 m0, s32, 7936
    s_nop 0
    buffer_load_dwordx4 v8, s[12:15], s31 offen offset:256 lds
    s_waitcnt lgkmcnt(4)
    v_mfma_f32_32x32x16_bf16 v[40:55], a[48:51], v[16:19], v[40:55]
    ds_read_b128 v[36:39], v13 offset:8192
    v_fma_f32 v124, v124, s39, s39
    v_fma_f32 v125, v125, s39, s39
    v_fma_f32 v126, v126, s39, s39
    v_mfma_f32_32x32x16_bf16 v[56:71], a[52:55], v[16:19], v[56:71]
    v_fma_f32 v127, v127, s39, s39
    v_fma_f32 v128, v128, s39, s39
    v_fma_f32 v129, v129, s39, s39
    s_waitcnt lgkmcnt(4)
    v_mfma_f32_32x32x16_bf16 v[40:55], a[56:59], v[20:23], v[40:55]
    ds_read_b128 v[16:19], v10 offset:12288
    v_fma_f32 v130, v130, s39, s39
    v_fma_f32 v131, v131, s39, s39
    v_fma_f32 v132, v132, s39, s39
    v_mfma_f32_32x32x16_bf16 v[56:71], a[60:63], v[20:23], v[56:71]
    v_fma_f32 v133, v133, s39, s39
    v_fma_f32 v134, v134, s39, s39
    v_fma_f32 v135, v135, s39, s39
    s_add_u32 m0, s32, 11904
    s_nop 0
    buffer_load_dwordx4 v8, s[12:15], s31 offen offset:384 lds
    s_waitcnt lgkmcnt(4)
    v_mfma_f32_32x32x16_bf16 v[40:55], a[64:67], v[24:27], v[40:55]
    ds_read_b128 v[20:23], v11 offset:12288
    v_fma_f32 v136, v136, s39, s39
    v_fma_f32 v137, v137, s39, s39
    v_fma_f32 v138, v138, s39, s39
    v_mfma_f32_32x32x16_bf16 v[56:71], a[68:71], v[24:27], v[56:71]
    v_fma_f32 v139, v139, s39, s39
    v_fma_f32 v140, v140, s39, s39
    v_fma_f32 v141, v141, s39, s39
    s_waitcnt lgkmcnt(4)
    v_mfma_f32_32x32x16_bf16 v[40:55], a[72:75], v[28:31], v[40:55]
    ds_read_b128 v[24:27], v12 offset:12288
    v_fma_f32 v142, v142, s39, s39
    v_fma_f32 v143, v143, s39, s39
    v_fma_f32 v144, v144, s39, s39
    v_mfma_f32_32x32x16_bf16 v[56:71], a[76:79], v[28:31], v[56:71]
    v_fma_f32 v145, v145, s39, s39
    v_fma_f32 v146, v146, s39, s39
    v_fma_f32 v147, v147, s39, s39
    s_add_u32 m0, s32, 15872
    s_nop 0
    buffer_load_dwordx4 v8, s[12:15], s31 offen offset:512 lds
    s_waitcnt lgkmcnt(4)
    v_mfma_f32_32x32x16_bf16 v[40:55], a[80:83], v[32:35], v[40:55]
    ds_read_b128 v[28:31], v13 offset:12288
    v_fma_f32 v148, v148, s39, s39
    v_fma_f32 v149, v149, s39, s39
    v_fma_f32 v150, v150, s39, s39
    v_mfma_f32_32x32x16_bf16 v[56:71], a[84:87], v[32:35], v[56:71]
    v_fma_f32 v151, v151, s39, s39
    v_rcp_f32 v120, v120
    v_rcp_f32 v121, v121
    s_waitcnt lgkmcnt(4)
    v_mfma_f32_32x32x16_bf16 v[40:55], a[88:91], v[36:39], v[40:55]
    ds_read_b128 v[32:35], v10 offset:16384
    v_rcp_f32 v122, v122
    v_rcp_f32 v123, v123
    v_rcp_f32 v124, v124
    v_mfma_f32_32x32x16_bf16 v[56:71], a[92:95], v[36:39], v[56:71]
    v_rcp_f32 v125, v125
    v_rcp_f32 v126, v126
    v_rcp_f32 v127, v127
    s_add_u32 m0, s32, 19840
    s_nop 0
    buffer_load_dwordx4 v8, s[12:15], s31 offen offset:640 lds
    s_waitcnt lgkmcnt(4)
    v_mfma_f32_32x32x16_bf16 v[40:55], a[96:99], v[16:19], v[40:55]
    ds_read_b128 v[36:39], v11 offset:16384
    v_rcp_f32 v128, v128
    v_rcp_f32 v129, v129
    v_rcp_f32 v130, v130
    v_mfma_f32_32x32x16_bf16 v[56:71], a[100:103], v[16:19], v[56:71]
    v_rcp_f32 v131, v131
    v_rcp_f32 v132, v132
    v_rcp_f32 v133, v133
    s_waitcnt lgkmcnt(4)
    v_mfma_f32_32x32x16_bf16 v[40:55], a[104:107], v[20:23], v[40:55]
    ds_read_b128 v[16:19], v12 offset:16384
    v_rcp_f32 v134, v134
    v_rcp_f32 v135, v135
    v_rcp_f32 v136, v136
    v_mfma_f32_32x32x16_bf16 v[56:71], a[108:111], v[20:23], v[56:71]
    v_rcp_f32 v137, v137
    v_rcp_f32 v138, v138
    v_rcp_f32 v139, v139
    s_add_u32 m0, s32, 23808
    s_nop 0
    buffer_load_dwordx4 v8, s[12:15], s31 offen offset:768 lds
    s_waitcnt lgkmcnt(4)
    v_mfma_f32_32x32x16_bf16 v[40:55], a[112:115], v[24:27], v[40:55]
    ds_read_b128 v[20:23], v13 offset:16384
    v_rcp_f32 v140, v140
    v_rcp_f32 v141, v141
    v_rcp_f32 v142, v142
    v_mfma_f32_32x32x16_bf16 v[56:71], a[116:119], v[24:27], v[56:71]
    v_rcp_f32 v143, v143
    v_rcp_f32 v144, v144
    v_rcp_f32 v145, v145
    s_waitcnt lgkmcnt(4)
    v_mfma_f32_32x32x16_bf16 v[40:55], a[120:123], v[28:31], v[40:55]
    ds_read_b128 v[24:27], v10 offset:20480
    v_rcp_f32 v146, v146
    v_rcp_f32 v147, v147
    v_rcp_f32 v148, v148
    v_mfma_f32_32x32x16_bf16 v[56:71], a[124:127], v[28:31], v[56:71]
    v_rcp_f32 v149, v149
    v_rcp_f32 v150, v150
    v_rcp_f32 v151, v151
    s_add_u32 m0, s32, 27776
    s_nop 0
    buffer_load_dwordx4 v8, s[12:15], s31 offen offset:896 lds
    s_waitcnt lgkmcnt(4)
    v_mfma_f32_32x32x16_bf16 v[40:55], a[128:131], v[32:35], v[40:55]
    ds_read_b128 v[28:31], v11 offset:20480
    v_mul_f32 v120, v120, v88
    v_mul_f32 v121, v121, v89
    v_mul_f32 v122, v122, v90
    v_mfma_f32_32x32x16_bf16 v[56:71], a[132:135], v[32:35], v[56:71]
    v_mul_f32 v123, v123, v91
    v_mul_f32 v124, v124, v92
    v_mul_f32 v125, v125, v93
    s_waitcnt lgkmcnt(4)
    v_mfma_f32_32x32x16_bf16 v[40:55], a[136:139], v[36:39], v[40:55]
    ds_read_b128 v[32:35], v12 offset:20480
    v_mul_f32 v126, v126, v94
    v_mul_f32 v127, v127, v95
    v_mul_f32 v128, v128, v96
    v_mfma_f32_32x32x16_bf16 v[56:71], a[140:143], v[36:39], v[56:71]
    v_mul_f32 v129, v129, v97
    v_mul_f32 v130, v130, v98
    v_mul_f32 v131, v131, v99
    s_add_u32 m0, s32, 31744
    s_nop 0
    buffer_load_dwordx4 v8, s[12:15], s31 offen offset:1024 lds
    s_waitcnt lgkmcnt(4)
    v_mfma_f32_32x32x16_bf16 v[40:55], a[144:147], v[16:19], v[40:55]
    ds_read_b128 v[36:39], v13 offset:20480
    v_mul_f32 v132, v132, v100
    v_mul_f32 v133, v133, v101
    v_mul_f32 v134, v134, v102
    v_mfma_f32_32x32x16_bf16 v[56:71], a[148:151], v[16:19], v[56:71]
    v_mul_f32 v135, v135, v103
    v_mul_f32 v136, v136, v104
    v_mul_f32 v137, v137, v105
    s_waitcnt lgkmcnt(4)
    v_mfma_f32_32x32x16_bf16 v[40:55], a[152:155], v[20:23], v[40:55]
    ds_read_b128 v[16:19], v10 offset:24576
    v_mul_f32 v138, v138, v106
    v_mul_f32 v139, v139, v107
    v_mul_f32 v140, v140, v108
    v_mfma_f32_32x32x16_bf16 v[56:71], a[156:159], v[20:23], v[56:71]
    v_mul_f32 v141, v141, v109
    v_mul_f32 v142, v142, v110
    v_mul_f32 v143, v143, v111
    s_add_u32 m0, s32, 35712
    s_nop 0
    buffer_load_dwordx4 v8, s[12:15], s31 offen offset:1152 lds
    s_waitcnt lgkmcnt(4)
    v_mfma_f32_32x32x16_bf16 v[40:55], a[160:163], v[24:27], v[40:55]
    ds_read_b128 v[20:23], v11 offset:24576
    v_mul_f32 v144, v144, v112
    v_mul_f32 v145, v145, v113
    v_mul_f32 v146, v146, v114
    v_mfma_f32_32x32x16_bf16 v[56:71], a[164:167], v[24:27], v[56:71]
    v_mul_f32 v147, v147, v115
    v_mul_f32 v148, v148, v116
    v_mul_f32 v149, v149, v117
    s_waitcnt lgkmcnt(4)
    v_mfma_f32_32x32x16_bf16 v[40:55], a[168:171], v[28:31], v[40:55]
    ds_read_b128 v[24:27], v12 offset:24576
    v_mul_f32 v150, v150, v118
    v_mul_f32 v151, v151, v119
    v_cvt_pk_bf16_f32 v152, v120, v121
    v_mfma_f32_32x32x16_bf16 v[56:71], a[172:175], v[28:31], v[56:71]
    v_cvt_pk_bf16_f32 v153, v122, v123
    v_cvt_pk_bf16_f32 v154, v124, v125
    v_cvt_pk_bf16_f32 v155, v126, v127
    s_waitcnt lgkmcnt(4)
    v_mfma_f32_32x32x16_bf16 v[40:55], a[176:179], v[32:35], v[40:55]
    ds_read_b128 v[28:31], v13 offset:24576
    v_cvt_pk_bf16_f32 v156, v128, v129
    v_cvt_pk_bf16_f32 v157, v130, v131
    v_cvt_pk_bf16_f32 v158, v132, v133
    v_mfma_f32_32x32x16_bf16 v[56:71], a[180:183], v[32:35], v[56:71]
    v_cvt_pk_bf16_f32 v159, v134, v135
    v_cvt_pk_bf16_f32 v160, v136, v137
    v_cvt_pk_bf16_f32 v161, v138, v139
    s_waitcnt lgkmcnt(4)
    v_mfma_f32_32x32x16_bf16 v[40:55], a[184:187], v[36:39], v[40:55]
    ds_read_b128 v[32:35], v10 offset:28672
    v_cvt_pk_bf16_f32 v162, v140, v141
    v_cvt_pk_bf16_f32 v163, v142, v143
    v_cvt_pk_bf16_f32 v164, v144, v145
    v_mfma_f32_32x32x16_bf16 v[56:71], a[188:191], v[36:39], v[56:71]
    v_cvt_pk_bf16_f32 v165, v146, v147
    v_cvt_pk_bf16_f32 v166, v148, v149
    v_cvt_pk_bf16_f32 v167, v150, v151
    s_waitcnt lgkmcnt(4)
    v_mfma_f32_32x32x16_bf16 v[40:55], a[192:195], v[16:19], v[40:55]
    ds_read_b128 v[36:39], v11 offset:28672
    buffer_store_dwordx4 v[152:155], v1, s[92:95], s35 offen offset:0 sc1
    buffer_store_dwordx4 v[156:159], v1, s[92:95], s35 offen offset:1024 sc1
    buffer_store_dwordx4 v[160:163], v1, s[92:95], s35 offen offset:2048 sc1
    v_mfma_f32_32x32x16_bf16 v[56:71], a[196:199], v[16:19], v[56:71]
    buffer_store_dwordx4 v[164:167], v1, s[92:95], s35 offen offset:3072 sc1
    s_waitcnt lgkmcnt(4)
    v_mfma_f32_32x32x16_bf16 v[40:55], a[200:203], v[20:23], v[40:55]
    ds_read_b128 v[16:19], v12 offset:28672
    v_mfma_f32_32x32x16_bf16 v[56:71], a[204:207], v[20:23], v[56:71]
    s_waitcnt lgkmcnt(4)
    v_mfma_f32_32x32x16_bf16 v[40:55], a[208:211], v[24:27], v[40:55]
    ds_read_b128 v[20:23], v13 offset:28672
    v_mfma_f32_32x32x16_bf16 v[56:71], a[212:215], v[24:27], v[56:71]
    s_waitcnt lgkmcnt(4)
    v_mfma_f32_32x32x16_bf16 v[40:55], a[216:219], v[28:31], v[40:55]
    ds_read_b128 v[24:27], v10 offset:32768
    v_mfma_f32_32x32x16_bf16 v[56:71], a[220:223], v[28:31], v[56:71]
    s_waitcnt lgkmcnt(4)
    v_mfma_f32_32x32x16_bf16 v[40:55], a[224:227], v[32:35], v[40:55]
    ds_read_b128 v[28:31], v11 offset:32768
    v_mfma_f32_32x32x16_bf16 v[56:71], a[228:231], v[32:35], v[56:71]
    s_waitcnt lgkmcnt(4)
    v_mfma_f32_32x32x16_bf16 v[40:55], a[232:235], v[36:39], v[40:55]
    ds_read_b128 v[32:35], v12 offset:32768
    v_mfma_f32_32x32x16_bf16 v[56:71], a[236:239], v[36:39], v[56:71]
    s_waitcnt lgkmcnt(4)
    v_mfma_f32_32x32x16_bf16 v[40:55], a[240:243], v[16:19], v[40:55]
    ds_read_b128 v[36:39], v13 offset:32768
    v_mfma_f32_32x32x16_bf16 v[56:71], a[244:247], v[16:19], v[56:71]
    s_waitcnt lgkmcnt(4)
    v_mfma_f32_32x32x16_bf16 v[40:55], a[248:251], v[20:23], v[40:55]
    ds_read_b128 v[16:19], v10 offset:36864
    v_mfma_f32_32x32x16_bf16 v[56:71], a[252:255], v[20:23], v[56:71]
    s_waitcnt lgkmcnt(4)
    v_mfma_f32_32x32x16_bf16 v[40:55], v[192:195], v[24:27], v[40:55]
    ds_read_b128 v[20:23], v11 offset:36864
    v_mfma_f32_32x32x16_bf16 v[56:71], v[196:199], v[24:27], v[56:71]
    s_waitcnt lgkmcnt(4)
    v_mfma_f32_32x32x16_bf16 v[40:55], v[200:203], v[28:31], v[40:55]
    ds_read_b128 v[24:27], v12 offset:36864
    v_mfma_f32_32x32x16_bf16 v[56:71], v[204:207], v[28:31], v[56:71]
    s_waitcnt lgkmcnt(4)
    v_mfma_f32_32x32x16_bf16 v[40:55], v[208:211], v[32:35], v[40:55]
    ds_read_b128 v[28:31], v13 offset:36864
    v_mfma_f32_32x32x16_bf16 v[56:71], v[212:215], v[32:35], v[56:71]
    s_waitcnt lgkmcnt(4)
    v_mfma_f32_32x32x16_bf16 v[40:55], v[216:219], v[36:39], v[40:55]
    v_mfma_f32_32x32x16_bf16 v[56:71], v[220:223], v[36:39], v[56:71]
    s_waitcnt lgkmcnt(3)
    v_mfma_f32_32x32x16_bf16 v[40:55], v[224:227], v[16:19], v[40:55]
    v_mfma_f32_32x32x16_bf16 v[56:71], v[228:231], v[16:19], v[56:71]
    s_waitcnt lgkmcnt(2)
    v_mfma_f32_32x32x16_bf16 v[40:55], v[232:235], v[20:23], v[40:55]
    v_mfma_f32_32x32x16_bf16 v[56:71], v[236:239], v[20:23], v[56:71]
    s_waitcnt lgkmcnt(1)
    v_mfma_f32_32x32x16_bf16 v[40:55], v[240:243], v[24:27], v[40:55]
    v_mfma_f32_32x32x16_bf16 v[56:71], v[244:247], v[24:27], v[56:71]
    s_waitcnt lgkmcnt(0)
    v_mfma_f32_32x32x16_bf16 v[40:55], v[248:251], v[28:31], v[40:55]
    v_mfma_f32_32x32x16_bf16 v[56:71], v[252:255], v[28:31], v[56:71]
    v_add_u32 v10, s33, v10
    v_add_u32 v11, s33, v11
    v_add_u32 v12, s33, v12
    v_add_u32 v13, s33, v13
    s_sub_u32 s33, 0, s33
    s_and_b32 s60, s23, 3
    s_lshl_b32 s60, s60, 4
    s_lshr_b32 s61, s23, 2
    s_add_u32 s60, s60, s61
    s_mul_i32 s60, s60, 110592
    s_add_u32 s35, s34, s60
    s_add_u32 s23, s23, 9
    s_mov_b32 s94, s36
    s_add_u32 s25, s25, 1
    v_mul_f32 v88, s39, v40
    v_mul_f32 v89, s39, v41
    v_mul_f32 v90, s39, v42
    v_mul_f32 v91, s39, v43
    v_mul_f32 v92, s39, v44
    v_mul_f32 v93, s39, v45
    v_mul_f32 v94, s39, v46
    v_mul_f32 v95, s39, v47
    v_mul_f32 v96, s39, v48
    v_mul_f32 v97, s39, v49
    v_mul_f32 v98, s39, v50
    v_mul_f32 v99, s39, v51
    v_mul_f32 v100, s39, v52
    v_mul_f32 v101, s39, v53
    v_mul_f32 v102, s39, v54
    v_mul_f32 v103, s39, v55
    v_mul_f32 v104, s39, v56
    v_mul_f32 v105, s39, v57
    v_mul_f32 v106, s39, v58
    v_mul_f32 v107, s39, v59
    v_mul_f32 v108, s39, v60
    v_mul_f32 v109, s39, v61
    v_mul_f32 v110, s39, v62
    v_mul_f32 v111, s39, v63
    v_mul_f32 v112, s39, v64
    v_mul_f32 v113, s39, v65
    v_mul_f32 v114, s39, v66
    v_mul_f32 v115, s39, v67
    v_mul_f32 v116, s39, v68
    v_mul_f32 v117, s39, v69
    v_mul_f32 v118, s39, v70
    v_mul_f32 v119, s39, v71
    s_cmp_lt_u32 s25, s24
    s_waitcnt vmcnt(4)
    s_cbranch_scc1 H_f1
    v_exp_f32 v120, v88
    v_exp_f32 v121, v89
    v_exp_f32 v122, v90
    v_exp_f32 v123, v91
    v_exp_f32 v124, v92
    v_exp_f32 v125, v93
    v_exp_f32 v126, v94
    v_exp_f32 v127, v95
    v_exp_f32 v128, v96
    v_exp_f32 v129, v97
    v_exp_f32 v130, v98
    v_exp_f32 v131, v99
    v_exp_f32 v132, v100
    v_exp_f32 v133, v101
    v_exp_f32 v134, v102
    v_exp_f32 v135, v103
    v_exp_f32 v136, v104
    v_exp_f32 v137, v105
    v_exp_f32 v138, v106
    v_exp_f32 v139, v107
    v_exp_f32 v140, v108
    v_exp_f32 v141, v109
    v_exp_f32 v142, v110
    v_exp_f32 v143, v111
    v_exp_f32 v144, v112
    v_exp_f32 v145, v113
    v_exp_f32 v146, v114
    v_exp_f32 v147, v115
    v_exp_f32 v148, v116
    v_exp_f32 v149, v117
    v_exp_f32 v150, v118
    v_exp_f32 v151, v119
    v_fma_f32 v120, v120, s39, s39
    v_fma_f32 v121, v121, s39, s39
    v_fma_f32 v122, v122, s39, s39
    v_fma_f32 v123, v123, s39, s39
    v_fma_f32 v124, v124, s39, s39
    v_fma_f32 v125, v125, s39, s39
    v_fma_f32 v126, v126, s39, s39
    v_fma_f32 v127, v127, s39, s39
    v_fma_f32 v128, v128, s39, s39
    v_fma_f32 v129, v129, s39, s39
    v_fma_f32 v130, v130, s39, s39
    v_fma_f32 v131, v131, s39, s39
    v_fma_f32 v132, v132, s39, s39
    v_fma_f32 v133, v133, s39, s39
    v_fma_f32 v134, v134, s39, s39
    v_fma_f32 v135, v135, s39, s39
    v_fma_f32 v136, v136, s39, s39
    v_fma_f32 v137, v137, s39, s39
    v_fma_f32 v138, v138, s39, s39
    v_fma_f32 v139, v139, s39, s39
    v_fma_f32 v140, v140, s39, s39
    v_fma_f32 v141, v141, s39, s39
    v_fma_f32 v142, v142, s39, s39
    v_fma_f32 v143, v143, s39, s39
    v_fma_f32 v144, v144, s39, s39
    v_fma_f32 v145, v145, s39, s39
    v_fma_f32 v146, v146, s39, s39
    v_fma_f32 v147, v147, s39, s39
    v_fma_f32 v148, v148, s39, s39
    v_fma_f32 v149, v149, s39, s39
    v_fma_f32 v150, v150, s39, s39
    v_fma_f32 v151, v151, s39, s39
    v_rcp_f32 v120, v120
    v_rcp_f32 v121, v121
    v_rcp_f32 v122, v122
    v_rcp_f32 v123, v123
    v_rcp_f32 v124, v124
    v_rcp_f32 v125, v125
    v_rcp_f32 v126, v126
    v_rcp_f32 v127, v127
    v_rcp_f32 v128, v128
    v_rcp_f32 v129, v129
    v_rcp_f32 v130, v130
    v_rcp_f32 v131, v131
    v_rcp_f32 v132, v132
    v_rcp_f32 v133, v133
    v_rcp_f32 v134, v134
    v_rcp_f32 v135, v135
    v_rcp_f32 v136, v136
    v_rcp_f32 v137, v137
    v_rcp_f32 v138, v138
    v_rcp_f32 v139, v139
    v_rcp_f32 v140, v140
    v_rcp_f32 v141, v141
    v_rcp_f32 v142, v142
    v_rcp_f32 v143, v143
    v_rcp_f32 v144, v144
    v_rcp_f32 v145, v145
    v_rcp_f32 v146, v146
    v_rcp_f32 v147, v147
    v_rcp_f32 v148, v148
    v_rcp_f32 v149, v149
    v_rcp_f32 v150, v150
    v_rcp_f32 v151, v151
    v_mul_f32 v120, v120, v88
    v_mul_f32 v121, v121, v89
    v_mul_f32 v122, v122, v90
    v_mul_f32 v123, v123, v91
    v_mul_f32 v124, v124, v92
    v_mul_f32 v125, v125, v93
    v_mul_f32 v126, v126, v94
    v_mul_f32 v127, v127, v95
    v_mul_f32 v128, v128, v96
    v_mul_f32 v129, v129, v97
    v_mul_f32 v130, v130, v98
    v_mul_f32 v131, v131, v99
    v_mul_f32 v132, v132, v100
    v_mul_f32 v133, v133, v101
    v_mul_f32 v134, v134, v102
    v_mul_f32 v135, v135, v103
    v_mul_f32 v136, v136, v104
    v_mul_f32 v137, v137, v105
    v_mul_f32 v138, v138, v106
    v_mul_f32 v139, v139, v107
    v_mul_f32 v140, v140, v108
    v_mul_f32 v141, v141, v109
    v_mul_f32 v142, v142, v110
    v_mul_f32 v143, v143, v111
    v_mul_f32 v144, v144, v112
    v_mul_f32 v145, v145, v113
    v_mul_f32 v146, v146, v114
    v_mul_f32 v147, v147, v115
    v_mul_f32 v148, v148, v116
    v_mul_f32 v149, v149, v117
    v_mul_f32 v150, v150, v118
    v_mul_f32 v151, v151, v119
    v_cvt_pk_bf16_f32 v152, v120, v121
    v_cvt_pk_bf16_f32 v153, v122, v123
    v_cvt_pk_bf16_f32 v154, v124, v125
    v_cvt_pk_bf16_f32 v155, v126, v127
    v_cvt_pk_bf16_f32 v156, v128, v129
    v_cvt_pk_bf16_f32 v157, v130, v131
    v_cvt_pk_bf16_f32 v158, v132, v133
    v_cvt_pk_bf16_f32 v159, v134, v135
    v_cvt_pk_bf16_f32 v160, v136, v137
    v_cvt_pk_bf16_f32 v161, v138, v139
    v_cvt_pk_bf16_f32 v162, v140, v141
    v_cvt_pk_bf16_f32 v163, v142, v143
    v_cvt_pk_bf16_f32 v164, v144, v145
    v_cvt_pk_bf16_f32 v165, v146, v147
    v_cvt_pk_bf16_f32 v166, v148, v149
    v_cvt_pk_bf16_f32 v167, v150, v151
    buffer_store_dwordx4 v[152:155], v1, s[92:95], s35 offen offset:0 sc1
    buffer_store_dwordx4 v[156:159], v1, s[92:95], s35 offen offset:1024 sc1
    buffer_store_dwordx4 v[160:163], v1, s[92:95], s35 offen offset:2048 sc1
    buffer_store_dwordx4 v[164:167], v1, s[92:95], s35 offen offset:3072 sc1
    s_waitcnt vmcnt(0)
    s_barrier
    s_branch H_f1f
H_f1e:
    s_mov_b32 s22, 262144
    v_mov_b32 v21, 192
H_wi2:
    global_load_dword v20, v21, s[6:7] sc1
    s_sub_u32 s22, s22, 1
    s_cbranch_scc1 W_fail
    s_waitcnt vmcnt(0)
    v_readfirstlane_b32 s21, v20
    s_and_b32 s61, s21, 0x3ff
    s_cmp_lt_u32 s61, 256
    s_cbranch_scc1 H_wi2
    s_cmp_gt_i32 s21, 0x3ff
    s_cselect_b32 s21, 8192, 0
H_f1f:
    v_mov_b32 v14, 1
    s_mov_b64 exec, s[54:55]
    buffer_store_dword v14, off, s[12:15], s20 offset:0 sc1
    s_mov_b64 exec, -1
    s_branch W_exit
W_main:
    s_sub_u32 s50, s50, 2
    s_lshl_b32 s60, s50, 3
    s_lshr_b32 s9, s51, 2
    s_add_u32 s9, s9, s60
    s_and_b32 s8, s51, 3
    s_lshl_b32 s30, s9, 8
    s_lshl_b32 s60, s10, 6
    s_add_u32 s30, s30, s60
    s_and_b32 s60, s9, 3
    s_cmp_eq_u32 s60, 1
    s_cselect_b64 vcc, -1, 0
    s_add_u32 m0, s28, 0
    s_add_u32 s61, s30, 0
    buffer_load_dwordx4 v5, s[76:79], s61 offen  lds
    s_add_u32 m0, s28, 1024
    s_add_u32 s61, s30, 0
    buffer_load_dwordx4 v5, s[80:83], s61 offen  lds
    s_add_u32 m0, s28, 2048
    s_add_u32 s61, s30, 131072
    buffer_load_dwordx4 v5, s[76:79], s61 offen  lds
    s_add_u32 m0, s28, 3072
    s_add_u32 s61, s30, 131072
    buffer_load_dwordx4 v5, s[80:83], s61 offen  lds
    s_add_u32 m0, s28, 4096
    s_add_u32 s61, s30, 262144
    buffer_load_dwordx4 v5, s[76:79], s61 offen  lds
    s_add_u32 m0, s28, 5120
    s_add_u32 s61, s30, 262144
    buffer_load_dwordx4 v5, s[80:83], s61 offen  lds
    s_cbranch_vccnz W_w1_2
    s_waitcnt vmcnt(5)
W_w1_2:
    s_add_u32 m0, s28, 6144
    s_add_u32 s61, s30, 393216
    buffer_load_dwordx4 v5, s[76:79], s61 offen  lds
    s_cbranch_vccnz W_w1_3
    s_waitcnt vmcnt(5)
W_w1_3:
    s_add_u32 m0, s28, 7168
    s_add_u32 s61, s30, 393216
    buffer_load_dwordx4 v5, s[80:83], s61 offen  lds
    s_cbranch_vccnz W_w2_0
    s_waitcnt vmcnt(5)
W_w2_0:
    s_add_u32 m0, s28, 8192
    s_add_u32 s61, s30, 524288
    buffer_load_dwordx4 v5, s[76:79], s61 offen  lds
    s_cbranch_vccnz W_w2_1
    s_waitcnt vmcnt(5)
W_w2_1:
    s_add_u32 m0, s28, 9216
    s_add_u32 s61, s30, 524288
    buffer_load_dwordx4 v5, s[80:83], s61 offen  lds
    s_cbranch_vccnz W_w2_2
    s_waitcnt vmcnt(5)
W_w2_2:
    s_add_u32 m0, s28, 10240
    s_add_u32 s61, s30, 655360
    buffer_load_dwordx4 v5, s[76:79], s61 offen  lds
    s_cbranch_vccnz W_w2_3
    s_waitcnt vmcnt(5)
W_w2_3:
    s_add_u32 m0, s28, 11264
    s_add_u32 s61, s30, 655360
    buffer_load_dwordx4 v5, s[80:83], s61 offen  lds
    s_cbranch_vccnz W_w3_0
    s_waitcnt vmcnt(5)
W_w3_0:
    s_add_u32 m0, s28, 12288
    s_add_u32 s61, s30, 786432
    buffer_load_dwordx4 v5, s[76:79], s61 offen  lds
    s_cbranch_vccnz W_w3_1
    s_waitcnt vmcnt(5)
W_w3_1:
    s_add_u32 m0, s28, 13312
    s_add_u32 s61, s30, 786432
    buffer_load_dwordx4 v5, s[80:83], s61 offen  lds
    s_cbranch_vccnz W_w3_2
    s_waitcnt vmcnt(5)
W_w3_2:
    s_add_u32 m0, s28, 14336
    s_add_u32 s61, s30, 917504
    buffer_load_dwordx4 v5, s[76:79], s61 offen  lds
    s_cbranch_vccnz W_w3_3
    s_waitcnt vmcnt(5)
W_w3_3:
    s_add_u32 m0, s28, 15360
    s_add_u32 s61, s30, 917504
    buffer_load_dwordx4 v5, s[80:83], s61 offen  lds
    s_cbranch_vccnz W_w4_0
    s_waitcnt vmcnt(5)
W_w4_0:
    s_add_u32 m0, s28, 16384
    s_add_u32 s61, s30, 1048576
    buffer_load_dwordx4 v5, s[76:79], s61 offen  lds
    s_cbranch_vccnz W_w4_1
    s_waitcnt vmcnt(5)
W_w4_1:
    s_add_u32 m0, s28, 17408
    s_add_u32 s61, s30, 1048576
    buffer_load_dwordx4 v5, s[80:83], s61 offen  lds
    s_cbranch_vccnz W_w4_2
    s_waitcnt vmcnt(5)
W_w4_2:
    s_add_u32 m0, s28, 18432
    s_add_u32 s61, s30, 1179648
    buffer_load_dwordx4 v5, s[76:79], s61 offen  lds
    s_cbranch_vccnz W_w4_3
    s_waitcnt vmcnt(5)
W_w4_3:
    s_add_u32 m0, s28, 19456
    s_add_u32 s61, s30, 1179648
    buffer_load_dwordx4 v5, s[80:83], s61 offen  lds
    s_waitcnt vmcnt(16)
    ds_read_b64_tr_b16 a[0:1], v3 offset:0
    ds_read_b64_tr_b16 a[2:3], v3 offset:256
    ds_read_b64_tr_b16 a[4:5], v3 offset:1024
    ds_read_b64_tr_b16 a[6:7], v3 offset:1280
    ds_read_b64_tr_b16 a[8:9], v3 offset:2048
    ds_read_b64_tr_b16 a[10:11], v3 offset:2304
    ds_read_b64_tr_b16 a[12:13], v3 offset:3072
    ds_read_b64_tr_b16 a[14:15], v3 offset:3328
    s_waitcnt lgkmcnt(0)
    s_cbranch_vccnz W_w5_0
    s_waitcnt vmcnt(5)
W_w5_0:
    s_add_u32 m0, s28, 0
    s_add_u32 s61, s30, 1310720
    buffer_load_dwordx4 v5, s[76:79], s61 offen  lds
    s_cbranch_vccnz W_w5_1
    s_waitcnt vmcnt(5)
W_w5_1:
    s_add_u32 m0, s28, 1024
    s_add_u32 s61, s30, 1310720
    buffer_load_dwordx4 v5, s[80:83], s61 offen  lds
    s_cbranch_vccnz W_w5_2
    s_waitcnt vmcnt(5)
W_w5_2:
    s_add_u32 m0, s28, 2048
    s_add_u32 s61, s30, 1441792
    buffer_load_dwordx4 v5, s[76:79], s61 offen  lds
    s_cbranch_vccnz W_w5_3
    s_waitcnt vmcnt(5)
W_w5_3:
    s_add_u32 m0, s28, 3072
    s_add_u32 s61, s30, 1441792
    buffer_load_dwordx4 v5, s[80:83], s61 offen  lds
    s_waitcnt vmcnt(16)
    ds_read_b64_tr_b16 a[16:17], v3 offset:4096
    ds_read_b64_tr_b16 a[18:19], v3 offset:4352
    ds_read_b64_tr_b16 a[20:21], v3 offset:5120
    ds_read_b64_tr_b16 a[22:23], v3 offset:5376
    ds_read_b64_tr_b16 a[24:25], v3 offset:6144
    ds_read_b64_tr_b16 a[26:27], v3 offset:6400
    ds_read_b64_tr_b16 a[28:29], v3 offset:7168
    ds_read_b64_tr_b16 a[30:31], v3 offset:7424
    s_waitcnt lgkmcnt(0)
    s_cbranch_vccnz W_w6_0
    s_waitcnt vmcnt(5)
W_w6_0:
    s_add_u32 m0, s28, 4096
    s_add_u32 s61, s30, 1572864
    buffer_load_dwordx4 v5, s[76:79], s61 offen  lds
    s_cbranch_vccnz W_w6_1
    s_waitcnt vmcnt(5)
W_w6_1:
    s_add_u32 m0, s28, 5120
    s_add_u32 s61, s30, 1572864
    buffer_load_dwordx4 v5, s[80:83], s61 offen  lds
    s_cbranch_vccnz W_w6_2
    s_waitcnt vmcnt(5)
W_w6_2:
    s_add_u32 m0, s28, 6144
    s_add_u32 s61, s30, 1703936
    buffer_load_dwordx4 v5, s[76:79], s61 offen  lds
    s_cbranch_vccnz W_w6_3
    s_waitcnt vmcnt(5)
W_w6_3:
    s_add_u32 m0, s28, 7168
    s_add_u32 s61, s30, 1703936
    buffer_load_dwordx4 v5, s[80:83], s61 offen  lds
    s_waitcnt vmcnt(16)
    ds_read_b64_tr_b16 a[32:33], v3 offset:8192
    ds_read_b64_tr_b16 a[34:35], v3 offset:8448
    ds_read_b64_tr_b16 a[36:37], v3 offset:9216
    ds_read_b64_tr_b16 a[38:39], v3 offset:9472
    ds_read_b64_tr_b16 a[40:41], v3 offset:10240
    ds_read_b64_tr_b16 a[42:43], v3 offset:10496
    ds_read_b64_tr_b16 a[44:45], v3 offset:11264
    ds_read_b64_tr_b16 a[46:47], v3 offset:11520
    s_waitcnt lgkmcnt(0)
    s_cbranch_vccnz W_w7_0
    s_waitcnt vmcnt(5)
W_w7_0:
    s_add_u32 m0, s28, 8192
    s_add_u32 s61, s30, 1835008
    buffer_load_dwordx4 v5, s[76:79], s61 offen  lds
    s_cbranch_vccnz W_w7_1
    s_waitcnt vmcnt(5)
W_w7_1:
    s_add_u32 m0, s28, 9216
    s_add_u32 s61, s30, 1835008
    buffer_load_dwordx4 v5, s[80:83], s61 offen  lds
    s_cbranch_vccnz W_w7_2
    s_waitcnt vmcnt(5)
W_w7_2:
    s_add_u32 m0, s28, 10240
    s_add_u32 s61, s30, 1966080
    buffer_load_dwordx4 v5, s[76:79], s61 offen  lds
    s_cbranch_vccnz W_w7_3
    s_waitcnt vmcnt(5)
W_w7_3:
    s_add_u32 m0, s28, 11264
    s_add_u32 s61, s30, 1966080
    buffer_load_dwordx4 v5, s[80:83], s61 offen  lds
    s_waitcnt vmcnt(16)
    ds_read_b64_tr_b16 a[48:49], v3 offset:12288
    ds_read_b64_tr_b16 a[50:51], v3 offset:12544
    ds_read_b64_tr_b16 a[52:53], v3 offset:13312
    ds_read_b64_tr_b16 a[54:55], v3 offset:13568
    ds_read_b64_tr_b16 a[56:57], v3 offset:14336
    ds_read_b64_tr_b16 a[58:59], v3 offset:14592
    ds_read_b64_tr_b16 a[60:61], v3 offset:15360
    ds_read_b64_tr_b16 a[62:63], v3 offset:15616
    s_waitcnt lgkmcnt(0)
    s_cbranch_vccnz W_w8_0
    s_waitcnt vmcnt(5)
W_w8_0:
    s_add_u32 m0, s28, 12288
    s_add_u32 s61, s30, 2097152
    buffer_load_dwordx4 v5, s[76:79], s61 offen  lds
    s_cbranch_vccnz W_w8_1
    s_waitcnt vmcnt(5)
W_w8_1:
    s_add_u32 m0, s28, 13312
    s_add_u32 s61, s30, 2097152
    buffer_load_dwordx4 v5, s[80:83], s61 offen  lds
    s_cbranch_vccnz W_w8_2
    s_waitcnt vmcnt(5)
W_w8_2:
    s_add_u32 m0, s28, 14336
    s_add_u32 s61, s30, 2228224
    buffer_load_dwordx4 v5, s[76:79], s61 offen  lds
    s_cbranch_vccnz W_w8_3
    s_waitcnt vmcnt(5)
W_w8_3:
    s_add_u32 m0, s28, 15360
    s_add_u32 s61, s30, 2228224
    buffer_load_dwordx4 v5, s[80:83], s61 offen  lds
    s_waitcnt vmcnt(16)
    ds_read_b64_tr_b16 a[64:65], v3 offset:16384
    ds_read_b64_tr_b16 a[66:67], v3 offset:16640
    ds_read_b64_tr_b16 a[68:69], v3 offset:17408
    ds_read_b64_tr_b16 a[70:71], v3 offset:17664
    ds_read_b64_tr_b16 a[72:73], v3 offset:18432
    ds_read_b64_tr_b16 a[74:75], v3 offset:18688
    ds_read_b64_tr_b16 a[76:77], v3 offset:19456
    ds_read_b64_tr_b16 a[78:79], v3 offset:19712
    s_waitcnt lgkmcnt(0)
    s_cbranch_vccnz W_w9_0
    s_waitcnt vmcnt(5)
W_w9_0:
    s_add_u32 m0, s28, 16384
    s_add_u32 s61, s30, 2359296
    buffer_load_dwordx4 v5, s[76:79], s61 offen  lds
    s_cbranch_vccnz W_w9_1
    s_waitcnt vmcnt(5)
W_w9_1:
    s_add_u32 m0, s28, 17408
    s_add_u32 s61, s30, 2359296
    buffer_load_dwordx4 v5, s[80:83], s61 offen  lds
    s_cbranch_vccnz W_w9_2
    s_waitcnt vmcnt(5)
W_w9_2:
    s_add_u32 m0, s28, 18432
    s_add_u32 s61, s30, 2490368
    buffer_load_dwordx4 v5, s[76:79], s61 offen  lds
    s_cbranch_vccnz W_w9_3
    s_waitcnt vmcnt(5)
W_w9_3:
    s_add_u32 m0, s28, 19456
    s_add_u32 s61, s30, 2490368
    buffer_load_dwordx4 v5, s[80:83], s61 offen  lds
    s_waitcnt vmcnt(16)
    ds_read_b64_tr_b16 a[80:81], v3 offset:0
    ds_read_b64_tr_b16 a[82:83], v3 offset:256
    ds_read_b64_tr_b16 a[84:85], v3 offset:1024
    ds_read_b64_tr_b16 a[86:87], v3 offset:1280
    ds_read_b64_tr_b16 a[88:89], v3 offset:2048
    ds_read_b64_tr_b16 a[90:91], v3 offset:2304
    ds_read_b64_tr_b16 a[92:93], v3 offset:3072
    ds_read_b64_tr_b16 a[94:95], v3 offset:3328
    s_waitcnt lgkmcnt(0)
    s_cbranch_vccnz W_w10_0
    s_waitcnt vmcnt(5)
W_w10_0:
    s_add_u32 m0, s28, 0
    s_add_u32 s61, s30, 2621440
    buffer_load_dwordx4 v5, s[76:79], s61 offen  lds
    s_cbranch_vccnz W_w10_1
    s_waitcnt vmcnt(5)
W_w10_1:
    s_add_u32 m0, s28, 1024
    s_add_u32 s61, s30, 2621440
    buffer_load_dwordx4 v5, s[80:83], s61 offen  lds
    s_cbranch_vccnz W_w10_2
    s_waitcnt vmcnt(5)
W_w10_2:
    s_add_u32 m0, s28, 2048
    s_add_u32 s61, s30, 2752512
    buffer_load_dwordx4 v5, s[76:79], s61 offen  lds
    s_cbranch_vccnz W_w10_3
    s_waitcnt vmcnt(5)
W_w10_3:
    s_add_u32 m0, s28, 3072
    s_add_u32 s61, s30, 2752512
    buffer_load_dwordx4 v5, s[80:83], s61 offen  lds
    s_waitcnt vmcnt(16)
    ds_read_b64_tr_b16 a[96:97], v3 offset:4096
    ds_read_b64_tr_b16 a[98:99], v3 offset:4352
    ds_read_b64_tr_b16 a[100:101], v3 offset:5120
    ds_read_b64_tr_b16 a[102:103], v3 offset:5376
    ds_read_b64_tr_b16 a[104:105], v3 offset:6144
    ds_read_b64_tr_b16 a[106:107], v3 offset:6400
    ds_read_b64_tr_b16 a[108:109], v3 offset:7168
    ds_read_b64_tr_b16 a[110:111], v3 offset:7424
    s_waitcnt lgkmcnt(0)
    s_cbranch_vccnz W_w11_0
    s_waitcnt vmcnt(5)
W_w11_0:
    s_add_u32 m0, s28, 4096
    s_add_u32 s61, s30, 2883584
    buffer_load_dwordx4 v5, s[76:79], s61 offen  lds
    s_cbranch_vccnz W_w11_1
    s_waitcnt vmcnt(5)
W_w11_1:
    s_add_u32 m0, s28, 5120
    s_add_u32 s61, s30, 2883584
    buffer_load_dwordx4 v5, s[80:83], s61 offen  lds
    s_cbranch_vccnz W_w11_2
    s_waitcnt vmcnt(5)
W_w11_2:
    s_add_u32 m0, s28, 6144
    s_add_u32 s61, s30, 3014656
    buffer_load_dwordx4 v5, s[76:79], s61 offen  lds
    s_cbranch_vccnz W_w11_3
    s_waitcnt vmcnt(5)
W_w11_3:
    s_add_u32 m0, s28, 7168
    s_add_u32 s61, s30, 3014656
    buffer_load_dwordx4 v5, s[80:83], s61 offen  lds
    s_waitcnt vmcnt(16)
    ds_read_b64_tr_b16 a[112:113], v3 offset:8192
    ds_read_b64_tr_b16 a[114:115], v3 offset:8448
    ds_read_b64_tr_b16 a[116:117], v3 offset:9216
    ds_read_b64_tr_b16 a[118:119], v3 offset:9472
    ds_read_b64_tr_b16 a[120:121], v3 offset:10240
    ds_read_b64_tr_b16 a[122:123], v3 offset:10496
    ds_read_b64_tr_b16 a[124:125], v3 offset:11264
    ds_read_b64_tr_b16 a[126:127], v3 offset:11520
    s_waitcnt lgkmcnt(0)
    s_cbranch_vccnz W_w12_0
    s_waitcnt vmcnt(5)
W_w12_0:
    s_add_u32 m0, s28, 8192
    s_add_u32 s61, s30, 3145728
    buffer_load_dwordx4 v5, s[76:79], s61 offen  lds
    s_cbranch_vccnz W_w12_1
    s_waitcnt vmcnt(5)
W_w12_1:
    s_add_u32 m0, s28, 9216
    s_add_u32 s61, s30, 3145728
    buffer_load_dwordx4 v5, s[80:83], s61 offen  lds
    s_cbranch_vccnz W_w12_2
    s_waitcnt vmcnt(5)
W_w12_2:
    s_add_u32 m0, s28, 10240
    s_add_u32 s61, s30, 3276800
    buffer_load_dwordx4 v5, s[76:79], s61 offen  lds
    s_cbranch_vccnz W_w12_3
    s_waitcnt vmcnt(5)
W_w12_3:
    s_add_u32 m0, s28, 11264
    s_add_u32 s61, s30, 3276800
    buffer_load_dwordx4 v5, s[80:83], s61 offen  lds
    s_waitcnt vmcnt(16)
    ds_read_b64_tr_b16 a[128:129], v3 offset:12288
    ds_read_b64_tr_b16 a[130:131], v3 offset:12544
    ds_read_b64_tr_b16 a[132:133], v3 offset:13312
    ds_read_b64_tr_b16 a[134:135], v3 offset:13568
    ds_read_b64_tr_b16 a[136:137], v3 offset:14336
    ds_read_b64_tr_b16 a[138:139], v3 offset:14592
    ds_read_b64_tr_b16 a[140:141], v3 offset:15360
    ds_read_b64_tr_b16 a[142:143], v3 offset:15616
    s_waitcnt lgkmcnt(0)
    s_cbranch_vccnz W_w13_0
    s_waitcnt vmcnt(5)
W_w13_0:
    s_add_u32 m0, s28, 12288
    s_add_u32 s61, s30, 3407872
    buffer_load_dwordx4 v5, s[76:79], s61 offen  lds
    s_cbranch_vccnz W_w13_1
    s_waitcnt vmcnt(5)
W_w13_1:
    s_add_u32 m0, s28, 13312
    s_add_u32 s61, s30, 3407872
    buffer_load_dwordx4 v5, s[80:83], s61 offen  lds
    s_cbranch_vccnz W_w13_2
    s_waitcnt vmcnt(5)
W_w13_2:
    s_add_u32 m0, s28, 14336
    s_add_u32 s61, s30, 3538944
    buffer_load_dwordx4 v5, s[76:79], s61 offen  lds
    s_cbranch_vccnz W_w13_3
    s_waitcnt vmcnt(5)
W_w13_3:
    s_add_u32 m0, s28, 15360
    s_add_u32 s61, s30, 3538944
    buffer_load_dwordx4 v5, s[80:83], s61 offen  lds
    s_waitcnt vmcnt(16)
    ds_read_b64_tr_b16 a[144:145], v3 offset:16384
    ds_read_b64_tr_b16 a[146:147], v3 offset:16640
    ds_read_b64_tr_b16 a[148:149], v3 offset:17408
    ds_read_b64_tr_b16 a[150:151], v3 offset:17664
    ds_read_b64_tr_b16 a[152:153], v3 offset:18432
    ds_read_b64_tr_b16 a[154:155], v3 offset:18688
    ds_read_b64_tr_b16 a[156:157], v3 offset:19456
    ds_read_b64_tr_b16 a[158:159], v3 offset:19712
    s_waitcnt lgkmcnt(0)
    s_cbranch_vccnz W_w14_0
    s_waitcnt vmcnt(5)
W_w14_0:
    s_add_u32 m0, s28, 16384
    s_add_u32 s61, s30, 3670016
    buffer_load_dwordx4 v5, s[76:79], s61 offen  lds
    s_cbranch_vccnz W_w14_1
    s_waitcnt vmcnt(5)
W_w14_1:
    s_add_u32 m0, s28, 17408
    s_add_u32 s61, s30, 3670016
    buffer_load_dwordx4 v5, s[80:83], s61 offen  lds
    s_cbranch_vccnz W_w14_2
    s_waitcnt vmcnt(5)
W_w14_2:
    s_add_u32 m0, s28, 18432
    s_add_u32 s61, s30, 3801088
    buffer_load_dwordx4 v5, s[76:79], s61 offen  lds
    s_cbranch_vccnz W_w14_3
    s_waitcnt vmcnt(5)
W_w14_3:
    s_add_u32 m0, s28, 19456
    s_add_u32 s61, s30, 3801088
    buffer_load_dwordx4 v5, s[80:83], s61 offen  lds
    s_waitcnt vmcnt(16)
    ds_read_b64_tr_b16 a[160:161], v3 offset:0
    ds_read_b64_tr_b16 a[162:163], v3 offset:256
    ds_read_b64_tr_b16 a[164:165], v3 offset:1024
    ds_read_b64_tr_b16 a[166:167], v3 offset:1280
    ds_read_b64_tr_b16 a[168:169], v3 offset:2048
    ds_read_b64_tr_b16 a[170:171], v3 offset:2304
    ds_read_b64_tr_b16 a[172:173], v3 offset:3072
    ds_read_b64_tr_b16 a[174:175], v3 offset:3328
    s_waitcnt lgkmcnt(0)
    s_cbranch_vccnz W_w15_0
    s_waitcnt vmcnt(5)
W_w15_0:
    s_add_u32 m0, s28, 0
    s_add_u32 s61, s30, 3932160
    buffer_load_dwordx4 v5, s[76:79], s61 offen  lds
    s_cbranch_vccnz W_w15_1
    s_waitcnt vmcnt(5)
W_w15_1:
    s_add_u32 m0, s28, 1024
    s_add_u32 s61, s30, 3932160
    buffer_load_dwordx4 v5, s[80:83], s61 offen  lds
    s_cbranch_vccnz W_w15_2
    s_waitcnt vmcnt(5)
W_w15_2:
    s_add_u32 m0, s28, 2048
    s_add_u32 s61, s30, 4063232
    buffer_load_dwordx4 v5, s[76:79], s61 offen  lds
    s_cbranch_vccnz W_w15_3
    s_waitcnt vmcnt(5)
W_w15_3:
    s_add_u32 m0, s28, 3072
    s_add_u32 s61, s30, 4063232
    buffer_load_dwordx4 v5, s[80:83], s61 offen  lds
    s_waitcnt vmcnt(16)
    ds_read_b64_tr_b16 a[176:177], v3 offset:4096
    ds_read_b64_tr_b16 a[178:179], v3 offset:4352
    ds_read_b64_tr_b16 a[180:181], v3 offset:5120
    ds_read_b64_tr_b16 a[182:183], v3 offset:5376
    ds_read_b64_tr_b16 a[184:185], v3 offset:6144
    ds_read_b64_tr_b16 a[186:187], v3 offset:6400
    ds_read_b64_tr_b16 a[188:189], v3 offset:7168
    ds_read_b64_tr_b16 a[190:191], v3 offset:7424
    s_waitcnt lgkmcnt(0)
    s_cbranch_vccnz W_w16_0
    s_waitcnt vmcnt(5)
W_w16_0:
    s_add_u32 m0, s28, 4096
    s_add_u32 s61, s30, 4194304
    buffer_load_dwordx4 v5, s[76:79], s61 offen  lds
    s_cbranch_vccnz W_w16_1
    s_waitcnt vmcnt(5)
W_w16_1:
    s_add_u32 m0, s28, 5120
    s_add_u32 s61, s30, 4194304
    buffer_load_dwordx4 v5, s[80:83], s61 offen  lds
    s_cbranch_vccnz W_w16_2
    s_waitcnt vmcnt(5)
W_w16_2:
    s_add_u32 m0, s28, 6144
    s_add_u32 s61, s30, 4325376
    buffer_load_dwordx4 v5, s[76:79], s61 offen  lds
    s_cbranch_vccnz W_w16_3
    s_waitcnt vmcnt(5)
W_w16_3:
    s_add_u32 m0, s28, 7168
    s_add_u32 s61, s30, 4325376
    buffer_load_dwordx4 v5, s[80:83], s61 offen  lds
    s_waitcnt vmcnt(16)
    ds_read_b64_tr_b16 a[192:193], v3 offset:8192
    ds_read_b64_tr_b16 a[194:195], v3 offset:8448
    ds_read_b64_tr_b16 a[196:197], v3 offset:9216
    ds_read_b64_tr_b16 a[198:199], v3 offset:9472
    ds_read_b64_tr_b16 a[200:201], v3 offset:10240
    ds_read_b64_tr_b16 a[202:203], v3 offset:10496
    ds_read_b64_tr_b16 a[204:205], v3 offset:11264
    ds_read_b64_tr_b16 a[206:207], v3 offset:11520
    s_waitcnt lgkmcnt(0)
    s_cbranch_vccnz W_w17_0
    s_waitcnt vmcnt(5)
W_w17_0:
    s_add_u32 m0, s28, 8192
    s_add_u32 s61, s30, 4456448
    buffer_load_dwordx4 v5, s[76:79], s61 offen  lds
    s_cbranch_vccnz W_w17_1
    s_waitcnt vmcnt(5)
W_w17_1:
    s_add_u32 m0, s28, 9216
    s_add_u32 s61, s30, 4456448
    buffer_load_dwordx4 v5, s[80:83], s61 offen  lds
    s_cbranch_vccnz W_w17_2
    s_waitcnt vmcnt(5)
W_w17_2:
    s_add_u32 m0, s28, 10240
    s_add_u32 s61, s30, 4587520
    buffer_load_dwordx4 v5, s[76:79], s61 offen  lds
    s_cbranch_vccnz W_w17_3
    s_waitcnt vmcnt(5)
W_w17_3:
    s_add_u32 m0, s28, 11264
    s_add_u32 s61, s30, 4587520
    buffer_load_dwordx4 v5, s[80:83], s61 offen  lds
    s_waitcnt vmcnt(16)
    ds_read_b64_tr_b16 a[208:209], v3 offset:12288
    ds_read_b64_tr_b16 a[210:211], v3 offset:12544
    ds_read_b64_tr_b16 a[212:213], v3 offset:13312
    ds_read_b64_tr_b16 a[214:215], v3 offset:13568
    ds_read_b64_tr_b16 a[216:217], v3 offset:14336
    ds_read_b64_tr_b16 a[218:219], v3 offset:14592
    ds_read_b64_tr_b16 a[220:221], v3 offset:15360
    ds_read_b64_tr_b16 a[222:223], v3 offset:15616
    s_waitcnt lgkmcnt(0)
    s_cbranch_vccnz W_w18_0
    s_waitcnt vmcnt(5)
W_w18_0:
    s_add_u32 m0, s28, 12288
    s_add_u32 s61, s30, 4718592
    buffer_load_dwordx4 v5, s[76:79], s61 offen  lds
    s_cbranch_vccnz W_w18_1
    s_waitcnt vmcnt(5)
W_w18_1:
    s_add_u32 m0, s28, 13312
    s_add_u32 s61, s30, 4718592
    buffer_load_dwordx4 v5, s[80:83], s61 offen  lds
    s_cbranch_vccnz W_w18_2
    s_waitcnt vmcnt(5)
W_w18_2:
    s_add_u32 m0, s28, 14336
    s_add_u32 s61, s30, 4849664
    buffer_load_dwordx4 v5, s[76:79], s61 offen  lds
    s_cbranch_vccnz W_w18_3
    s_waitcnt vmcnt(5)
W_w18_3:
    s_add_u32 m0, s28, 15360
    s_add_u32 s61, s30, 4849664
    buffer_load_dwordx4 v5, s[80:83], s61 offen  lds
    s_waitcnt vmcnt(16)
    ds_read_b64_tr_b16 a[224:225], v3 offset:16384
    ds_read_b64_tr_b16 a[226:227], v3 offset:16640
    ds_read_b64_tr_b16 a[228:229], v3 offset:17408
    ds_read_b64_tr_b16 a[230:231], v3 offset:17664
    ds_read_b64_tr_b16 a[232:233], v3 offset:18432
    ds_read_b64_tr_b16 a[234:235], v3 offset:18688
    ds_read_b64_tr_b16 a[236:237], v3 offset:19456
    ds_read_b64_tr_b16 a[238:239], v3 offset:19712
    s_waitcnt lgkmcnt(0)
    s_cbranch_vccnz W_w19_0
    s_waitcnt vmcnt(5)
W_w19_0:
    s_add_u32 m0, s28, 16384
    s_add_u32 s61, s30, 4980736
    buffer_load_dwordx4 v5, s[76:79], s61 offen  lds
    s_cbranch_vccnz W_w19_1
    s_waitcnt vmcnt(5)
W_w19_1:
    s_add_u32 m0, s28, 17408
    s_add_u32 s61, s30, 4980736
    buffer_load_dwordx4 v5, s[80:83], s61 offen  lds
    s_cbranch_vccnz W_w19_2
    s_waitcnt vmcnt(5)
W_w19_2:
    s_add_u32 m0, s28, 18432
    s_add_u32 s61, s30, 5111808
    buffer_load_dwordx4 v5, s[76:79], s61 offen  lds
    s_cbranch_vccnz W_w19_3
    s_waitcnt vmcnt(5)
W_w19_3:
    s_add_u32 m0, s28, 19456
    s_add_u32 s61, s30, 5111808
    buffer_load_dwordx4 v5, s[80:83], s61 offen  lds
    s_waitcnt vmcnt(16)
    ds_read_b64_tr_b16 a[240:241], v3 offset:0
    ds_read_b64_tr_b16 a[242:243], v3 offset:256
    ds_read_b64_tr_b16 a[244:245], v3 offset:1024
    ds_read_b64_tr_b16 a[246:247], v3 offset:1280
    ds_read_b64_tr_b16 a[248:249], v3 offset:2048
    ds_read_b64_tr_b16 a[250:251], v3 offset:2304
    ds_read_b64_tr_b16 a[252:253], v3 offset:3072
    ds_read_b64_tr_b16 a[254:255], v3 offset:3328
    s_waitcnt lgkmcnt(0)
    s_waitcnt vmcnt(12)
    ds_read_b64_tr_b16 v[192:193], v3 offset:4096
    ds_read_b64_tr_b16 v[194:195], v3 offset:4352
    ds_read_b64_tr_b16 v[196:197], v3 offset:5120
    ds_read_b64_tr_b16 v[198:199], v3 offset:5376
    ds_read_b64_tr_b16 v[200:201], v3 offset:6144
    ds_read_b64_tr_b16 v[202:203], v3 offset:6400
    ds_read_b64_tr_b16 v[204:205], v3 offset:7168
    ds_read_b64_tr_b16 v[206:207], v3 offset:7424
    s_waitcnt lgkmcnt(0)
    s_waitcnt vmcnt(8)
    ds_read_b64_tr_b16 v[208:209], v3 offset:8192
    ds_read_b64_tr_b16 v[210:211], v3 offset:8448
    ds_read_b64_tr_b16 v[212:213], v3 offset:9216
    ds_read_b64_tr_b16 v[214:215], v3 offset:9472
    ds_read_b64_tr_b16 v[216:217], v3 offset:10240
    ds_read_b64_tr_b16 v[218:219], v3 offset:10496
    ds_read_b64_tr_b16 v[220:221], v3 offset:11264
    ds_read_b64_tr_b16 v[222:223], v3 offset:11520
    s_waitcnt lgkmcnt(0)
    s_waitcnt vmcnt(4)
    ds_read_b64_tr_b16 v[224:225], v3 offset:12288
    ds_read_b64_tr_b16 v[226:227], v3 offset:12544
    ds_read_b64_tr_b16 v[228:229], v3 offset:13312
    ds_read_b64_tr_b16 v[230:231], v3 offset:13568
    ds_read_b64_tr_b16 v[232:233], v3 offset:14336
    ds_read_b64_tr_b16 v[234:235], v3 offset:14592
    ds_read_b64_tr_b16 v[236:237], v3 offset:15360
    ds_read_b64_tr_b16 v[238:239], v3 offset:15616
    s_waitcnt lgkmcnt(0)
    s_waitcnt vmcnt(0)
    ds_read_b64_tr_b16 v[240:241], v3 offset:16384
    ds_read_b64_tr_b16 v[242:243], v3 offset:16640
    ds_read_b64_tr_b16 v[244:245], v3 offset:17408
    ds_read_b64_tr_b16 v[246:247], v3 offset:17664
    ds_read_b64_tr_b16 v[248:249], v3 offset:18432
    ds_read_b64_tr_b16 v[250:251], v3 offset:18688
    ds_read_b64_tr_b16 v[252:253], v3 offset:19456
    ds_read_b64_tr_b16 v[254:255], v3 offset:19712
    s_waitcnt lgkmcnt(0)
    s_mov_b32 s22, 262144
    v_mov_b32 v21, 192
W_wi:
    global_load_dword v20, v21, s[6:7] sc1
    s_sub_u32 s22, s22, 1
    s_cbranch_scc1 W_fail
    s_waitcnt vmcnt(0)
    v_readfirstlane_b32 s21, v20
    s_and_b32 s61, s21, 0x3ff
    s_cmp_lt_u32 s61, 256
    s_cbranch_scc1 W_wi
    s_cmp_gt_i32 s21, 0x3ff
    s_cselect_b32 s21, 8192, 0
    s_mov_b32 s23, s8
    s_mov_b32 s25, 0
    s_mul_i32 s31, s8, 40960
    s_add_u32 s31, s31, 4194304
    s_mov_b32 s32, s29
    s_mov_b32 s33, 40960
    s_add_u32 m0, s32, 0
    s_nop 0
    buffer_load_dwordx4 v8, s[12:15], s31 offen offset:0 lds
    s_add_u32 m0, s32, 3968
    s_nop 0
    buffer_load_dwordx4 v8, s[12:15], s31 offen offset:128 lds
    s_add_u32 m0, s32, 7936
    s_nop 0
    buffer_load_dwordx4 v8, s[12:15], s31 offen offset:256 lds
    s_add_u32 m0, s32, 11904
    s_nop 0
    buffer_load_dwordx4 v8, s[12:15], s31 offen offset:384 lds
    s_add_u32 m0, s32, 15872
    s_nop 0
    buffer_load_dwordx4 v8, s[12:15], s31 offen offset:512 lds
    s_add_u32 m0, s32, 19840
    s_nop 0
    buffer_load_dwordx4 v8, s[12:15], s31 offen offset:640 lds
    s_add_u32 m0, s32, 23808
    s_nop 0
    buffer_load_dwordx4 v8, s[12:15], s31 offen offset:768 lds
    s_add_u32 m0, s32, 27776
    s_nop 0
    buffer_load_dwordx4 v8, s[12:15], s31 offen offset:896 lds
    s_add_u32 m0, s32, 31744
    s_nop 0
    buffer_load_dwordx4 v8, s[12:15], s31 offen offset:1024 lds
    s_add_u32 m0, s32, 35712
    s_nop 0
    buffer_load_dwordx4 v8, s[12:15], s31 offen offset:1152 lds
    s_load_dwordx2 s[88:89], s[0:1], 72
    s_mov_b32 s90, 2211840
    s_mov_b32 s91, 0x00020000
    s_lshl_b32 s27, s9, 14
    s_mul_i32 s34, s9, 16384
    s_lshl_b32 s60, s10, 11
    s_add_u32 s34, s34, s60
    s_mul_i32 s60, s8, 524288
    s_add_u32 s34, s34, s60
    s_add_u32 s34, s34, 16777216
    s_add_u32 s27, s27, 5120
    s_add_u32 s27, s27, s21
    s_lshl_b32 s60, s8, 2
    v_mov_b32 v9, s60
    s_lshl_b32 s60, s51, 2
    s_add_u32 s60, s60, s10
    s_lshl_b32 s60, s60, 12
    v_lshl_add_u32 v88, v0, 6, s60
    s_mov_b32 s36, 0
    s_waitcnt vmcnt(0) lgkmcnt(0)
W_kv:
    s_barrier
    v_mov_b32 v14, s23
    ds_read_b128 v[16:19], v10 offset:0
    ds_read_b128 v[20:23], v11 offset:0
    ds_read_b128 v[24:27], v12 offset:0
    ds_read_b128 v[28:31], v13 offset:0
    ds_read_b128 v[32:35], v10 offset:4096
    s_add_u32 s31, s31, 163840
    s_add_u32 s32, s32, s33
    s_min_u32 s31, s31, 6774784
    s_waitcnt lgkmcnt(4)
    v_mfma_f32_32x32x16_bf16 v[40:55], a[0:3], v[16:19], 0
    ds_read_b128 v[36:39], v11 offset:4096
    v_mfma_f32_32x32x16_bf16 v[56:71], v[16:19], a[4:7], 0
    s_waitcnt lgkmcnt(4)
    v_mfma_f32_32x32x16_bf16 v[40:55], a[8:11], v[20:23], v[40:55]
    ds_read_b128 v[16:19], v12 offset:4096
    v_mfma_f32_32x32x16_bf16 v[56:71], v[20:23], a[12:15], v[56:71]
    s_add_u32 m0, s32, 0
    s_nop 0
    buffer_load_dwordx4 v8, s[12:15], s31 offen offset:0 lds
    s_waitcnt lgkmcnt(4)
    v_mfma_f32_32x32x16_bf16 v[40:55], a[16:19], v[24:27], v[40:55]
    ds_read_b128 v[20:23], v13 offset:4096
    v_mfma_f32_32x32x16_bf16 v[56:71], v[24:27], a[20:23], v[56:71]
    s_waitcnt lgkmcnt(4)
    v_mfma_f32_32x32x16_bf16 v[40:55], a[24:27], v[28:31], v[40:55]
    ds_read_b128 v[24:27], v10 offset:8192
    v_mfma_f32_32x32x16_bf16 v[56:71], v[28:31], a[28:31], v[56:71]
    s_add_u32 m0, s32, 3968
    s_nop 0
    buffer_load_dwordx4 v8, s[12:15], s31 offen offset:128 lds
    s_waitcnt lgkmcnt(4)
    v_mfma_f32_32x32x16_bf16 v[40:55], a[32:35], v[32:35], v[40:55]
    ds_read_b128 v[28:31], v11 offset:8192
    v_mfma_f32_32x32x16_bf16 v[56:71], v[32:35], a[36:39], v[56:71]
    s_waitcnt lgkmcnt(4)
    v_mfma_f32_32x32x16_bf16 v[40:55], a[40:43], v[36:39], v[40:55]
    ds_read_b128 v[32:35], v12 offset:8192
    v_mfma_f32_32x32x16_bf16 v[56:71], v[36:39], a[44:47], v[56:71]
    s_add_u32 m0, s32, 7936
    s_nop 0
    buffer_load_dwordx4 v8, s[12:15], s31 offen offset:256 lds
    s_waitcnt lgkmcnt(4)
    v_mfma_f32_32x32x16_bf16 v[40:55], a[48:51], v[16:19], v[40:55]
    ds_read_b128 v[36:39], v13 offset:8192
    v_mfma_f32_32x32x16_bf16 v[56:71], v[16:19], a[52:55], v[56:71]
    s_waitcnt lgkmcnt(4)
    v_mfma_f32_32x32x16_bf16 v[40:55], a[56:59], v[20:23], v[40:55]
    ds_read_b128 v[16:19], v10 offset:12288
    v_mfma_f32_32x32x16_bf16 v[56:71], v[20:23], a[60:63], v[56:71]
    s_add_u32 m0, s32, 11904
    s_nop 0
    buffer_load_dwordx4 v8, s[12:15], s31 offen offset:384 lds
    s_waitcnt lgkmcnt(4)
    v_mfma_f32_32x32x16_bf16 v[40:55], a[64:67], v[24:27], v[40:55]
    ds_read_b128 v[20:23], v11 offset:12288
    v_mfma_f32_32x32x16_bf16 v[56:71], v[24:27], a[68:71], v[56:71]
    s_waitcnt lgkmcnt(4)
    v_mfma_f32_32x32x16_bf16 v[40:55], a[72:75], v[28:31], v[40:55]
    ds_read_b128 v[24:27], v12 offset:12288
    v_mfma_f32_32x32x16_bf16 v[56:71], v[28:31], a[76:79], v[56:71]
    s_add_u32 m0, s32, 15872
    s_nop 0
    buffer_load_dwordx4 v8, s[12:15], s31 offen offset:512 lds
    s_waitcnt lgkmcnt(4)
    v_mfma_f32_32x32x16_bf16 v[40:55], a[80:83], v[32:35], v[40:55]
    ds_read_b128 v[28:31], v13 offset:12288
    v_mfma_f32_32x32x16_bf16 v[56:71], v[32:35], a[84:87], v[56:71]
    s_waitcnt lgkmcnt(4)
    v_mfma_f32_32x32x16_bf16 v[40:55], a[88:91], v[36:39], v[40:55]
    ds_read_b128 v[32:35], v10 offset:16384
    v_mfma_f32_32x32x16_bf16 v[56:71], v[36:39], a[92:95], v[56:71]
    s_add_u32 m0, s32, 19840
    s_nop 0
    buffer_load_dwordx4 v8, s[12:15], s31 offen offset:640 lds
    s_waitcnt lgkmcnt(4)
    v_mfma_f32_32x32x16_bf16 v[40:55], a[96:99], v[16:19], v[40:55]
    ds_read_b128 v[36:39], v11 offset:16384
    v_mfma_f32_32x32x16_bf16 v[56:71], v[16:19], a[100:103], v[56:71]
    s_waitcnt lgkmcnt(4)
    v_mfma_f32_32x32x16_bf16 v[40:55], a[104:107], v[20:23], v[40:55]
    ds_read_b128 v[16:19], v12 offset:16384
    v_mfma_f32_32x32x16_bf16 v[56:71], v[20:23], a[108:111], v[56:71]
    s_add_u32 m0, s32, 23808
    s_nop 0
    buffer_load_dwordx4 v8, s[12:15], s31 offen offset:768 lds
    s_waitcnt lgkmcnt(4)
    v_mfma_f32_32x32x16_bf16 v[40:55], a[112:115], v[24:27], v[40:55]
    ds_read_b128 v[20:23], v13 offset:16384
    v_mfma_f32_32x32x16_bf16 v[56:71], v[24:27], a[116:119], v[56:71]
    s_waitcnt lgkmcnt(4)
    v_mfma_f32_32x32x16_bf16 v[40:55], a[120:123], v[28:31], v[40:55]
    ds_read_b128 v[24:27], v10 offset:20480
    v_mfma_f32_32x32x16_bf16 v[56:71], v[28:31], a[124:127], v[56:71]
    s_add_u32 m0, s32, 27776
    s_nop 0
    buffer_load_dwordx4 v8, s[12:15], s31 offen offset:896 lds
    s_waitcnt lgkmcnt(4)
    v_mfma_f32_32x32x16_bf16 v[40:55], a[128:131], v[32:35], v[40:55]
    ds_read_b128 v[28:31], v11 offset:20480
    v_mfma_f32_32x32x16_bf16 v[56:71], v[32:35], a[132:135], v[56:71]
    s_waitcnt lgkmcnt(4)
    v_mfma_f32_32x32x16_bf16 v[40:55], a[136:139], v[36:39], v[40:55]
    ds_read_b128 v[32:35], v12 offset:20480
    v_mfma_f32_32x32x16_bf16 v[56:71], v[36:39], a[140:143], v[56:71]
    s_add_u32 m0, s32, 31744
    s_nop 0
    buffer_load_dwordx4 v8, s[12:15], s31 offen offset:1024 lds
    s_waitcnt lgkmcnt(4)
    v_mfma_f32_32x32x16_bf16 v[40:55], a[144:147], v[16:19], v[40:55]
    ds_read_b128 v[36:39], v13 offset:20480
    v_mfma_f32_32x32x16_bf16 v[56:71], v[16:19], a[148:151], v[56:71]
    s_waitcnt lgkmcnt(4)
    v_mfma_f32_32x32x16_bf16 v[40:55], a[152:155], v[20:23], v[40:55]
    ds_read_b128 v[16:19], v10 offset:24576
    v_mfma_f32_32x32x16_bf16 v[56:71], v[20:23], a[156:159], v[56:71]
    s_add_u32 m0, s32, 35712
    s_nop 0
    buffer_load_dwordx4 v8, s[12:15], s31 offen offset:1152 lds
    s_waitcnt lgkmcnt(4)
    v_mfma_f32_32x32x16_bf16 v[40:55], a[160:163], v[24:27], v[40:55]
    ds_read_b128 v[20:23], v11 offset:24576
    v_mfma_f32_32x32x16_bf16 v[56:71], v[24:27], a[164:167], v[56:71]
    s_waitcnt lgkmcnt(4)
    v_mfma_f32_32x32x16_bf16 v[40:55], a[168:171], v[28:31], v[40:55]
    ds_read_b128 v[24:27], v12 offset:24576
    v_mfma_f32_32x32x16_bf16 v[56:71], v[28:31], a[172:175], v[56:71]
    s_waitcnt lgkmcnt(4)
    v_mfma_f32_32x32x16_bf16 v[40:55], a[176:179], v[32:35], v[40:55]
    ds_read_b128 v[28:31], v13 offset:24576
    v_mfma_f32_32x32x16_bf16 v[56:71], v[32:35], a[180:183], v[56:71]
    s_waitcnt vmcnt(10)
    s_barrier
    s_mov_b64 exec, s[54:55]
    buffer_store_dword v14, v9, s[12:15], s27 offen offset:768 sc1
    s_mov_b64 exec, -1
    s_waitcnt lgkmcnt(4)
    v_mfma_f32_32x32x16_bf16 v[40:55], a[184:187], v[36:39], v[40:55]
    ds_read_b128 v[32:35], v10 offset:28672
    v_mfma_f32_32x32x16_bf16 v[56:71], v[36:39], a[188:191], v[56:71]
    s_waitcnt lgkmcnt(4)
    v_mfma_f32_32x32x16_bf16 v[40:55], a[192:195], v[16:19], v[40:55]
    ds_read_b128 v[36:39], v11 offset:28672
    v_mfma_f32_32x32x16_bf16 v[56:71], v[16:19], a[196:199], v[56:71]
    s_cmp_ge_u32 s23, 32
    s_cbranch_scc0 W_nt
    buffer_load_dword v89, v88, s[88:91], s36 offen
    s_add_u32 s36, s36, 0x80000
W_nt:
    s_waitcnt lgkmcnt(4)
    v_mfma_f32_32x32x16_bf16 v[40:55], a[200:203], v[20:23], v[40:55]
    ds_read_b128 v[16:19], v12 offset:28672
    v_mfma_f32_32x32x16_bf16 v[56:71], v[20:23], a[204:207], v[56:71]
    s_waitcnt lgkmcnt(4)
    v_mfma_f32_32x32x16_bf16 v[40:55], a[208:211], v[24:27], v[40:55]
    ds_read_b128 v[20:23], v13 offset:28672
    v_mfma_f32_32x32x16_bf16 v[56:71], v[24:27], a[212:215], v[56:71]
    s_waitcnt lgkmcnt(4)
    v_mfma_f32_32x32x16_bf16 v[40:55], a[216:219], v[28:31], v[40:55]
    ds_read_b128 v[24:27], v10 offset:32768
    v_mfma_f32_32x32x16_bf16 v[56:71], v[28:31], a[220:223], v[56:71]
    s_waitcnt lgkmcnt(4)
    v_mfma_f32_32x32x16_bf16 v[40:55], a[224:227], v[32:35], v[40:55]
    ds_read_b128 v[28:31], v11 offset:32768
    v_mfma_f32_32x32x16_bf16 v[56:71], v[32:35], a[228:231], v[56:71]
    s_waitcnt lgkmcnt(4)
    v_mfma_f32_32x32x16_bf16 v[40:55], a[232:235], v[36:39], v[40:55]
    ds_read_b128 v[32:35], v12 offset:32768
    v_mfma_f32_32x32x16_bf16 v[56:71], v[36:39], a[236:239], v[56:71]
    s_waitcnt lgkmcnt(4)
    v_mfma_f32_32x32x16_bf16 v[40:55], a[240:243], v[16:19], v[40:55]
    ds_read_b128 v[36:39], v13 offset:32768
    v_mfma_f32_32x32x16_bf16 v[56:71], v[16:19], a[244:247], v[56:71]
    s_waitcnt lgkmcnt(4)
    v_mfma_f32_32x32x16_bf16 v[40:55], a[248:251], v[20:23], v[40:55]
    ds_read_b128 v[16:19], v10 offset:36864
    v_mfma_f32_32x32x16_bf16 v[56:71], v[20:23], a[252:255], v[56:71]
    s_waitcnt lgkmcnt(4)
    v_mfma_f32_32x32x16_bf16 v[40:55], v[192:195], v[24:27], v[40:55]
    ds_read_b128 v[20:23], v11 offset:36864
    v_mfma_f32_32x32x16_bf16 v[56:71], v[24:27], v[196:199], v[56:71]
    s_waitcnt lgkmcnt(4)
    v_mfma_f32_32x32x16_bf16 v[40:55], v[200:203], v[28:31], v[40:55]
    ds_read_b128 v[24:27], v12 offset:36864
    v_mfma_f32_32x32x16_bf16 v[56:71], v[28:31], v[204:207], v[56:71]
    s_waitcnt lgkmcnt(4)
    v_mfma_f32_32x32x16_bf16 v[40:55], v[208:211], v[32:35], v[40:55]
    ds_read_b128 v[28:31], v13 offset:36864
    v_mfma_f32_32x32x16_bf16 v[56:71], v[32:35], v[212:215], v[56:71]
    s_waitcnt lgkmcnt(4)
    v_mfma_f32_32x32x16_bf16 v[40:55], v[216:219], v[36:39], v[40:55]
    v_mfma_f32_32x32x16_bf16 v[56:71], v[36:39], v[220:223], v[56:71]
    s_waitcnt lgkmcnt(3)
    v_mfma_f32_32x32x16_bf16 v[40:55], v[224:227], v[16:19], v[40:55]
    v_mfma_f32_32x32x16_bf16 v[56:71], v[16:19], v[228:231], v[56:71]
    s_waitcnt lgkmcnt(2)
    v_mfma_f32_32x32x16_bf16 v[40:55], v[232:235], v[20:23], v[40:55]
    v_mfma_f32_32x32x16_bf16 v[56:71], v[20:23], v[236:239], v[56:71]
    s_waitcnt lgkmcnt(1)
    v_mfma_f32_32x32x16_bf16 v[40:55], v[240:243], v[24:27], v[40:55]
    v_mfma_f32_32x32x16_bf16 v[56:71], v[24:27], v[244:247], v[56:71]
    s_waitcnt lgkmcnt(0)
    v_mfma_f32_32x32x16_bf16 v[40:55], v[248:251], v[28:31], v[40:55]
    v_mfma_f32_32x32x16_bf16 v[56:71], v[28:31], v[252:255], v[56:71]
    v_add_u32 v10, s33, v10
    v_add_u32 v11, s33, v11
    v_add_u32 v12, s33, v12
    v_add_u32 v13, s33, v13
    s_sub_u32 s33, 0, s33
    v_cvt_pk_bf16_f32 v72, v40, v41
    v_cvt_pk_bf16_f32 v73, v42, v43
    v_cvt_pk_bf16_f32 v74, v44, v45
    v_cvt_pk_bf16_f32 v75, v46, v47
    v_cvt_pk_bf16_f32 v76, v48, v49
    v_cvt_pk_bf16_f32 v77, v50, v51
    v_cvt_pk_bf16_f32 v78, v52, v53
    v_cvt_pk_bf16_f32 v79, v54, v55
    v_cvt_pk_bf16_f32 v80, v56, v57
    v_cvt_pk_bf16_f32 v81, v58, v59
    v_cvt_pk_bf16_f32 v82, v60, v61
    v_cvt_pk_bf16_f32 v83, v62, v63
    v_cvt_pk_bf16_f32 v84, v64, v65
    v_cvt_pk_bf16_f32 v85, v66, v67
    v_cvt_pk_bf16_f32 v86, v68, v69
    v_cvt_pk_bf16_f32 v87, v70, v71
    s_waitcnt vmcnt(0)
    s_add_u32 s35, s34, 8192
    buffer_store_dwordx4 v[72:75], v1, s[12:15], s34 offen sc1
    buffer_store_dwordx4 v[76:79], v1, s[12:15], s34 offen offset:1024 sc1
    buffer_store_dwordx4 v[80:83], v1, s[12:15], s35 offen sc1
    buffer_store_dwordx4 v[84:87], v1, s[12:15], s35 offen offset:1024 sc1
    s_add_u32 s34, s34, 2097152
    s_add_u32 s23, s23, 4
    s_cmp_lt_u32 s23, 64
    s_cbranch_scc1 W_kv
    s_mov_b32 s19, 3080192
    s_mov_b32 s22, 262144
H_wh:
    buffer_load_dword v14, v2, s[12:15], s19 offen offset:0 sc1
    s_sub_u32 s22, s22, 1
    s_cbranch_scc1 W_fail
    s_waitcnt vmcnt(0)
    v_cmp_gt_u32 vcc, 1, v14
    s_cbranch_vccnz H_wh
    s_waitcnt vmcnt(0)
    s_barrier
    v_mov_b32 v14, 64
    s_mov_b64 exec, s[54:55]
    buffer_store_dword v14, v9, s[12:15], s27 offen offset:768 sc1
    s_mov_b64 exec, -1
    s_mov_b32 s19, 3080192
    s_load_dwordx2 s[80:81], s[0:1], 72
    s_mov_b32 s82, 2211840
    s_mov_b32 s83, 0x00020000
    s_lshl_b32 s42, s51, 8
    s_lshl_b32 s60, s10, 6
    s_add_u32 s42, s42, s60
    s_mul_i32 s38, s10, 32768
    s_add_u32 s38, s38, 32768
    s_sub_u32 s61, s38, s28
    v_add_u32 v185, s61, v3
    v_min_u32 v184, 39, v0
    s_mul_i32 s61, s10, 40
    v_add_u32 v184, s61, v184
    v_lshrrev_b32 v184, 1, v184
    v_and_b32 v16, 1, v0
    v_lshlrev_b32 v16, 7, v16
    v_lshl_add_u32 v184, v184, 13, v16
    s_sub_u32 s62, s42, s60
    s_cmp_lt_u32 s51, 30
    s_cbranch_scc0 H_q
    buffer_load_dword v15, v184, s[84:87], s62 offen
    s_add_u32 s62, s62, 262144
    buffer_load_dword v15, v184, s[84:87], s62 offen
    s_sub_u32 s60, 655360, s60
    v_add_u32 v184, s60, v184
    s_mul_i32 s60, s51, 26
    s_lshr_b32 s60, s60, 8
    s_mul_i32 s61, s60, 10
    s_sub_u32 s36, s51, s61
    s_lshl_b32 s61, s60, 2
    s_add_u32 s8, s50, s61
    s_cmp_lt_u32 s8, 4
    s_cselect_b32 s24, 6, 5
    s_mul_i32 s37, s36, 2
    s_min_u32 s37, s37, 18
    s_lshl_b32 s60, s37, 6
    s_mul_i32 s30, s10, 552960
    s_add_u32 s30, s30, s60
    s_lshr_b32 s35, s8, 2
    s_lshl4_add_u32 s35, s50, s35
    s_mul_i32 s35, s35, 110592
    s_mul_i32 s61, s10, 27648
    s_add_u32 s35, s35, s61
    s_add_u32 s35, s35, 67108864
    s_mul_i32 s53, s8, 40960
    s_lshl_b32 s60, s37, 11
    s_add_u32 s53, s53, s60
    s_add_u32 s53, s53, 79691776
    s_lshl_b32 s60, s10, 12
    v_add_u32 v180, s60, v1
    v_add_u32 v181, s29, v1
    s_lshl_b32 s60, s10, 9
    v_lshl_add_u32 v182, v0, 3, s60
    s_mov_b32 s25, 0
    s_mul_i32 s60, s36, 22
    v_min_u32 v183, 21, v0
    v_add_u32 v183, s60, v183
    v_min_u32 v183, 215, v183
    v_lshlrev_b32 v183, 7, v183
    v_add_u32 v183, 331776, v183
    s_waitcnt lgkmcnt(0)
    s_sub_u32 s61, s35, 331776
    buffer_load_dword v15, v183, s[12:15], s61 offen
    s_add_u32 m0, s28, 0
    s_add_u32 s61, s30, 0
    buffer_load_dwordx4 v7, s[80:83], s61 offen  lds
    s_add_u32 m0, s28, 1024
    s_add_u32 s61, s30, 64
    buffer_load_dwordx4 v7, s[80:83], s61 offen  lds
    s_add_u32 m0, s28, 2048
    s_add_u32 s61, s30, 20480
    buffer_load_dwordx4 v7, s[80:83], s61 offen  lds
    s_add_u32 m0, s28, 3072
    s_add_u32 s61, s30, 20544
    buffer_load_dwordx4 v7, s[80:83], s61 offen  lds
    s_add_u32 m0, s28, 4096
    s_add_u32 s61, s30, 40960
    buffer_load_dwordx4 v7, s[80:83], s61 offen  lds
    s_add_u32 m0, s28, 5120
    s_add_u32 s61, s30, 41024
    buffer_load_dwordx4 v7, s[80:83], s61 offen  lds
    s_add_u32 m0, s28, 6144
    s_add_u32 s61, s30, 61440
    buffer_load_dwordx4 v7, s[80:83], s61 offen  lds
    s_add_u32 m0, s28, 7168
    s_add_u32 s61, s30, 61504
    buffer_load_dwordx4 v7, s[80:83], s61 offen  lds
    s_add_u32 m0, s28, 8192
    s_add_u32 s61, s30, 81920
    buffer_load_dwordx4 v7, s[80:83], s61 offen  lds
    s_add_u32 m0, s28, 9216
    s_add_u32 s61, s30, 81984
    buffer_load_dwordx4 v7, s[80:83], s61 offen  lds
    s_add_u32 m0, s28, 10240
    s_add_u32 s61, s30, 102400
    buffer_load_dwordx4 v7, s[80:83], s61 offen  lds
    s_add_u32 m0, s28, 11264
    s_add_u32 s61, s30, 102464
    buffer_load_dwordx4 v7, s[80:83], s61 offen  lds
    s_add_u32 m0, s28, 12288
    s_add_u32 s61, s30, 122880
    buffer_load_dwordx4 v7, s[80:83], s61 offen  lds
    s_add_u32 m0, s28, 13312
    s_add_u32 s61, s30, 122944
    buffer_load_dwordx4 v7, s[80:83], s61 offen  lds
    s_add_u32 m0, s28, 14336
    s_add_u32 s61, s30, 143360
    buffer_load_dwordx4 v7, s[80:83], s61 offen  lds
    s_add_u32 m0, s28, 15360
    s_add_u32 s61, s30, 143424
    buffer_load_dwordx4 v7, s[80:83], s61 offen  lds
    s_add_u32 m0, s28, 16384
    s_add_u32 s61, s30, 163840
    buffer_load_dwordx4 v7, s[80:83], s61 offen  lds
    s_add_u32 m0, s28, 17408
    s_add_u32 s61, s30, 163904
    buffer_load_dwordx4 v7, s[80:83], s61 offen  lds
    s_add_u32 m0, s28, 18432
    s_add_u32 s61, s30, 184320
    buffer_load_dwordx4 v7, s[80:83], s61 offen  lds
    s_add_u32 m0, s28, 19456
    s_add_u32 s61, s30, 184384
    buffer_load_dwordx4 v7, s[80:83], s61 offen  lds
    s_waitcnt vmcnt(16)
    ds_read_b64_tr_b16 a[0:1], v4 offset:0
    ds_read_b64_tr_b16 a[2:3], v4 offset:512
    ds_read_b64_tr_b16 a[4:5], v4 offset:1024
    ds_read_b64_tr_b16 a[6:7], v4 offset:1536
    ds_read_b64_tr_b16 a[8:9], v4 offset:2048
    ds_read_b64_tr_b16 a[10:11], v4 offset:2560
    ds_read_b64_tr_b16 a[12:13], v4 offset:3072
    ds_read_b64_tr_b16 a[14:15], v4 offset:3584
    s_waitcnt lgkmcnt(0)
    s_add_u32 m0, s28, 0
    s_add_u32 s61, s30, 204800
    buffer_load_dwordx4 v7, s[80:83], s61 offen  lds
    s_add_u32 m0, s28, 1024
    s_add_u32 s61, s30, 204864
    buffer_load_dwordx4 v7, s[80:83], s61 offen  lds
    s_add_u32 m0, s28, 2048
    s_add_u32 s61, s30, 225280
    buffer_load_dwordx4 v7, s[80:83], s61 offen  lds
    s_add_u32 m0, s28, 3072
    s_add_u32 s61, s30, 225344
    buffer_load_dwordx4 v7, s[80:83], s61 offen  lds
    s_waitcnt vmcnt(16)
    ds_read_b64_tr_b16 a[16:17], v4 offset:4096
    ds_read_b64_tr_b16 a[18:19], v4 offset:4608
    ds_read_b64_tr_b16 a[20:21], v4 offset:5120
    ds_read_b64_tr_b16 a[22:23], v4 offset:5632
    ds_read_b64_tr_b16 a[24:25], v4 offset:6144
    ds_read_b64_tr_b16 a[26:27], v4 offset:6656
    ds_read_b64_tr_b16 a[28:29], v4 offset:7168
    ds_read_b64_tr_b16 a[30:31], v4 offset:7680
    s_waitcnt lgkmcnt(0)
    s_add_u32 m0, s28, 4096
    s_add_u32 s61, s30, 245760
    buffer_load_dwordx4 v7, s[80:83], s61 offen  lds
    s_add_u32 m0, s28, 5120
    s_add_u32 s61, s30, 245824
    buffer_load_dwordx4 v7, s[80:83], s61 offen  lds
    s_add_u32 m0, s28, 6144
    s_add_u32 s61, s30, 266240
    buffer_load_dwordx4 v7, s[80:83], s61 offen  lds
    s_add_u32 m0, s28, 7168
    s_add_u32 s61, s30, 266304
    buffer_load_dwordx4 v7, s[80:83], s61 offen  lds
    s_waitcnt vmcnt(16)
    ds_read_b64_tr_b16 a[32:33], v4 offset:8192
    ds_read_b64_tr_b16 a[34:35], v4 offset:8704
    ds_read_b64_tr_b16 a[36:37], v4 offset:9216
    ds_read_b64_tr_b16 a[38:39], v4 offset:9728
    ds_read_b64_tr_b16 a[40:41], v4 offset:10240
    ds_read_b64_tr_b16 a[42:43], v4 offset:10752
    ds_read_b64_tr_b16 a[44:45], v4 offset:11264
    ds_read_b64_tr_b16 a[46:47], v4 offset:11776
    s_waitcnt lgkmcnt(0)
    s_add_u32 m0, s28, 8192
    s_add_u32 s61, s30, 286720
    buffer_load_dwordx4 v7, s[80:83], s61 offen  lds
    s_add_u32 m0, s28, 9216
    s_add_u32 s61, s30, 286784
    buffer_load_dwordx4 v7, s[80:83], s61 offen  lds
    s_add_u32 m0, s28, 10240
    s_add_u32 s61, s30, 307200
    buffer_load_dwordx4 v7, s[80:83], s61 offen  lds
    s_add_u32 m0, s28, 11264
    s_add_u32 s61, s30, 307264
    buffer_load_dwordx4 v7, s[80:83], s61 offen  lds
    s_waitcnt vmcnt(16)
    ds_read_b64_tr_b16 a[48:49], v4 offset:12288
    ds_read_b64_tr_b16 a[50:51], v4 offset:12800
    ds_read_b64_tr_b16 a[52:53], v4 offset:13312
    ds_read_b64_tr_b16 a[54:55], v4 offset:13824
    ds_read_b64_tr_b16 a[56:57], v4 offset:14336
    ds_read_b64_tr_b16 a[58:59], v4 offset:14848
    ds_read_b64_tr_b16 a[60:61], v4 offset:15360
    ds_read_b64_tr_b16 a[62:63], v4 offset:15872
    s_waitcnt lgkmcnt(0)
    s_add_u32 m0, s28, 12288
    s_add_u32 s61, s30, 327680
    buffer_load_dwordx4 v7, s[80:83], s61 offen  lds
    s_add_u32 m0, s28, 13312
    s_add_u32 s61, s30, 327744
    buffer_load_dwordx4 v7, s[80:83], s61 offen  lds
    s_add_u32 m0, s28, 14336
    s_add_u32 s61, s30, 348160
    buffer_load_dwordx4 v7, s[80:83], s61 offen  lds
    s_add_u32 m0, s28, 15360
    s_add_u32 s61, s30, 348224
    buffer_load_dwordx4 v7, s[80:83], s61 offen  lds
    s_waitcnt vmcnt(16)
    ds_read_b64_tr_b16 a[64:65], v4 offset:16384
    ds_read_b64_tr_b16 a[66:67], v4 offset:16896
    ds_read_b64_tr_b16 a[68:69], v4 offset:17408
    ds_read_b64_tr_b16 a[70:71], v4 offset:17920
    ds_read_b64_tr_b16 a[72:73], v4 offset:18432
    ds_read_b64_tr_b16 a[74:75], v4 offset:18944
    ds_read_b64_tr_b16 a[76:77], v4 offset:19456
    ds_read_b64_tr_b16 a[78:79], v4 offset:19968
    s_waitcnt lgkmcnt(0)
    s_add_u32 m0, s28, 16384
    s_add_u32 s61, s30, 368640
    buffer_load_dwordx4 v7, s[80:83], s61 offen  lds
    s_add_u32 m0, s28, 17408
    s_add_u32 s61, s30, 368704
    buffer_load_dwordx4 v7, s[80:83], s61 offen  lds
    s_add_u32 m0, s28, 18432
    s_add_u32 s61, s30, 389120
    buffer_load_dwordx4 v7, s[80:83], s61 offen  lds
    s_add_u32 m0, s28, 19456
    s_add_u32 s61, s30, 389184
    buffer_load_dwordx4 v7, s[80:83], s61 offen  lds
    s_waitcnt vmcnt(16)
    ds_read_b64_tr_b16 a[80:81], v4 offset:0
    ds_read_b64_tr_b16 a[82:83], v4 offset:512
    ds_read_b64_tr_b16 a[84:85], v4 offset:1024
    ds_read_b64_tr_b16 a[86:87], v4 offset:1536
    ds_read_b64_tr_b16 a[88:89], v4 offset:2048
    ds_read_b64_tr_b16 a[90:91], v4 offset:2560
    ds_read_b64_tr_b16 a[92:93], v4 offset:3072
    ds_read_b64_tr_b16 a[94:95], v4 offset:3584
    s_waitcnt lgkmcnt(0)
    s_add_u32 m0, s28, 0
    s_add_u32 s61, s30, 409600
    buffer_load_dwordx4 v7, s[80:83], s61 offen  lds
    s_add_u32 m0, s28, 1024
    s_add_u32 s61, s30, 409664
    buffer_load_dwordx4 v7, s[80:83], s61 offen  lds
    s_add_u32 m0, s28, 2048
    s_add_u32 s61, s30, 430080
    buffer_load_dwordx4 v7, s[80:83], s61 offen  lds
    s_add_u32 m0, s28, 3072
    s_add_u32 s61, s30, 430144
    buffer_load_dwordx4 v7, s[80:83], s61 offen  lds
    s_waitcnt vmcnt(16)
    ds_read_b64_tr_b16 a[96:97], v4 offset:4096
    ds_read_b64_tr_b16 a[98:99], v4 offset:4608
    ds_read_b64_tr_b16 a[100:101], v4 offset:5120
    ds_read_b64_tr_b16 a[102:103], v4 offset:5632
    ds_read_b64_tr_b16 a[104:105], v4 offset:6144
    ds_read_b64_tr_b16 a[106:107], v4 offset:6656
    ds_read_b64_tr_b16 a[108:109], v4 offset:7168
    ds_read_b64_tr_b16 a[110:111], v4 offset:7680
    s_waitcnt lgkmcnt(0)
    s_add_u32 m0, s28, 4096
    s_add_u32 s61, s30, 450560
    buffer_load_dwordx4 v7, s[80:83], s61 offen  lds
    s_add_u32 m0, s28, 5120
    s_add_u32 s61, s30, 450624
    buffer_load_dwordx4 v7, s[80:83], s61 offen  lds
    s_add_u32 m0, s28, 6144
    s_add_u32 s61, s30, 471040
    buffer_load_dwordx4 v7, s[80:83], s61 offen  lds
    s_add_u32 m0, s28, 7168
    s_add_u32 s61, s30, 471104
    buffer_load_dwordx4 v7, s[80:83], s61 offen  lds
    s_waitcnt vmcnt(16)
    ds_read_b64_tr_b16 a[112:113], v4 offset:8192
    ds_read_b64_tr_b16 a[114:115], v4 offset:8704
    ds_read_b64_tr_b16 a[116:117], v4 offset:9216
    ds_read_b64_tr_b16 a[118:119], v4 offset:9728
    ds_read_b64_tr_b16 a[120:121], v4 offset:10240
    ds_read_b64_tr_b16 a[122:123], v4 offset:10752
    ds_read_b64_tr_b16 a[124:125], v4 offset:11264
    ds_read_b64_tr_b16 a[126:127], v4 offset:11776
    s_waitcnt lgkmcnt(0)
    s_add_u32 m0, s28, 8192
    s_add_u32 s61, s30, 491520
    buffer_load_dwordx4 v7, s[80:83], s61 offen  lds
    s_add_u32 m0, s28, 9216
    s_add_u32 s61, s30, 491584
    buffer_load_dwordx4 v7, s[80:83], s61 offen  lds
    s_add_u32 m0, s28, 10240
    s_add_u32 s61, s30, 512000
    buffer_load_dwordx4 v7, s[80:83], s61 offen  lds
    s_add_u32 m0, s28, 11264
    s_add_u32 s61, s30, 512064
    buffer_load_dwordx4 v7, s[80:83], s61 offen  lds
    s_waitcnt vmcnt(16)
    ds_read_b64_tr_b16 a[128:129], v4 offset:12288
    ds_read_b64_tr_b16 a[130:131], v4 offset:12800
    ds_read_b64_tr_b16 a[132:133], v4 offset:13312
    ds_read_b64_tr_b16 a[134:135], v4 offset:13824
    ds_read_b64_tr_b16 a[136:137], v4 offset:14336
    ds_read_b64_tr_b16 a[138:139], v4 offset:14848
    ds_read_b64_tr_b16 a[140:141], v4 offset:15360
    ds_read_b64_tr_b16 a[142:143], v4 offset:15872
    s_waitcnt lgkmcnt(0)
    s_add_u32 m0, s28, 12288
    s_add_u32 s61, s30, 532480
    buffer_load_dwordx4 v7, s[80:83], s61 offen  lds
    s_add_u32 m0, s28, 13312
    s_add_u32 s61, s30, 532544
    buffer_load_dwordx4 v7, s[80:83], s61 offen  lds
    s_waitcnt vmcnt(14)
    ds_read_b64_tr_b16 a[144:145], v4 offset:16384
    ds_read_b64_tr_b16 a[146:147], v4 offset:16896
    ds_read_b64_tr_b16 a[148:149], v4 offset:17408
    ds_read_b64_tr_b16 a[150:151], v4 offset:17920
    ds_read_b64_tr_b16 a[152:153], v4 offset:18432
    ds_read_b64_tr_b16 a[154:155], v4 offset:18944
    ds_read_b64_tr_b16 a[156:157], v4 offset:19456
    ds_read_b64_tr_b16 a[158:159], v4 offset:19968
    s_waitcnt lgkmcnt(0)
    s_waitcnt vmcnt(10)
    ds_read_b64_tr_b16 a[160:161], v4 offset:0
    ds_read_b64_tr_b16 a[162:163], v4 offset:512
    ds_read_b64_tr_b16 a[164:165], v4 offset:1024
    ds_read_b64_tr_b16 a[166:167], v4 offset:1536
    ds_read_b64_tr_b16 a[168:169], v4 offset:2048
    ds_read_b64_tr_b16 a[170:171], v4 offset:2560
    ds_read_b64_tr_b16 a[172:173], v4 offset:3072
    ds_read_b64_tr_b16 a[174:175], v4 offset:3584
    s_waitcnt lgkmcnt(0)
    s_waitcnt vmcnt(6)
    ds_read_b64_tr_b16 a[176:177], v4 offset:4096
    ds_read_b64_tr_b16 a[178:179], v4 offset:4608
    ds_read_b64_tr_b16 a[180:181], v4 offset:5120
    ds_read_b64_tr_b16 a[182:183], v4 offset:5632
    ds_read_b64_tr_b16 a[184:185], v4 offset:6144
    ds_read_b64_tr_b16 a[186:187], v4 offset:6656
    ds_read_b64_tr_b16 a[188:189], v4 offset:7168
    ds_read_b64_tr_b16 a[190:191], v4 offset:7680
    s_waitcnt lgkmcnt(0)
    s_waitcnt vmcnt(2)
    ds_read_b64_tr_b16 a[192:193], v4 offset:8192
    ds_read_b64_tr_b16 a[194:195], v4 offset:8704
    ds_read_b64_tr_b16 a[196:197], v4 offset:9216
    ds_read_b64_tr_b16 a[198:199], v4 offset:9728
    ds_read_b64_tr_b16 a[200:201], v4 offset:10240
    ds_read_b64_tr_b16 a[202:203], v4 offset:10752
    ds_read_b64_tr_b16 a[204:205], v4 offset:11264
    ds_read_b64_tr_b16 a[206:207], v4 offset:11776
    s_waitcnt lgkmcnt(0)
    s_waitcnt vmcnt(0)
    ds_read_b64_tr_b16 a[208:209], v4 offset:12288
    ds_read_b64_tr_b16 a[210:211], v4 offset:12800
    ds_read_b64_tr_b16 a[212:213], v4 offset:13312
    ds_read_b64_tr_b16 a[214:215], v4 offset:13824
    s_waitcnt lgkmcnt(0)
    s_barrier
    s_add_u32 m0, s38, 0
    s_add_u32 s62, s42, 0
    buffer_load_dwordx4 v5, s[84:87], s62 offen lds
    s_add_u32 m0, s38, 1024
    s_add_u32 s62, s42, 131072
    buffer_load_dwordx4 v5, s[84:87], s62 offen lds
    s_add_u32 s38, s38, 2048
    s_add_u32 s42, s42, 262144
    s_add_u32 s61, s35, 0
    buffer_load_dwordx4 v[72:75], v1, s[12:15], s61 offen offset:0
    buffer_load_dwordx4 v[76:79], v1, s[12:15], s61 offen offset:1024
    buffer_load_dwordx4 v[80:83], v1, s[12:15], s61 offen offset:2048
    buffer_load_dwordx4 v[84:87], v1, s[12:15], s61 offen offset:3072
    s_add_u32 s61, s35, 4096
    buffer_load_dwordx4 v[88:91], v1, s[12:15], s61 offen offset:0
    buffer_load_dwordx4 v[92:95], v1, s[12:15], s61 offen offset:1024
    buffer_load_dwordx4 v[96:99], v1, s[12:15], s61 offen offset:2048
    buffer_load_dwordx4 v[100:103], v1, s[12:15], s61 offen offset:3072
    s_add_u32 s61, s35, 8192
    buffer_load_dwordx4 v[104:107], v1, s[12:15], s61 offen offset:0
    buffer_load_dwordx4 v[108:111], v1, s[12:15], s61 offen offset:1024
    buffer_load_dwordx4 v[112:115], v1, s[12:15], s61 offen offset:2048
    buffer_load_dwordx4 v[116:119], v1, s[12:15], s61 offen offset:3072
    s_add_u32 s61, s35, 12288
    buffer_load_dwordx4 v[120:123], v1, s[12:15], s61 offen offset:0
    buffer_load_dwordx4 v[124:127], v1, s[12:15], s61 offen offset:1024
    buffer_load_dwordx4 v[128:131], v1, s[12:15], s61 offen offset:2048
    buffer_load_dwordx4 v[132:135], v1, s[12:15], s61 offen offset:3072
    s_add_u32 s61, s35, 16384
    buffer_load_dwordx4 v[136:139], v1, s[12:15], s61 offen offset:0
    buffer_load_dwordx4 v[140:143], v1, s[12:15], s61 offen offset:1024
    buffer_load_dwordx4 v[144:147], v1, s[12:15], s61 offen offset:2048
    buffer_load_dwordx4 v[148:151], v1, s[12:15], s61 offen offset:3072
    s_add_u32 s61, s35, 20480
    buffer_load_dwordx4 v[152:155], v1, s[12:15], s61 offen offset:0
    buffer_load_dwordx4 v[156:159], v1, s[12:15], s61 offen offset:1024
    buffer_load_dwordx4 v[160:163], v1, s[12:15], s61 offen offset:2048
    buffer_load_dwordx4 v[164:167], v1, s[12:15], s61 offen offset:3072
    s_add_u32 s61, s35, 24576
    buffer_load_dwordx4 v[168:171], v1, s[12:15], s61 offen offset:0
    buffer_load_dwordx4 v[172:175], v1, s[12:15], s61 offen offset:1024
    buffer_load_dwordx4 v[176:179], v1, s[12:15], s61 offen offset:2048
    s_add_u32 m0, s38, 0
    s_add_u32 s62, s42, 0
    buffer_load_dwordx4 v5, s[84:87], s62 offen lds
    s_add_u32 m0, s38, 1024
    s_add_u32 s62, s42, 131072
    buffer_load_dwordx4 v5, s[84:87], s62 offen lds
    s_add_u32 m0, s38, 2048
    s_add_u32 s62, s42, 262144
    buffer_load_dwordx4 v5, s[84:87], s62 offen lds
    s_add_u32 m0, s38, 3072
    s_add_u32 s62, s42, 393216
    buffer_load_dwordx4 v5, s[84:87], s62 offen lds
    s_add_u32 m0, s38, 4096
    s_add_u32 s62, s42, 524288
    buffer_load_dwordx4 v5, s[84:87], s62 offen lds
    buffer_load_dword v15, v184, s[84:87], s42 offen
    buffer_load_dword v14, v2, s[12:15], s35 offen
    buffer_load_dword v14, v2, s[12:15], s35 offen
H_f2:
    s_add_u32 s60, s25, 1
    s_cmp_lt_u32 s60, s24
    s_cselect_b32 s60, 331776, 0
    s_add_u32 s35, s35, s60
    s_cmp_lt_u32 s25, 5
    s_cselect_b32 s60, 655360, 0
    s_cselect_b32 s62, 5120, 0
    s_add_u32 s42, s42, s60
    s_add_u32 s38, s38, s62
    s_waitcnt vmcnt(34)
    v_mfma_f32_32x32x16_bf16 v[40:55], a[0:3], v[72:75], 0
    v_mfma_f32_32x32x16_bf16 v[56:71], a[4:7], v[72:75], 0
    s_add_u32 s61, s35, 0
    buffer_load_dwordx4 v[72:75], v1, s[12:15], s61 offen offset:0
    s_waitcnt vmcnt(34)
    v_mfma_f32_32x32x16_bf16 v[40:55], a[8:11], v[76:79], v[40:55]
    v_mfma_f32_32x32x16_bf16 v[56:71], a[12:15], v[76:79], v[56:71]
    buffer_load_dwordx4 v[76:79], v1, s[12:15], s61 offen offset:1024
    s_waitcnt vmcnt(34)
    v_mfma_f32_32x32x16_bf16 v[40:55], a[16:19], v[80:83], v[40:55]
    v_mfma_f32_32x32x16_bf16 v[56:71], a[20:23], v[80:83], v[56:71]
    buffer_load_dwordx4 v[80:83], v1, s[12:15], s61 offen offset:2048
    s_waitcnt vmcnt(34)
    v_mfma_f32_32x32x16_bf16 v[40:55], a[24:27], v[84:87], v[40:55]
    v_mfma_f32_32x32x16_bf16 v[56:71], a[28:31], v[84:87], v[56:71]
    buffer_load_dwordx4 v[84:87], v1, s[12:15], s61 offen offset:3072
    s_waitcnt vmcnt(34)
    v_mfma_f32_32x32x16_bf16 v[40:55], a[32:35], v[88:91], v[40:55]
    v_mfma_f32_32x32x16_bf16 v[56:71], a[36:39], v[88:91], v[56:71]
    s_add_u32 s61, s35, 4096
    buffer_load_dwordx4 v[88:91], v1, s[12:15], s61 offen offset:0
    s_waitcnt vmcnt(34)
    v_mfma_f32_32x32x16_bf16 v[40:55], a[40:43], v[92:95], v[40:55]
    v_mfma_f32_32x32x16_bf16 v[56:71], a[44:47], v[92:95], v[56:71]
    buffer_load_dwordx4 v[92:95], v1, s[12:15], s61 offen offset:1024
    s_waitcnt vmcnt(34)
    v_mfma_f32_32x32x16_bf16 v[40:55], a[48:51], v[96:99], v[40:55]
    v_mfma_f32_32x32x16_bf16 v[56:71], a[52:55], v[96:99], v[56:71]
    buffer_load_dwordx4 v[96:99], v1, s[12:15], s61 offen offset:2048
    s_waitcnt vmcnt(34)
    v_mfma_f32_32x32x16_bf16 v[40:55], a[56:59], v[100:103], v[40:55]
    v_mfma_f32_32x32x16_bf16 v[56:71], a[60:63], v[100:103], v[56:71]
    buffer_load_dwordx4 v[100:103], v1, s[12:15], s61 offen offset:3072
    s_waitcnt vmcnt(34)
    v_mfma_f32_32x32x16_bf16 v[40:55], a[64:67], v[104:107], v[40:55]
    v_mfma_f32_32x32x16_bf16 v[56:71], a[68:71], v[104:107], v[56:71]
    s_add_u32 s61, s35, 8192
    buffer_load_dwordx4 v[104:107], v1, s[12:15], s61 offen offset:0
    s_waitcnt vmcnt(34)
    v_mfma_f32_32x32x16_bf16 v[40:55], a[72:75], v[108:111], v[40:55]
    v_mfma_f32_32x32x16_bf16 v[56:71], a[76:79], v[108:111], v[56:71]
    buffer_load_dwordx4 v[108:111], v1, s[12:15], s61 offen offset:1024
    s_waitcnt vmcnt(34)
    v_mfma_f32_32x32x16_bf16 v[40:55], a[80:83], v[112:115], v[40:55]
    v_mfma_f32_32x32x16_bf16 v[56:71], a[84:87], v[112:115], v[56:71]
    buffer_load_dwordx4 v[112:115], v1, s[12:15], s61 offen offset:2048
    s_waitcnt vmcnt(34)
    v_mfma_f32_32x32x16_bf16 v[40:55], a[88:91], v[116:119], v[40:55]
    v_mfma_f32_32x32x16_bf16 v[56:71], a[92:95], v[116:119], v[56:71]
    buffer_load_dwordx4 v[116:119], v1, s[12:15], s61 offen offset:3072
    s_waitcnt vmcnt(34)
    v_mfma_f32_32x32x16_bf16 v[40:55], a[96:99], v[120:123], v[40:55]
    v_mfma_f32_32x32x16_bf16 v[56:71], a[100:103], v[120:123], v[56:71]
    s_add_u32 s61, s35, 12288
    buffer_load_dwordx4 v[120:123], v1, s[12:15], s61 offen offset:0
    s_waitcnt vmcnt(34)
    v_mfma_f32_32x32x16_bf16 v[40:55], a[104:107], v[124:127], v[40:55]
    v_mfma_f32_32x32x16_bf16 v[56:71], a[108:111], v[124:127], v[56:71]
    buffer_load_dwordx4 v[124:127], v1, s[12:15], s61 offen offset:1024
    s_waitcnt vmcnt(34)
    v_mfma_f32_32x32x16_bf16 v[40:55], a[112:115], v[128:131], v[40:55]
    v_mfma_f32_32x32x16_bf16 v[56:71], a[116:119], v[128:131], v[56:71]
    buffer_load_dwordx4 v[128:131], v1, s[12:15], s61 offen offset:2048
    s_waitcnt vmcnt(34)
    v_mfma_f32_32x32x16_bf16 v[40:55], a[120:123], v[132:135], v[40:55]
    v_mfma_f32_32x32x16_bf16 v[56:71], a[124:127], v[132:135], v[56:71]
    buffer_load_dwordx4 v[132:135], v1, s[12:15], s61 offen offset:3072
    s_waitcnt vmcnt(34)
    v_mfma_f32_32x32x16_bf16 v[40:55], a[128:131], v[136:139], v[40:55]
    v_mfma_f32_32x32x16_bf16 v[56:71], a[132:135], v[136:139], v[56:71]
    s_add_u32 s61, s35, 16384
    buffer_load_dwordx4 v[136:139], v1, s[12:15], s61 offen offset:0
    s_waitcnt vmcnt(34)
    v_mfma_f32_32x32x16_bf16 v[40:55], a[136:139], v[140:143], v[40:55]
    v_mfma_f32_32x32x16_bf16 v[56:71], a[140:143], v[140:143], v[56:71]
    buffer_load_dwordx4 v[140:143], v1, s[12:15], s61 offen offset:1024
    s_waitcnt vmcnt(34)
    v_mfma_f32_32x32x16_bf16 v[40:55], a[144:147], v[144:147], v[40:55]
    v_mfma_f32_32x32x16_bf16 v[56:71], a[148:151], v[144:147], v[56:71]
    buffer_load_dwordx4 v[144:147], v1, s[12:15], s61 offen offset:2048
    s_waitcnt vmcnt(34)
    v_mfma_f32_32x32x16_bf16 v[40:55], a[152:155], v[148:151], v[40:55]
    v_mfma_f32_32x32x16_bf16 v[56:71], a[156:159], v[148:151], v[56:71]
    buffer_load_dwordx4 v[148:151], v1, s[12:15], s61 offen offset:3072
    s_waitcnt vmcnt(34)
    v_mfma_f32_32x32x16_bf16 v[40:55], a[160:163], v[152:155], v[40:55]
    v_mfma_f32_32x32x16_bf16 v[56:71], a[164:167], v[152:155], v[56:71]
    s_add_u32 s61, s35, 20480
    buffer_load_dwordx4 v[152:155], v1, s[12:15], s61 offen offset:0
    s_waitcnt vmcnt(34)
    v_mfma_f32_32x32x16_bf16 v[40:55], a[168:171], v[156:159], v[40:55]
    v_mfma_f32_32x32x16_bf16 v[56:71], a[172:175], v[156:159], v[56:71]
    buffer_load_dwordx4 v[156:159], v1, s[12:15], s61 offen offset:1024
    s_waitcnt vmcnt(34)
    v_mfma_f32_32x32x16_bf16 v[40:55], a[176:179], v[160:163], v[40:55]
    v_mfma_f32_32x32x16_bf16 v[56:71], a[180:183], v[160:163], v[56:71]
    buffer_load_dwordx4 v[160:163], v1, s[12:15], s61 offen offset:2048
    s_waitcnt vmcnt(34)
    v_mfma_f32_32x32x16_bf16 v[40:55], a[184:187], v[164:167], v[40:55]
    v_mfma_f32_32x32x16_bf16 v[56:71], a[188:191], v[164:167], v[56:71]
    buffer_load_dwordx4 v[164:167], v1, s[12:15], s61 offen offset:3072
    s_waitcnt vmcnt(34)
    v_mfma_f32_32x32x16_bf16 v[40:55], a[192:195], v[168:171], v[40:55]
    v_mfma_f32_32x32x16_bf16 v[56:71], a[196:199], v[168:171], v[56:71]
    s_add_u32 s61, s35, 24576
    buffer_load_dwordx4 v[168:171], v1, s[12:15], s61 offen offset:0
    s_waitcnt vmcnt(34)
    v_mfma_f32_32x32x16_bf16 v[40:55], a[200:203], v[172:175], v[40:55]
    v_mfma_f32_32x32x16_bf16 v[56:71], a[204:207], v[172:175], v[56:71]
    buffer_load_dwordx4 v[172:175], v1, s[12:15], s61 offen offset:1024
    s_waitcnt vmcnt(34)
    v_mfma_f32_32x32x16_bf16 v[40:55], a[208:211], v[176:179], v[40:55]
    v_mfma_f32_32x32x16_bf16 v[56:71], a[212:215], v[176:179], v[56:71]
    buffer_load_dwordx4 v[176:179], v1, s[12:15], s61 offen offset:2048
    s_add_u32 m0, s38, 0
    s_add_u32 s62, s42, 0
    buffer_load_dwordx4 v5, s[84:87], s62 offen lds
    ds_write_b128 v180, v[40:43] offset:0
    ds_write_b128 v180, v[44:47] offset:1024
    ds_write_b128 v180, v[48:51] offset:2048
    ds_write_b128 v180, v[52:55] offset:3072
    s_nop 3
    ds_write_b128 v180, v[56:59] offset:16384
    ds_write_b128 v180, v[60:63] offset:17408
    ds_write_b128 v180, v[64:67] offset:18432
    ds_write_b128 v180, v[68:71] offset:19456
    s_add_u32 m0, s38, 1024
    s_add_u32 s62, s42, 131072
    buffer_load_dwordx4 v5, s[84:87], s62 offen lds
    s_add_u32 m0, s38, 2048
    s_add_u32 s62, s42, 262144
    buffer_load_dwordx4 v5, s[84:87], s62 offen lds
    s_waitcnt lgkmcnt(0)
    s_barrier
    ds_read_b128 v[40:43], v181 offset:0
    ds_read_b128 v[44:47], v181 offset:4096
    ds_read_b128 v[48:51], v181 offset:8192
    ds_read_b128 v[52:55], v181 offset:12288
    ds_read_b128 v[56:59], v181 offset:16384
    ds_read_b128 v[60:63], v181 offset:20480
    ds_read_b128 v[64:67], v181 offset:24576
    ds_read_b128 v[68:71], v181 offset:28672
    s_add_u32 m0, s38, 3072
    s_add_u32 s62, s42, 393216
    buffer_load_dwordx4 v5, s[84:87], s62 offen lds
    s_add_u32 m0, s38, 4096
    s_add_u32 s62, s42, 524288
    buffer_load_dwordx4 v5, s[84:87], s62 offen lds
    s_waitcnt lgkmcnt(0)
    s_barrier
    buffer_load_dword v15, v184, s[84:87], s42 offen
    v_add_f32 v40, v40, v44
    v_add_f32 v48, v48, v52
    v_add_f32 v41, v41, v45
    v_add_f32 v49, v49, v53
    v_add_f32 v42, v42, v46
    v_add_f32 v50, v50, v54
    v_add_f32 v43, v43, v47
    v_add_f32 v51, v51, v55
    v_add_f32 v40, v40, v48
    v_add_f32 v41, v41, v49
    v_add_f32 v42, v42, v50
    v_add_f32 v43, v43, v51
    v_add_f32 v56, v56, v60
    v_add_f32 v64, v64, v68
    v_add_f32 v57, v57, v61
    v_add_f32 v65, v65, v69
    v_add_f32 v58, v58, v62
    v_add_f32 v66, v66, v70
    v_add_f32 v59, v59, v63
    v_add_f32 v67, v67, v71
    v_add_f32 v56, v56, v64
    v_add_f32 v57, v57, v65
    v_add_f32 v58, v58, v66
    v_add_f32 v59, v59, v67
    v_mul_f32 v44, s39, v40
    v_mul_f32 v45, s39, v41
    v_mul_f32 v46, s39, v42
    v_mul_f32 v47, s39, v43
    v_mul_f32 v60, s39, v56
    v_mul_f32 v61, s39, v57
    v_mul_f32 v62, s39, v58
    v_mul_f32 v63, s39, v59
    v_exp_f32 v44, v44
    v_exp_f32 v45, v45
    v_exp_f32 v46, v46
    v_exp_f32 v47, v47
    v_exp_f32 v60, v60
    v_exp_f32 v61, v61
    v_exp_f32 v62, v62
    v_exp_f32 v63, v63
    v_add_f32 v44, 1.0, v44
    v_add_f32 v45, 1.0, v45
    v_add_f32 v46, 1.0, v46
    v_add_f32 v47, 1.0, v47
    v_add_f32 v60, 1.0, v60
    v_add_f32 v61, 1.0, v61
    v_add_f32 v62, 1.0, v62
    v_add_f32 v63, 1.0, v63
    v_rcp_f32 v44, v44
    v_rcp_f32 v45, v45
    v_rcp_f32 v46, v46
    v_rcp_f32 v47, v47
    v_rcp_f32 v60, v60
    v_rcp_f32 v61, v61
    v_rcp_f32 v62, v62
    v_rcp_f32 v63, v63
    v_mul_f32 v40, v40, v44
    v_mul_f32 v41, v41, v45
    v_mul_f32 v42, v42, v46
    v_mul_f32 v43, v43, v47
    v_mul_f32 v56, v56, v60
    v_mul_f32 v57, v57, v61
    v_mul_f32 v58, v58, v62
    v_mul_f32 v59, v59, v63
    v_cvt_pk_bf16_f32 v16, v40, v41
    v_cvt_pk_bf16_f32 v17, v42, v43
    v_cvt_pk_bf16_f32 v18, v56, v57
    v_cvt_pk_bf16_f32 v19, v58, v59
    buffer_store_dwordx2 v[16:17], v182, s[12:15], s53 offen offset:0
    buffer_store_dwordx2 v[18:19], v182, s[12:15], s53 offen offset:2048
    s_add_u32 s53, s53, 491520
    s_add_u32 s25, s25, 1
    s_cmp_lt_u32 s25, s24
    s_cbranch_scc1 H_f2
    s_waitcnt vmcnt(0)
    s_barrier
    s_branch H_f2e
H_q:
    s_add_u32 m0, s38, 0
    s_add_u32 s62, s42, 0
    buffer_load_dwordx4 v5, s[84:87], s62 offen lds
    s_waitcnt vmcnt(2)
    s_add_u32 m0, s38, 1024
    s_add_u32 s62, s42, 131072
    buffer_load_dwordx4 v5, s[84:87], s62 offen lds
    s_waitcnt vmcnt(2)
    s_add_u32 m0, s38, 2048
    s_add_u32 s62, s42, 262144
    buffer_load_dwordx4 v5, s[84:87], s62 offen lds
    s_waitcnt vmcnt(2)
    s_add_u32 m0, s38, 3072
    s_add_u32 s62, s42, 393216
    buffer_load_dwordx4 v5, s[84:87], s62 offen lds
    s_waitcnt vmcnt(2)
    s_add_u32 m0, s38, 4096
    s_add_u32 s62, s42, 524288
    buffer_load_dwordx4 v5, s[84:87], s62 offen lds
    s_waitcnt vmcnt(2)
    s_add_u32 m0, s38, 5120
    s_add_u32 s62, s42, 655360
    buffer_load_dwordx4 v5, s[84:87], s62 offen lds
    s_waitcnt vmcnt(2)
    s_add_u32 m0, s38, 6144
    s_add_u32 s62, s42, 786432
    buffer_load_dwordx4 v5, s[84:87], s62 offen lds
    s_waitcnt vmcnt(2)
    s_add_u32 m0, s38, 7168
    s_add_u32 s62, s42, 917504
    buffer_load_dwordx4 v5, s[84:87], s62 offen lds
    s_waitcnt vmcnt(2)
    s_add_u32 m0, s38, 8192
    s_add_u32 s62, s42, 1048576
    buffer_load_dwordx4 v5, s[84:87], s62 offen lds
    s_waitcnt vmcnt(2)
    s_add_u32 m0, s38, 9216
    s_add_u32 s62, s42, 1179648
    buffer_load_dwordx4 v5, s[84:87], s62 offen lds
    s_waitcnt vmcnt(2)
    s_add_u32 m0, s38, 10240
    s_add_u32 s62, s42, 1310720
    buffer_load_dwordx4 v5, s[84:87], s62 offen lds
    s_waitcnt vmcnt(2)
    s_add_u32 m0, s38, 11264
    s_add_u32 s62, s42, 1441792
    buffer_load_dwordx4 v5, s[84:87], s62 offen lds
    s_waitcnt vmcnt(2)
    s_add_u32 m0, s38, 12288
    s_add_u32 s62, s42, 1572864
    buffer_load_dwordx4 v5, s[84:87], s62 offen lds
    s_waitcnt vmcnt(2)
    s_add_u32 m0, s38, 13312
    s_add_u32 s62, s42, 1703936
    buffer_load_dwordx4 v5, s[84:87], s62 offen lds
    s_waitcnt vmcnt(2)
    s_add_u32 m0, s38, 14336
    s_add_u32 s62, s42, 1835008
    buffer_load_dwordx4 v5, s[84:87], s62 offen lds
    s_waitcnt vmcnt(2)
    s_add_u32 m0, s38, 15360
    s_add_u32 s62, s42, 1966080
    buffer_load_dwordx4 v5, s[84:87], s62 offen lds
    s_waitcnt vmcnt(2)
    s_add_u32 m0, s38, 16384
    s_add_u32 s62, s42, 2097152
    buffer_load_dwordx4 v5, s[84:87], s62 offen lds
    s_waitcnt vmcnt(2)
    s_add_u32 m0, s38, 17408
    s_add_u32 s62, s42, 2228224
    buffer_load_dwordx4 v5, s[84:87], s62 offen lds
    s_waitcnt vmcnt(2)
    s_add_u32 m0, s38, 18432
    s_add_u32 s62, s42, 2359296
    buffer_load_dwordx4 v5, s[84:87], s62 offen lds
    s_waitcnt vmcnt(2)
    s_add_u32 m0, s38, 19456
    s_add_u32 s62, s42, 2490368
    buffer_load_dwordx4 v5, s[84:87], s62 offen lds
    s_waitcnt vmcnt(2)
    s_add_u32 m0, s38, 20480
    s_add_u32 s62, s42, 2621440
    buffer_load_dwordx4 v5, s[84:87], s62 offen lds
    s_waitcnt vmcnt(2)
    s_add_u32 m0, s38, 21504
    s_add_u32 s62, s42, 2752512
    buffer_load_dwordx4 v5, s[84:87], s62 offen lds
    s_waitcnt vmcnt(2)
    s_add_u32 m0, s38, 22528
    s_add_u32 s62, s42, 2883584
    buffer_load_dwordx4 v5, s[84:87], s62 offen lds
    s_waitcnt vmcnt(2)
    s_add_u32 m0, s38, 23552
    s_add_u32 s62, s42, 3014656
    buffer_load_dwordx4 v5, s[84:87], s62 offen lds
    s_waitcnt vmcnt(2)
    s_add_u32 m0, s38, 24576
    s_add_u32 s62, s42, 3145728
    buffer_load_dwordx4 v5, s[84:87], s62 offen lds
    s_waitcnt vmcnt(2)
    s_add_u32 m0, s38, 25600
    s_add_u32 s62, s42, 3276800
    buffer_load_dwordx4 v5, s[84:87], s62 offen lds
    s_waitcnt vmcnt(2)
    s_add_u32 m0, s38, 26624
    s_add_u32 s62, s42, 3407872
    buffer_load_dwordx4 v5, s[84:87], s62 offen lds
    s_waitcnt vmcnt(2)
    s_add_u32 m0, s38, 27648
    s_add_u32 s62, s42, 3538944
    buffer_load_dwordx4 v5, s[84:87], s62 offen lds
    s_waitcnt vmcnt(2)
    s_add_u32 m0, s38, 28672
    s_add_u32 s62, s42, 3670016
    buffer_load_dwordx4 v5, s[84:87], s62 offen lds
    s_waitcnt vmcnt(2)
    s_add_u32 m0, s38, 29696
    s_add_u32 s62, s42, 3801088
    buffer_load_dwordx4 v5, s[84:87], s62 offen lds
    s_waitcnt vmcnt(2)
    s_add_u32 m0, s38, 30720
    s_add_u32 s62, s42, 3932160
    buffer_load_dwordx4 v5, s[84:87], s62 offen lds
    s_waitcnt vmcnt(2)
    s_add_u32 m0, s38, 31744
    s_add_u32 s62, s42, 4063232
    buffer_load_dwordx4 v5, s[84:87], s62 offen lds
    s_waitcnt vmcnt(2)
    s_waitcnt vmcnt(0)
H_f2e:
    s_waitcnt lgkmcnt(0)
    v_mov_b32 v14, 1
    s_mov_b64 exec, s[54:55]
    buffer_store_dword v14, off, s[12:15], s20 offset:256
    s_mov_b64 exec, -1
    ds_read_b64_tr_b16 a[0:1], v185 offset:0
    ds_read_b64_tr_b16 a[2:3], v185 offset:256
    ds_read_b64_tr_b16 a[8:9], v185 offset:1024
    ds_read_b64_tr_b16 a[10:11], v185 offset:1280
    ds_read_b64_tr_b16 a[16:17], v185 offset:2048
    ds_read_b64_tr_b16 a[18:19], v185 offset:2304
    ds_read_b64_tr_b16 a[24:25], v185 offset:3072
    ds_read_b64_tr_b16 a[26:27], v185 offset:3328
    ds_read_b64_tr_b16 a[32:33], v185 offset:4096
    ds_read_b64_tr_b16 a[34:35], v185 offset:4352
    ds_read_b64_tr_b16 a[40:41], v185 offset:5120
    ds_read_b64_tr_b16 a[42:43], v185 offset:5376
    ds_read_b64_tr_b16 a[48:49], v185 offset:6144
    ds_read_b64_tr_b16 a[50:51], v185 offset:6400
    ds_read_b64_tr_b16 a[56:57], v185 offset:7168
    ds_read_b64_tr_b16 a[58:59], v185 offset:7424
    ds_read_b64_tr_b16 a[64:65], v185 offset:8192
    ds_read_b64_tr_b16 a[66:67], v185 offset:8448
    ds_read_b64_tr_b16 a[72:73], v185 offset:9216
    ds_read_b64_tr_b16 a[74:75], v185 offset:9472
    ds_read_b64_tr_b16 a[80:81], v185 offset:10240
    ds_read_b64_tr_b16 a[82:83], v185 offset:10496
    ds_read_b64_tr_b16 a[88:89], v185 offset:11264
    ds_read_b64_tr_b16 a[90:91], v185 offset:11520
    ds_read_b64_tr_b16 a[96:97], v185 offset:12288
    ds_read_b64_tr_b16 a[98:99], v185 offset:12544
    ds_read_b64_tr_b16 a[104:105], v185 offset:13312
    ds_read_b64_tr_b16 a[106:107], v185 offset:13568
    ds_read_b64_tr_b16 a[112:113], v185 offset:14336
    ds_read_b64_tr_b16 a[114:115], v185 offset:14592
    ds_read_b64_tr_b16 a[120:121], v185 offset:15360
    ds_read_b64_tr_b16 a[122:123], v185 offset:15616
    ds_read_b64_tr_b16 a[128:129], v185 offset:16384
    ds_read_b64_tr_b16 a[130:131], v185 offset:16640
    ds_read_b64_tr_b16 a[136:137], v185 offset:17408
    ds_read_b64_tr_b16 a[138:139], v185 offset:17664
    ds_read_b64_tr_b16 a[144:145], v185 offset:18432
    ds_read_b64_tr_b16 a[146:147], v185 offset:18688
    ds_read_b64_tr_b16 a[152:153], v185 offset:19456
    ds_read_b64_tr_b16 a[154:155], v185 offset:19712
    ds_read_b64_tr_b16 a[160:161], v185 offset:20480
    ds_read_b64_tr_b16 a[162:163], v185 offset:20736
    ds_read_b64_tr_b16 a[168:169], v185 offset:21504
    ds_read_b64_tr_b16 a[170:171], v185 offset:21760
    ds_read_b64_tr_b16 a[176:177], v185 offset:22528
    ds_read_b64_tr_b16 a[178:179], v185 offset:22784
    ds_read_b64_tr_b16 a[184:185], v185 offset:23552
    ds_read_b64_tr_b16 a[186:187], v185 offset:23808
    ds_read_b64_tr_b16 a[192:193], v185 offset:24576
    ds_read_b64_tr_b16 a[194:195], v185 offset:24832
    ds_read_b64_tr_b16 a[200:201], v185 offset:25600
    ds_read_b64_tr_b16 a[202:203], v185 offset:25856
    ds_read_b64_tr_b16 a[208:209], v185 offset:26624
    ds_read_b64_tr_b16 a[210:211], v185 offset:26880
    ds_read_b64_tr_b16 a[216:217], v185 offset:27648
    ds_read_b64_tr_b16 a[218:219], v185 offset:27904
    ds_read_b64_tr_b16 a[224:225], v185 offset:28672
    ds_read_b64_tr_b16 a[226:227], v185 offset:28928
    ds_read_b64_tr_b16 a[232:233], v185 offset:29696
    ds_read_b64_tr_b16 a[234:235], v185 offset:29952
    ds_read_b64_tr_b16 a[240:241], v185 offset:30720
    ds_read_b64_tr_b16 a[242:243], v185 offset:30976
    ds_read_b64_tr_b16 a[248:249], v185 offset:31744
    ds_read_b64_tr_b16 a[250:251], v185 offset:32000
    s_waitcnt lgkmcnt(0)
    s_barrier
    s_load_dwordx2 s[76:77], s[0:1], 40
    s_mov_b32 s78, 5242880
    s_mov_b32 s79, 0x00020000
    s_load_dwordx2 s[80:81], s[0:1], 80
    s_mov_b32 s82, 2621440
    s_mov_b32 s83, 0x00020000
    s_mov_b32 s8, s50
    s_mov_b32 s9, s51
    s_lshl_b32 s30, s9, 8
    s_lshl_b32 s60, s10, 6
    s_add_u32 s30, s30, s60
    s_mul_i32 s38, s9, 163840
    s_mul_i32 s60, s10, 320
    s_add_u32 s38, s38, s60
    s_lshl_b32 s27, s9, 14
    s_add_u32 s27, s27, 5120
    s_add_u32 s27, s27, s21
    s_waitcnt lgkmcnt(0)
    s_mov_b32 s23, s8
    s_mov_b32 s25, 0
    s_mul_i32 s31, s8, 40960
    s_add_u32 s31, s31, 4194304
    s_mov_b32 s32, s29
    s_mov_b32 s33, 40960
    s_add_u32 m0, s32, 0
    s_nop 0
    buffer_load_dwordx4 v8, s[12:15], s31 offen offset:0 lds
    s_add_u32 m0, s32, 3968
    s_nop 0
    buffer_load_dwordx4 v8, s[12:15], s31 offen offset:128 lds
    s_add_u32 m0, s32, 7936
    s_nop 0
    buffer_load_dwordx4 v8, s[12:15], s31 offen offset:256 lds
    s_add_u32 m0, s32, 11904
    s_nop 0
    buffer_load_dwordx4 v8, s[12:15], s31 offen offset:384 lds
    s_add_u32 m0, s32, 15872
    s_nop 0
    buffer_load_dwordx4 v8, s[12:15], s31 offen offset:512 lds
    s_add_u32 m0, s32, 19840
    s_nop 0
    buffer_load_dwordx4 v8, s[12:15], s31 offen offset:640 lds
    s_add_u32 m0, s32, 23808
    s_nop 0
    buffer_load_dwordx4 v8, s[12:15], s31 offen offset:768 lds
    s_add_u32 m0, s32, 27776
    s_nop 0
    buffer_load_dwordx4 v8, s[12:15], s31 offen offset:896 lds
    s_add_u32 m0, s32, 31744
    s_nop 0
    buffer_load_dwordx4 v8, s[12:15], s31 offen offset:1024 lds
    s_add_u32 m0, s32, 35712
    s_nop 0
    buffer_load_dwordx4 v8, s[12:15], s31 offen offset:1152 lds
    s_mul_i32 s42, s8, 1769472
    s_add_u32 s42, s42, 67108864
    s_lshl_b32 s35, s10, 5
    s_add_u32 s35, s35, s9
    s_cmp_lt_u32 s35, 80
    s_cselect_b32 s37, 1, 0
    s_cselect_b32 s35, s35, 0
    s_mul_i32 s36, s35, 17408
    s_add_u32 s36, s36, s42
    v_lshlrev_b32 v18, 6, v0
    v_lshrrev_b32 v16, 2, v0
    v_and_b32 v17, 3, v0
    v_lshlrev_b32 v17, 6, v17
    v_lshl_add_u32 v16, v16, 13, v17
    s_lshl_b32 s60, s10, 17
    s_lshl_b32 s61, s9, 8
    s_add_u32 s60, s60, s61
    v_add_u32 v16, s60, v16
    s_mul_i32 s60, s9, 163840
    s_lshl_b32 s61, s10, 12
    s_add_u32 s60, s60, s61
    v_lshl_add_u32 v17, v0, 6, s60
    s_mov_b32 s61, 4194304
    buffer_load_dword v14, v16, s[84:87], s61 offen
    s_mov_b32 s61, 4718592
    buffer_load_dword v14, v16, s[84:87], s61 offen
    s_mov_b32 s61, 0
    buffer_load_dword v14, v17, s[76:79], s61 offen
    s_add_u32 m0, s28, 0
    s_add_u32 s61, s30, 4194304
    buffer_load_dwordx4 v5, s[84:87], s61 offen  lds
    s_add_u32 m0, s28, 1024
    s_add_u32 s61, s30, 4325376
    buffer_load_dwordx4 v5, s[84:87], s61 offen  lds
    s_add_u32 m0, s28, 2048
    s_add_u32 s61, s30, 4456448
    buffer_load_dwordx4 v5, s[84:87], s61 offen  lds
    s_add_u32 m0, s28, 3072
    s_add_u32 s61, s30, 4587520
    buffer_load_dwordx4 v5, s[84:87], s61 offen  lds
    s_waitcnt vmcnt(0)
    ds_read_b64_tr_b16 v[192:193], v3 offset:0
    ds_read_b64_tr_b16 v[194:195], v3 offset:256
    ds_read_b64_tr_b16 v[200:201], v3 offset:1024
    ds_read_b64_tr_b16 v[202:203], v3 offset:1280
    ds_read_b64_tr_b16 v[208:209], v3 offset:2048
    ds_read_b64_tr_b16 v[210:211], v3 offset:2304
    ds_read_b64_tr_b16 v[216:217], v3 offset:3072
    ds_read_b64_tr_b16 v[218:219], v3 offset:3328
    s_waitcnt lgkmcnt(0)
    s_mov_b32 s61, 16384
    buffer_load_dword v14, v17, s[76:79], s61 offen
    s_add_u32 m0, s28, 0
    s_add_u32 s61, s30, 4718592
    buffer_load_dwordx4 v5, s[84:87], s61 offen  lds
    s_add_u32 m0, s28, 1024
    s_add_u32 s61, s30, 4849664
    buffer_load_dwordx4 v5, s[84:87], s61 offen  lds
    s_add_u32 m0, s28, 2048
    s_add_u32 s61, s30, 4980736
    buffer_load_dwordx4 v5, s[84:87], s61 offen  lds
    s_add_u32 m0, s28, 3072
    s_add_u32 s61, s30, 5111808
    buffer_load_dwordx4 v5, s[84:87], s61 offen  lds
    s_waitcnt vmcnt(0)
    ds_read_b64_tr_b16 v[224:225], v3 offset:0
    ds_read_b64_tr_b16 v[226:227], v3 offset:256
    ds_read_b64_tr_b16 v[232:233], v3 offset:1024
    ds_read_b64_tr_b16 v[234:235], v3 offset:1280
    ds_read_b64_tr_b16 v[240:241], v3 offset:2048
    ds_read_b64_tr_b16 v[242:243], v3 offset:2304
    ds_read_b64_tr_b16 v[248:249], v3 offset:3072
    ds_read_b64_tr_b16 v[250:251], v3 offset:3328
    s_waitcnt lgkmcnt(0)
    s_mov_b32 s61, 32768
    buffer_load_dword v14, v17, s[76:79], s61 offen
    s_add_u32 m0, s28, 0
    s_add_u32 s61, s38, 0
    buffer_load_dwordx4 v7, s[76:79], s61 offen  lds
    s_add_u32 m0, s28, 1024
    s_add_u32 s61, s38, 64
    buffer_load_dwordx4 v7, s[76:79], s61 offen  lds
    s_add_u32 m0, s28, 2048
    s_add_u32 s61, s38, 128
    buffer_load_dwordx4 v7, s[76:79], s61 offen  lds
    s_add_u32 m0, s28, 3072
    s_add_u32 s61, s38, 192
    buffer_load_dwordx4 v7, s[76:79], s61 offen  lds
    s_waitcnt vmcnt(0)
    ds_read_b64_tr_b16 a[4:5], v4 offset:0
    ds_read_b64_tr_b16 a[6:7], v4 offset:512
    ds_read_b64_tr_b16 a[12:13], v4 offset:1024
    ds_read_b64_tr_b16 a[14:15], v4 offset:1536
    ds_read_b64_tr_b16 a[20:21], v4 offset:2048
    ds_read_b64_tr_b16 a[22:23], v4 offset:2560
    ds_read_b64_tr_b16 a[28:29], v4 offset:3072
    ds_read_b64_tr_b16 a[30:31], v4 offset:3584
    s_waitcnt lgkmcnt(0)
    s_mov_b32 s61, 49152
    buffer_load_dword v14, v17, s[76:79], s61 offen
    s_add_u32 m0, s28, 0
    s_add_u32 s61, s38, 256
    buffer_load_dwordx4 v7, s[76:79], s61 offen  lds
    s_add_u32 m0, s28, 1024
    s_add_u32 s61, s38, 20480
    buffer_load_dwordx4 v7, s[76:79], s61 offen  lds
    s_add_u32 m0, s28, 2048
    s_add_u32 s61, s38, 20544
    buffer_load_dwordx4 v7, s[76:79], s61 offen  lds
    s_add_u32 m0, s28, 3072
    s_add_u32 s61, s38, 20608
    buffer_load_dwordx4 v7, s[76:79], s61 offen  lds
    s_waitcnt vmcnt(0)
    ds_read_b64_tr_b16 a[36:37], v4 offset:0
    ds_read_b64_tr_b16 a[38:39], v4 offset:512
    ds_read_b64_tr_b16 a[44:45], v4 offset:1024
    ds_read_b64_tr_b16 a[46:47], v4 offset:1536
    ds_read_b64_tr_b16 a[52:53], v4 offset:2048
    ds_read_b64_tr_b16 a[54:55], v4 offset:2560
    ds_read_b64_tr_b16 a[60:61], v4 offset:3072
    ds_read_b64_tr_b16 a[62:63], v4 offset:3584
    s_waitcnt lgkmcnt(0)
    s_mov_b32 s61, 65536
    buffer_load_dword v14, v17, s[76:79], s61 offen
    s_add_u32 m0, s28, 0
    s_add_u32 s61, s38, 20672
    buffer_load_dwordx4 v7, s[76:79], s61 offen  lds
    s_add_u32 m0, s28, 1024
    s_add_u32 s61, s38, 20736
    buffer_load_dwordx4 v7, s[76:79], s61 offen  lds
    s_add_u32 m0, s28, 2048
    s_add_u32 s61, s38, 40960
    buffer_load_dwordx4 v7, s[76:79], s61 offen  lds
    s_add_u32 m0, s28, 3072
    s_add_u32 s61, s38, 41024
    buffer_load_dwordx4 v7, s[76:79], s61 offen  lds
    s_waitcnt vmcnt(0)
    ds_read_b64_tr_b16 a[68:69], v4 offset:0
    ds_read_b64_tr_b16 a[70:71], v4 offset:512
    ds_read_b64_tr_b16 a[76:77], v4 offset:1024
    ds_read_b64_tr_b16 a[78:79], v4 offset:1536
    ds_read_b64_tr_b16 a[84:85], v4 offset:2048
    ds_read_b64_tr_b16 a[86:87], v4 offset:2560
    ds_read_b64_tr_b16 a[92:93], v4 offset:3072
    ds_read_b64_tr_b16 a[94:95], v4 offset:3584
    s_waitcnt lgkmcnt(0)
    s_mov_b32 s61, 81920
    buffer_load_dword v14, v17, s[76:79], s61 offen
    s_add_u32 m0, s28, 0
    s_add_u32 s61, s38, 41088
    buffer_load_dwordx4 v7, s[76:79], s61 offen  lds
    s_add_u32 m0, s28, 1024
    s_add_u32 s61, s38, 41152
    buffer_load_dwordx4 v7, s[76:79], s61 offen  lds
    s_add_u32 m0, s28, 2048
    s_add_u32 s61, s38, 41216
    buffer_load_dwordx4 v7, s[76:79], s61 offen  lds
    s_add_u32 m0, s28, 3072
    s_add_u32 s61, s38, 61440
    buffer_load_dwordx4 v7, s[76:79], s61 offen  lds
    s_waitcnt vmcnt(0)
    ds_read_b64_tr_b16 a[100:101], v4 offset:0
    ds_read_b64_tr_b16 a[102:103], v4 offset:512
    ds_read_b64_tr_b16 a[108:109], v4 offset:1024
    ds_read_b64_tr_b16 a[110:111], v4 offset:1536
    ds_read_b64_tr_b16 a[116:117], v4 offset:2048
    ds_read_b64_tr_b16 a[118:119], v4 offset:2560
    ds_read_b64_tr_b16 a[124:125], v4 offset:3072
    ds_read_b64_tr_b16 a[126:127], v4 offset:3584
    s_waitcnt lgkmcnt(0)
    s_mov_b32 s61, 98304
    buffer_load_dword v14, v17, s[76:79], s61 offen
    s_add_u32 m0, s28, 0
    s_add_u32 s61, s38, 61504
    buffer_load_dwordx4 v7, s[76:79], s61 offen  lds
    s_add_u32 m0, s28, 1024
    s_add_u32 s61, s38, 61568
    buffer_load_dwordx4 v7, s[76:79], s61 offen  lds
    s_add_u32 m0, s28, 2048
    s_add_u32 s61, s38, 61632
    buffer_load_dwordx4 v7, s[76:79], s61 offen  lds
    s_add_u32 m0, s28, 3072
    s_add_u32 s61, s38, 61696
    buffer_load_dwordx4 v7, s[76:79], s61 offen  lds
    s_waitcnt vmcnt(0)
    ds_read_b64_tr_b16 a[132:133], v4 offset:0
    ds_read_b64_tr_b16 a[134:135], v4 offset:512
    ds_read_b64_tr_b16 a[140:141], v4 offset:1024
    ds_read_b64_tr_b16 a[142:143], v4 offset:1536
    ds_read_b64_tr_b16 a[148:149], v4 offset:2048
    ds_read_b64_tr_b16 a[150:151], v4 offset:2560
    ds_read_b64_tr_b16 a[156:157], v4 offset:3072
    ds_read_b64_tr_b16 a[158:159], v4 offset:3584
    s_waitcnt lgkmcnt(0)
    s_mov_b32 s61, 114688
    buffer_load_dword v14, v17, s[76:79], s61 offen
    s_add_u32 m0, s28, 0
    s_add_u32 s61, s38, 81920
    buffer_load_dwordx4 v7, s[76:79], s61 offen  lds
    s_add_u32 m0, s28, 1024
    s_add_u32 s61, s38, 81984
    buffer_load_dwordx4 v7, s[76:79], s61 offen  lds
    s_add_u32 m0, s28, 2048
    s_add_u32 s61, s38, 82048
    buffer_load_dwordx4 v7, s[76:79], s61 offen  lds
    s_add_u32 m0, s28, 3072
    s_add_u32 s61, s38, 82112
    buffer_load_dwordx4 v7, s[76:79], s61 offen  lds
    s_waitcnt vmcnt(0)
    ds_read_b64_tr_b16 a[164:165], v4 offset:0
    ds_read_b64_tr_b16 a[166:167], v4 offset:512
    ds_read_b64_tr_b16 a[172:173], v4 offset:1024
    ds_read_b64_tr_b16 a[174:175], v4 offset:1536
    ds_read_b64_tr_b16 a[180:181], v4 offset:2048
    ds_read_b64_tr_b16 a[182:183], v4 offset:2560
    ds_read_b64_tr_b16 a[188:189], v4 offset:3072
    ds_read_b64_tr_b16 a[190:191], v4 offset:3584
    s_waitcnt lgkmcnt(0)
    s_mov_b32 s61, 131072
    buffer_load_dword v14, v17, s[76:79], s61 offen
    s_add_u32 m0, s28, 0
    s_add_u32 s61, s38, 82176
    buffer_load_dwordx4 v7, s[76:79], s61 offen  lds
    s_add_u32 m0, s28, 1024
    s_add_u32 s61, s38, 102400
    buffer_load_dwordx4 v7, s[76:79], s61 offen  lds
    s_add_u32 m0, s28, 2048
    s_add_u32 s61, s38, 102464
    buffer_load_dwordx4 v7, s[76:79], s61 offen  lds
    s_add_u32 m0, s28, 3072
    s_add_u32 s61, s38, 102528
    buffer_load_dwordx4 v7, s[76:79], s61 offen  lds
    s_waitcnt vmcnt(0)
    ds_read_b64_tr_b16 a[196:197], v4 offset:0
    ds_read_b64_tr_b16 a[198:199], v4 offset:512
    ds_read_b64_tr_b16 a[204:205], v4 offset:1024
    ds_read_b64_tr_b16 a[206:207], v4 offset:1536
    ds_read_b64_tr_b16 a[212:213], v4 offset:2048
    ds_read_b64_tr_b16 a[214:215], v4 offset:2560
    ds_read_b64_tr_b16 a[220:221], v4 offset:3072
    ds_read_b64_tr_b16 a[222:223], v4 offset:3584
    s_waitcnt lgkmcnt(0)
    s_mov_b32 s61, 147456
    buffer_load_dword v14, v17, s[76:79], s61 offen
    s_add_u32 m0, s28, 0
    s_add_u32 s61, s38, 102592
    buffer_load_dwordx4 v7, s[76:79], s61 offen  lds
    s_add_u32 m0, s28, 1024
    s_add_u32 s61, s38, 102656
    buffer_load_dwordx4 v7, s[76:79], s61 offen  lds
    s_add_u32 m0, s28, 2048
    s_add_u32 s61, s38, 122880
    buffer_load_dwordx4 v7, s[76:79], s61 offen  lds
    s_add_u32 m0, s28, 3072
    s_add_u32 s61, s38, 122944
    buffer_load_dwordx4 v7, s[76:79], s61 offen  lds
    s_waitcnt vmcnt(0)
    ds_read_b64_tr_b16 a[228:229], v4 offset:0
    ds_read_b64_tr_b16 a[230:231], v4 offset:512
    ds_read_b64_tr_b16 a[236:237], v4 offset:1024
    ds_read_b64_tr_b16 a[238:239], v4 offset:1536
    ds_read_b64_tr_b16 a[244:245], v4 offset:2048
    ds_read_b64_tr_b16 a[246:247], v4 offset:2560
    ds_read_b64_tr_b16 a[252:253], v4 offset:3072
    ds_read_b64_tr_b16 a[254:255], v4 offset:3584
    s_waitcnt lgkmcnt(0)
    s_add_u32 m0, s28, 0
    s_add_u32 s61, s38, 123008
    buffer_load_dwordx4 v7, s[76:79], s61 offen  lds
    s_add_u32 m0, s28, 1024
    s_add_u32 s61, s38, 123072
    buffer_load_dwordx4 v7, s[76:79], s61 offen  lds
    s_add_u32 m0, s28, 2048
    s_add_u32 s61, s38, 123136
    buffer_load_dwordx4 v7, s[76:79], s61 offen  lds
    s_add_u32 m0, s28, 3072
    s_add_u32 s61, s38, 143360
    buffer_load_dwordx4 v7, s[76:79], s61 offen  lds
    s_waitcnt vmcnt(0)
    ds_read_b64_tr_b16 v[196:197], v4 offset:0
    ds_read_b64_tr_b16 v[198:199], v4 offset:512
    ds_read_b64_tr_b16 v[204:205], v4 offset:1024
    ds_read_b64_tr_b16 v[206:207], v4 offset:1536
    ds_read_b64_tr_b16 v[212:213], v4 offset:2048
    ds_read_b64_tr_b16 v[214:215], v4 offset:2560
    ds_read_b64_tr_b16 v[220:221], v4 offset:3072
    ds_read_b64_tr_b16 v[222:223], v4 offset:3584
    s_waitcnt lgkmcnt(0)
    s_add_u32 m0, s28, 0
    s_add_u32 s61, s38, 143424
    buffer_load_dwordx4 v7, s[76:79], s61 offen  lds
    s_add_u32 m0, s28, 1024
    s_add_u32 s61, s38, 143488
    buffer_load_dwordx4 v7, s[76:79], s61 offen  lds
    s_add_u32 m0, s28, 2048
    s_add_u32 s61, s38, 143552
    buffer_load_dwordx4 v7, s[76:79], s61 offen  lds
    s_add_u32 m0, s28, 3072
    s_add_u32 s61, s38, 143616
    buffer_load_dwordx4 v7, s[76:79], s61 offen  lds
    s_waitcnt vmcnt(0)
    ds_read_b64_tr_b16 v[228:229], v4 offset:0
    ds_read_b64_tr_b16 v[230:231], v4 offset:512
    ds_read_b64_tr_b16 v[236:237], v4 offset:1024
    ds_read_b64_tr_b16 v[238:239], v4 offset:1536
    ds_read_b64_tr_b16 v[244:245], v4 offset:2048
    ds_read_b64_tr_b16 v[246:247], v4 offset:2560
    ds_read_b64_tr_b16 v[252:253], v4 offset:3072
    ds_read_b64_tr_b16 v[254:255], v4 offset:3584
    s_waitcnt lgkmcnt(0)
    s_lshl_b32 s60, s8, 2
    v_mov_b32 v15, s60
    s_mul_i32 s16, s9, 16384
    s_add_u32 s16, s16, 16777216
    s_mul_i32 s17, s9, 266240
    s_add_u32 s17, s17, 7340032
    s_mov_b32 s22, 262144
W_wk:
    buffer_load_dword v14, v15, s[12:15], s27 offen offset:768 sc1
    s_sub_u32 s22, s22, 1
    s_cbranch_scc1 W_fail
    s_waitcnt vmcnt(0)
    v_cmp_gt_u32 vcc, 64, v14
    s_cbranch_vccnz W_wk
    v_and_b32 v16, 31, v0
    v_lshlrev_b32 v190, 2, v16
    s_mov_b32 s22, 262144
W_wg:
    buffer_load_dword v14, v190, s[12:15], s26 offen offset:256 sc1
    s_sub_u32 s22, s22, 1
    s_cbranch_scc1 W_fail
    s_waitcnt vmcnt(0)
    v_cmp_gt_u32 vcc, 1, v14
    s_cbranch_vccnz W_wg
    s_mov_b32 s40, 0x3e0293ee
    v_lshrrev_b32 v17, 5, v0
    v_lshlrev_b32 v18, 2, v17
    v_sub_u32 v6, v16, v18
    v_bfe_u32 v16, v0, 2, 2
    v_add_u32 v16, v16, v18
    v_lshlrev_b32 v16, 3, v16
    v_and_b32 v19, 1, v0
    v_lshl_add_u32 v16, v19, 8, v16
    v_add_u32 v7, s28, v16
    s_lshl_b32 s60, s10, 9
    s_add_u32 s60, s60, 2048
    v_lshl_add_u32 v5, v0, 3, s60
    s_lshl_b32 s41, s8, 7
    s_add_u32 s41, s41, s27
    v_mov_b32 v3, 0xff800000
    s_lshl_b32 s60, s10, 11
    s_add_u32 s60, s60, 147456
    v_add_u32 v9, s60, v1
    v_add_u32 v4, 147456, v1
    v_and_b32 v20, 15, v0
    v_bfe_u32 v21, v0, 4, 1
    v_lshlrev_b32 v22, 4, v20
    v_lshl_add_u32 v22, v17, 8, v22
    v_mul_u32_u24 v23, 17408, v21
    v_add_u32 v22, v22, v23
    s_lshl_b32 s60, s9, 9
    s_mul_i32 s61, s10, 348160
    s_add_u32 s60, s60, s61
    v_add_u32 v191, s60, v22
    s_and_b32 s60, s35, 1
    s_lshl_b32 s60, s60, 4
    v_add_u32 v20, s60, v20
    v_mul_u32_u24 v22, 1280, v20
    v_lshl_add_u32 v22, v21, 4, v22
    v_lshl_add_u32 v22, v17, 3, v22
    s_lshr_b32 s60, s35, 1
    s_lshl_b32 s61, s60, 5
    v_add_u32 v188, s61, v22
    v_lshlrev_b32 v22, 3, v20
    v_lshl_add_u32 v22, v17, 8, v22
    v_lshl_add_u32 v22, v21, 9, v22
    s_lshl_b32 s61, s60, 10
    s_add_u32 s61, s61, 79691776
    v_add_u32 v189, s61, v22
    v_bfe_u32 v22, v0, 3, 1
    v_xor_b32 v22, v22, v21
    v_bfe_u32 v23, v0, 1, 2
    v_lshl_add_u32 v23, v22, 2, v23
    v_lshlrev_b32 v19, 4, v19
    v_mov_b32 v22, 0x3f80
    v_lshlrev_b32 v19, v19, v22
    v_cmp_eq_u32 vcc, 0, v23
    s_nop 1
    v_cndmask_b32 v184, 0, v19, vcc
    v_cmp_eq_u32 vcc, 1, v23
    s_nop 1
    v_cndmask_b32 v185, 0, v19, vcc
    v_cmp_eq_u32 vcc, 2, v23
    s_nop 1
    v_cndmask_b32 v186, 0, v19, vcc
    v_cmp_eq_u32 vcc, 3, v23
    s_nop 1
    v_cndmask_b32 v187, 0, v19, vcc
    s_cmp_eq_u32 s10, 3
    s_cselect_b64 s[54:55], 1, 0
    s_mov_b32 s56, 0
    s_mov_b32 s49, 0
    s_waitcnt vmcnt(0)
    s_barrier
    s_mov_b32 s22, 2097152
    s_mov_b32 s43, 0
    s_mov_b32 s82, 0
    s_mov_b64 s[84:85], s[12:13]
    s_mov_b64 s[88:89], s[12:13]
    s_mov_b32 s91, 0x00020000
    s_mov_b64 s[92:93], s[12:13]
    s_mov_b32 s94, 0
    s_mov_b32 s95, 0x00020000
    s_lshl_b32 s34, s10, 11
    s_add_u32 s16, s16, s34
    s_add_u32 s38, s28, 4096
    s_mov_b32 s59, s23
    s_cmp_eq_u32 s10, 1
    s_cselect_b32 s53, 79691776, 0
    s_cmp_eq_u32 s10, 0
    s_cselect_b32 s53, 4358144, s53
    s_add_u32 s60, s9, 128
    s_mul_i32 s60, s60, 1280
    s_add_u32 s53, s53, s60
    s_cmp_lt_u32 s10, 2
    s_cselect_b64 s[76:77], s[12:13], s[72:73]
    s_cselect_b32 s78, s14, s74
    s_cmp_eq_u32 s10, 3
    s_cselect_b32 s78, 0, s78
    s_mul_i32 s44, s59, 524288
    s_add_u32 s44, s44, s16
    s_add_u32 s45, s44, 8192
    s_cmp_lt_u32 s59, 64
    s_cselect_b32 s86, s14, 0
    s_add_u32 m0, s28, 2048
    s_nop 0
    buffer_load_dwordx4 v1, s[84:87], s44 offen offset:0  lds
    s_add_u32 m0, s28, 2048
    s_nop 0
    buffer_load_dwordx4 v1, s[84:87], s44 offen offset:1024  lds
    s_mul_i32 s46, s59, 4096
    s_add_u32 s46, s46, s17
    s_cmp_gt_u32 s56, s59
    s_cselect_b32 s57, 1, 0
    s_cselect_b32 s90, s14, 0
    buffer_load_dwordx2 v[14:15], off, s[12:15], s41 sc1
    buffer_load_dwordx4 v[88:91], v1, s[84:87], s45 offen offset:0
    buffer_load_dwordx4 v[92:95], v1, s[84:87], s45 offen offset:1024
    s_mov_b32 m0, s28
    s_nop 0
    buffer_load_dwordx4 v1, s[88:91], s46 offen  lds
    buffer_load_dwordx4 v1, s[88:91], s46 offen offset:1024  lds
    buffer_load_dwordx2 v[180:181], v5, s[88:91], s46 offen
    v_add_u32 v35, 83968, v1
    s_waitcnt vmcnt(6)
    s_barrier
    ds_read_b128 v[96:99], v35 offset:0
    ds_read_b128 v[100:103], v35 offset:1024
    ds_read_b128 v[104:107], v35 offset:20480
    ds_read_b128 v[108:111], v35 offset:21504
    ds_read_b128 v[112:115], v35 offset:40960
    ds_read_b128 v[116:119], v35 offset:41984
    ds_read_b128 v[120:123], v35 offset:61440
    ds_read_b128 v[124:127], v35 offset:62464
    s_waitcnt lgkmcnt(0)
    s_barrier
    ds_read_b128 v[16:19], v10 offset:0
    ds_read_b128 v[20:23], v11 offset:0
    ds_read_b128 v[24:27], v12 offset:0
    ds_read_b128 v[28:31], v13 offset:0
    ds_read_b128 v[32:35], v10 offset:4096
W_att:
    s_add_u32 s31, s31, 163840
    s_add_u32 s32, s32, s33
    s_min_u32 s31, s31, 6774784
    s_waitcnt lgkmcnt(4)
    v_mfma_f32_32x32x16_bf16 v[40:55], a[0:3], v[16:19], 0
    ds_read_b128 v[36:39], v11 offset:4096
    s_waitcnt lgkmcnt(4)
    v_mfma_f32_32x32x16_bf16 v[40:55], a[8:11], v[20:23], v[40:55]
    ds_read_b128 v[16:19], v12 offset:4096
    v_cvt_pk_bf16_f32 v160, v56, v57
    v_cvt_pk_bf16_f32 v161, v58, v59
    v_cvt_pk_bf16_f32 v162, v60, v61
    v_cvt_pk_bf16_f32 v163, v62, v63
    s_waitcnt lgkmcnt(4)
    v_mfma_f32_32x32x16_bf16 v[40:55], a[16:19], v[24:27], v[40:55]
    ds_read_b128 v[20:23], v13 offset:4096
    s_add_u32 s61, s42, 278528
    buffer_store_dwordx4 v[160:163], v191, s[92:95], s61 offen
    v_cvt_pk_bf16_f32 v164, v64, v65
    v_cvt_pk_bf16_f32 v165, v66, v67
    v_cvt_pk_bf16_f32 v166, v68, v69
    v_cvt_pk_bf16_f32 v167, v70, v71
    s_waitcnt lgkmcnt(4)
    v_mfma_f32_32x32x16_bf16 v[40:55], a[24:27], v[28:31], v[40:55]
    ds_read_b128 v[24:27], v10 offset:8192
    s_waitcnt lgkmcnt(4)
    v_mfma_f32_32x32x16_bf16 v[40:55], a[32:35], v[32:35], v[40:55]
    ds_read_b128 v[28:31], v11 offset:8192
    s_add_u32 s61, s42, 313344
    buffer_store_dwordx4 v[164:167], v191, s[92:95], s61 offen
    s_waitcnt lgkmcnt(4)
    v_mfma_f32_32x32x16_bf16 v[40:55], a[40:43], v[36:39], v[40:55]
    ds_read_b128 v[32:35], v12 offset:8192
    s_mov_b32 s94, s14
    s_mov_b32 s58, s49
    s_mul_i32 s49, s23, 40960
    s_add_u32 s59, s23, 4
    s_waitcnt lgkmcnt(4)
    v_mfma_f32_32x32x16_bf16 v[40:55], a[48:51], v[16:19], v[40:55]
    ds_read_b128 v[36:39], v13 offset:8192
    s_add_u32 m0, s32, 0
    s_nop 0
    buffer_load_dwordx4 v8, s[12:15], s31 offen offset:0 lds
    s_waitcnt lgkmcnt(4)
    v_mfma_f32_32x32x16_bf16 v[40:55], a[56:59], v[20:23], v[40:55]
    ds_read_b128 v[16:19], v10 offset:12288
    s_mul_i32 s44, s59, 524288
    s_add_u32 s44, s44, s16
    s_add_u32 s45, s44, 8192
    s_cmp_lt_u32 s59, 64
    s_cselect_b32 s86, s14, 0
    s_waitcnt lgkmcnt(4)
    v_mfma_f32_32x32x16_bf16 v[40:55], a[64:67], v[24:27], v[40:55]
    ds_read_b128 v[20:23], v11 offset:12288
    s_add_u32 m0, s32, 3968
    s_nop 0
    buffer_load_dwordx4 v8, s[12:15], s31 offen offset:128 lds
    s_waitcnt lgkmcnt(4)
    v_mfma_f32_32x32x16_bf16 v[40:55], a[72:75], v[28:31], v[40:55]
    ds_read_b128 v[24:27], v12 offset:12288
    s_waitcnt lgkmcnt(4)
    v_mfma_f32_32x32x16_bf16 v[40:55], a[80:83], v[32:35], v[40:55]
    ds_read_b128 v[28:31], v13 offset:12288
    s_add_u32 m0, s32, 7936
    s_nop 0
    buffer_load_dwordx4 v8, s[12:15], s31 offen offset:256 lds
    s_waitcnt lgkmcnt(4)
    v_mfma_f32_32x32x16_bf16 v[40:55], a[88:91], v[36:39], v[40:55]
    ds_read_b128 v[32:35], v10 offset:16384
    s_waitcnt lgkmcnt(4)
    v_mfma_f32_32x32x16_bf16 v[40:55], a[96:99], v[16:19], v[40:55]
    ds_read_b128 v[36:39], v11 offset:16384
    s_add_u32 m0, s32, 11904
    s_nop 0
    buffer_load_dwordx4 v8, s[12:15], s31 offen offset:384 lds
    s_waitcnt lgkmcnt(4)
    v_mfma_f32_32x32x16_bf16 v[40:55], a[104:107], v[20:23], v[40:55]
    ds_read_b128 v[16:19], v12 offset:16384
    s_waitcnt lgkmcnt(4)
    v_mfma_f32_32x32x16_bf16 v[40:55], a[112:115], v[24:27], v[40:55]
    ds_read_b128 v[20:23], v13 offset:16384
    s_add_u32 m0, s32, 15872
    s_nop 0
    buffer_load_dwordx4 v8, s[12:15], s31 offen offset:512 lds
    s_waitcnt lgkmcnt(4)
    v_mfma_f32_32x32x16_bf16 v[40:55], a[120:123], v[28:31], v[40:55]
    ds_read_b128 v[24:27], v10 offset:20480
    s_waitcnt lgkmcnt(4)
    v_mfma_f32_32x32x16_bf16 v[40:55], a[128:131], v[32:35], v[40:55]
    ds_read_b128 v[28:31], v11 offset:20480
    s_add_u32 m0, s32, 19840
    s_nop 0
    buffer_load_dwordx4 v8, s[12:15], s31 offen offset:640 lds
    s_waitcnt lgkmcnt(4)
    v_mfma_f32_32x32x16_bf16 v[40:55], a[136:139], v[36:39], v[40:55]
    ds_read_b128 v[32:35], v12 offset:20480
    s_waitcnt lgkmcnt(4)
    v_mfma_f32_32x32x16_bf16 v[40:55], a[144:147], v[16:19], v[40:55]
    ds_read_b128 v[36:39], v13 offset:20480
    s_add_u32 m0, s32, 23808
    s_nop 0
    buffer_load_dwordx4 v8, s[12:15], s31 offen offset:768 lds
    s_waitcnt lgkmcnt(4)
    v_mfma_f32_32x32x16_bf16 v[40:55], a[152:155], v[20:23], v[40:55]
    ds_read_b128 v[16:19], v10 offset:24576
    s_waitcnt lgkmcnt(4)
    v_mfma_f32_32x32x16_bf16 v[40:55], a[160:163], v[24:27], v[40:55]
    ds_read_b128 v[20:23], v11 offset:24576
    s_add_u32 m0, s32, 27776
    s_nop 0
    buffer_load_dwordx4 v8, s[12:15], s31 offen offset:896 lds
    s_waitcnt vmcnt(10)
    v_min_u32 v14, v14, v15
    v_lshlrev_b32 v15, 9, v2
    s_waitcnt lgkmcnt(4)
    v_mfma_f32_32x32x16_bf16 v[40:55], a[168:171], v[28:31], v[40:55]
    ds_read_b128 v[24:27], v12 offset:24576
    v_add_u32 v15, 147456, v15
    s_waitcnt lgkmcnt(4)
    v_mfma_f32_32x32x16_bf16 v[40:55], a[176:179], v[32:35], v[40:55]
    ds_read_b128 v[28:31], v13 offset:24576
    s_add_u32 m0, s32, 31744
    s_nop 0
    buffer_load_dwordx4 v8, s[12:15], s31 offen offset:1024 lds
    s_mul_i32 exec_lo, s54, 15
    s_mov_b32 exec_hi, 0
    ds_write_b32 v15, v14
    s_mov_b64 exec, -1
    s_waitcnt lgkmcnt(4)
    v_mfma_f32_32x32x16_bf16 v[40:55], a[184:187], v[36:39], v[40:55]
    ds_read_b128 v[32:35], v10 offset:28672
    s_waitcnt lgkmcnt(4)
    v_mfma_f32_32x32x16_bf16 v[40:55], a[192:195], v[16:19], v[40:55]
    ds_read_b128 v[36:39], v11 offset:28672
    s_add_u32 m0, s32, 35712
    s_nop 0
    buffer_load_dwordx4 v8, s[12:15], s31 offen offset:1152 lds
    s_waitcnt vmcnt(10) lgkmcnt(2)
    s_barrier
    v_mov_b32 v183, s25
    s_mov_b64 exec, s[54:55]
    buffer_store_dword v183, off, s[12:15], s20
    s_mov_b64 exec, -1
    ds_read_b32 v14, v9
    s_waitcnt lgkmcnt(5)
    v_mfma_f32_32x32x16_bf16 v[40:55], a[200:203], v[20:23], v[40:55]
    ds_read_b128 v[16:19], v12 offset:28672
    s_waitcnt lgkmcnt(5)
    v_mfma_f32_32x32x16_bf16 v[40:55], a[208:211], v[24:27], v[40:55]
    ds_read_b128 v[20:23], v13 offset:28672
    s_waitcnt lgkmcnt(2)
    v_readfirstlane_b32 s56, v14
    v_mfma_f32_32x32x16_bf16 v[40:55], a[216:219], v[28:31], v[40:55]
    ds_read_b128 v[24:27], v10 offset:32768
    s_cmp_gt_u32 s56, s23
    s_cselect_b32 s60, 1, 0
    s_cmp_gt_u32 s60, s57
    s_cbranch_scc1 W_k2
W_k2b:
    v_mfma_f32_32x32x16_bf16 v[40:55], a[224:227], v[32:35], v[40:55]
    ds_read_b128 v[28:31], v11 offset:32768
    v_mfma_f32_32x32x16_bf16 v[40:55], a[232:235], v[36:39], v[40:55]
    ds_read_b128 v[32:35], v12 offset:32768
    s_waitcnt lgkmcnt(4)
    v_mfma_f32_32x32x16_bf16 v[40:55], a[240:243], v[16:19], v[40:55]
    ds_read_b128 v[36:39], v13 offset:32768
    s_waitcnt lgkmcnt(4)
    v_mfma_f32_32x32x16_bf16 v[40:55], a[248:251], v[20:23], v[40:55]
    ds_read_b128 v[16:19], v10 offset:36864
    s_waitcnt lgkmcnt(4)
    v_mfma_f32_32x32x16_bf16 v[40:55], v[192:195], v[24:27], v[40:55]
    ds_read_b128 v[20:23], v11 offset:36864
    s_waitcnt lgkmcnt(4)
    v_mfma_f32_32x32x16_bf16 v[40:55], v[200:203], v[28:31], v[40:55]
    ds_read_b128 v[24:27], v12 offset:36864
    s_waitcnt lgkmcnt(4)
    v_mfma_f32_32x32x16_bf16 v[40:55], v[208:211], v[32:35], v[40:55]
    ds_read_b128 v[28:31], v13 offset:36864
    s_waitcnt lgkmcnt(4)
    v_mfma_f32_32x32x16_bf16 v[40:55], v[216:219], v[36:39], v[40:55]
    buffer_load_dword v182, v190, s[12:15], s26 offen sc1
    s_waitcnt lgkmcnt(3)
    v_mfma_f32_32x32x16_bf16 v[40:55], v[224:227], v[16:19], v[40:55]
    s_add_u32 m0, s28, 2048
    s_nop 0
    buffer_load_dwordx4 v1, s[84:87], s44 offen offset:0  lds
    s_waitcnt lgkmcnt(2)
    v_mfma_f32_32x32x16_bf16 v[40:55], v[232:235], v[20:23], v[40:55]
    s_waitcnt lgkmcnt(1)
    v_mfma_f32_32x32x16_bf16 v[40:55], v[240:243], v[24:27], v[40:55]
    s_add_u32 m0, s28, 2048
    s_nop 0
    buffer_load_dwordx4 v1, s[84:87], s44 offen offset:1024  lds
    s_waitcnt lgkmcnt(0)
    v_mfma_f32_32x32x16_bf16 v[40:55], v[248:251], v[28:31], v[40:55]
    v_add_u32 v10, s33, v10
    v_add_u32 v11, s33, v11
    v_add_u32 v12, s33, v12
    v_add_u32 v13, s33, v13
    s_sub_u32 s33, 0, s33
    s_nop 6
    v_cvt_pk_bf16_f32 v160, v40, v41
    v_cvt_pk_bf16_f32 v161, v42, v43
    v_cvt_pk_bf16_f32 v162, v44, v45
    v_cvt_pk_bf16_f32 v163, v46, v47
    v_cvt_pk_bf16_f32 v164, v48, v49
    v_cvt_pk_bf16_f32 v165, v50, v51
    v_cvt_pk_bf16_f32 v166, v52, v53
    v_cvt_pk_bf16_f32 v167, v54, v55
    ds_write_b128 v9, v[160:163] offset:0
    ds_write_b128 v9, v[164:167] offset:1024
    s_cmp_eq_u32 s43, 0
    s_waitcnt vmcnt(2)
    s_cbranch_scc1 W_nr1
W_rd:
    v_cmp_gt_u32 vcc, s25, v182
    s_cbranch_vccnz W_rdx
W_nr1:
    s_waitcnt lgkmcnt(0)
    s_barrier
    ds_read_b128 v[128:131], v4 offset:0
    ds_read_b128 v[132:135], v4 offset:1024
    ds_read_b128 v[136:139], v4 offset:2048
    ds_read_b128 v[140:143], v4 offset:3072
    ds_read_b128 v[144:147], v4 offset:4096
    ds_read_b128 v[148:151], v4 offset:5120
    ds_read_b128 v[152:155], v4 offset:6144
    ds_read_b128 v[156:159], v4 offset:7168
    s_cmp_eq_u32 s57, 0
    s_cbranch_scc1 W_late
    s_cmp_eq_u32 s43, 0
    s_cbranch_scc1 W_s0
    s_waitcnt lgkmcnt(7)
    v_mfma_f32_32x32x16_bf16 v[72:87], v[96:99], v[128:131], 0
    s_add_u32 s47, s36, 0
    s_add_u32 m0, s38, 0
    s_nop 0
    buffer_load_dwordx4 v1, s[12:15], s47 offen offset:0 sc1 lds
    s_waitcnt lgkmcnt(6)
    v_mfma_f32_32x32x16_bf16 v[72:87], v[100:103], v[132:135], v[72:87]
    ds_read_b64_tr_b16 v[96:97], v7 offset:0
    ds_read_b64_tr_b16 v[98:99], v7 offset:64
    buffer_load_dwordx4 v1, s[12:15], s47 offen offset:1024 sc1 lds
    s_waitcnt lgkmcnt(7)
    v_mfma_f32_32x32x16_bf16 v[72:87], v[104:107], v[136:139], v[72:87]
    ds_read_b64_tr_b16 v[100:101], v7 offset:128
    ds_read_b64_tr_b16 v[102:103], v7 offset:192
    buffer_load_dwordx4 v1, s[12:15], s47 offen offset:2048 sc1 lds
    s_waitcnt lgkmcnt(8)
    v_mfma_f32_32x32x16_bf16 v[72:87], v[108:111], v[140:143], v[72:87]
    ds_read_b64_tr_b16 v[104:105], v7 offset:512
    ds_read_b64_tr_b16 v[106:107], v7 offset:576
    buffer_load_dwordx4 v1, s[12:15], s47 offen offset:3072 sc1 lds
    s_waitcnt lgkmcnt(9)
    v_mfma_f32_32x32x16_bf16 v[72:87], v[112:115], v[144:147], v[72:87]
    ds_read_b64_tr_b16 v[108:109], v7 offset:640
    ds_read_b64_tr_b16 v[110:111], v7 offset:704
    s_add_u32 s47, s36, 4096
    s_add_u32 m0, s38, 4096
    s_nop 0
    buffer_load_dwordx4 v1, s[12:15], s47 offen offset:0 sc1 lds
    s_waitcnt lgkmcnt(10)
    v_mfma_f32_32x32x16_bf16 v[72:87], v[116:119], v[148:151], v[72:87]
    ds_read_b64_tr_b16 v[112:113], v7 offset:1024
    ds_read_b64_tr_b16 v[114:115], v7 offset:1088
    buffer_load_dwordx4 v1, s[12:15], s47 offen offset:1024 sc1 lds
    s_waitcnt lgkmcnt(11)
    v_mfma_f32_32x32x16_bf16 v[72:87], v[120:123], v[152:155], v[72:87]
    ds_read_b64_tr_b16 v[116:117], v7 offset:1152
    ds_read_b64_tr_b16 v[118:119], v7 offset:1216
    buffer_load_dwordx4 v1, s[12:15], s47 offen offset:2048 sc1 lds
    s_waitcnt lgkmcnt(12)
    v_mfma_f32_32x32x16_bf16 v[72:87], v[124:127], v[156:159], v[72:87]
    ds_read_b64_tr_b16 v[120:121], v7 offset:1536
    ds_read_b64_tr_b16 v[122:123], v7 offset:1600
    buffer_load_dwordx4 v1, s[12:15], s47 offen offset:3072 sc1 lds
    s_waitcnt lgkmcnt(12)
    v_mfma_f32_32x32x16_bf16 v[56:71], v[96:99], v[128:131], 0
    s_add_u32 s47, s36, 8192
    s_add_u32 m0, s38, 8192
    s_nop 0
    buffer_load_dwordx4 v1, s[12:15], s47 offen offset:0 sc1 lds
    ds_read_b64_tr_b16 v[124:125], v7 offset:1664
    ds_read_b64_tr_b16 v[126:127], v7 offset:1728
    s_waitcnt lgkmcnt(12)
    v_mfma_f32_32x32x16_bf16 v[56:71], v[100:103], v[132:135], v[56:71]
    buffer_load_dwordx4 v1, s[12:15], s47 offen offset:1024 sc1 lds
    v_cmp_gt_i32 s[60:61], 0, v6
    v_cmp_gt_i32 s[62:63], 1, v6
    v_cmp_gt_i32 s[66:67], 2, v6
    v_cmp_gt_i32 vcc, 3, v6
    v_cndmask_b32 v72, v72, v3, s[60:61]
    v_cndmask_b32 v73, v73, v3, s[62:63]
    s_waitcnt lgkmcnt(10)
    v_mfma_f32_32x32x16_bf16 v[56:71], v[104:107], v[136:139], v[56:71]
    buffer_load_dwordx4 v1, s[12:15], s47 offen offset:2048 sc1 lds
    v_cndmask_b32 v74, v74, v3, s[66:67]
    v_cndmask_b32 v75, v75, v3, vcc
    v_cmp_gt_i32 s[60:61], 8, v6
    v_cmp_gt_i32 s[62:63], 9, v6
    v_cmp_gt_i32 s[66:67], 10, v6
    v_cmp_gt_i32 vcc, 11, v6
    s_waitcnt lgkmcnt(8)
    v_mfma_f32_32x32x16_bf16 v[56:71], v[108:111], v[140:143], v[56:71]
    buffer_load_dwordx4 v1, s[12:15], s47 offen offset:3072 sc1 lds
    v_cndmask_b32 v76, v76, v3, s[60:61]
    v_cndmask_b32 v77, v77, v3, s[62:63]
    v_cndmask_b32 v78, v78, v3, s[66:67]
    v_cndmask_b32 v79, v79, v3, vcc
    v_cmp_gt_i32 s[60:61], 16, v6
    v_cmp_gt_i32 s[62:63], 17, v6
    s_waitcnt lgkmcnt(6)
    v_mfma_f32_32x32x16_bf16 v[56:71], v[112:115], v[144:147], v[56:71]
    s_add_u32 s47, s36, 12288
    s_add_u32 m0, s38, 12288
    s_nop 0
    buffer_load_dwordx4 v1, s[12:15], s47 offen offset:0 sc1 lds
    v_cmp_gt_i32 s[66:67], 18, v6
    v_cmp_gt_i32 vcc, 19, v6
    v_cndmask_b32 v80, v80, v3, s[60:61]
    v_cndmask_b32 v81, v81, v3, s[62:63]
    v_cndmask_b32 v82, v82, v3, s[66:67]
    v_cndmask_b32 v83, v83, v3, vcc
    s_waitcnt lgkmcnt(4)
    v_mfma_f32_32x32x16_bf16 v[56:71], v[116:119], v[148:151], v[56:71]
    buffer_load_dwordx4 v1, s[12:15], s47 offen offset:1024 sc1 lds
    v_cmp_gt_i32 s[60:61], 24, v6
    v_cmp_gt_i32 s[62:63], 25, v6
    v_cmp_gt_i32 s[66:67], 26, v6
    v_cmp_gt_i32 vcc, 27, v6
    v_cndmask_b32 v84, v84, v3, s[60:61]
    v_cndmask_b32 v85, v85, v3, s[62:63]
    s_waitcnt lgkmcnt(2)
    v_mfma_f32_32x32x16_bf16 v[56:71], v[120:123], v[152:155], v[56:71]
    buffer_load_dwordx4 v1, s[12:15], s47 offen offset:2048 sc1 lds
    v_cndmask_b32 v86, v86, v3, s[66:67]
    v_cndmask_b32 v87, v87, v3, vcc
    v_max3_f32 v183, v72, v73, v74
    v_max3_f32 v183, v183, v75, v76
    v_max3_f32 v183, v183, v77, v78
    v_max3_f32 v183, v183, v79, v80
    s_waitcnt lgkmcnt(0)
    v_mfma_f32_32x32x16_bf16 v[56:71], v[124:127], v[156:159], v[56:71]
    buffer_load_dwordx4 v1, s[12:15], s47 offen offset:3072 sc1 lds
    v_max3_f32 v183, v183, v81, v82
    v_max3_f32 v183, v183, v83, v84
    v_max3_f32 v183, v183, v85, v86
    v_max_f32 v183, v183, v87
W_soft:
    s_nop 6
    v_max3_f32 v16, v183, v56, v57
    v_max3_f32 v17, v16, v58, v59
    v_max3_f32 v16, v16, v58, v59
    v_add_u32 v34, s38, v1
    v_mov_b32 v182, s25
    v_permlane32_swap_b32 v16, v17
    v_max_f32 v16, v16, v17
    v_mul_f32 v16, s40, v16
    v_pk_fma_f32 v[72:73], v[72:73], s[40:41], v[16:17] op_sel_hi:[1,0,0] neg_lo:[0,0,1] neg_hi:[0,0,1]
    v_pk_fma_f32 v[74:75], v[74:75], s[40:41], v[16:17] op_sel_hi:[1,0,0] neg_lo:[0,0,1] neg_hi:[0,0,1]
    v_pk_fma_f32 v[76:77], v[76:77], s[40:41], v[16:17] op_sel_hi:[1,0,0] neg_lo:[0,0,1] neg_hi:[0,0,1]
    v_pk_fma_f32 v[78:79], v[78:79], s[40:41], v[16:17] op_sel_hi:[1,0,0] neg_lo:[0,0,1] neg_hi:[0,0,1]
    v_pk_fma_f32 v[80:81], v[80:81], s[40:41], v[16:17] op_sel_hi:[1,0,0] neg_lo:[0,0,1] neg_hi:[0,0,1]
    v_pk_fma_f32 v[82:83], v[82:83], s[40:41], v[16:17] op_sel_hi:[1,0,0] neg_lo:[0,0,1] neg_hi:[0,0,1]
    v_pk_fma_f32 v[84:85], v[84:85], s[40:41], v[16:17] op_sel_hi:[1,0,0] neg_lo:[0,0,1] neg_hi:[0,0,1]
    v_pk_fma_f32 v[86:87], v[86:87], s[40:41], v[16:17] op_sel_hi:[1,0,0] neg_lo:[0,0,1] neg_hi:[0,0,1]
    v_pk_fma_f32 v[56:57], v[56:57], s[40:41], v[16:17] op_sel_hi:[1,0,0] neg_lo:[0,0,1] neg_hi:[0,0,1]
    v_pk_fma_f32 v[58:59], v[58:59], s[40:41], v[16:17] op_sel_hi:[1,0,0] neg_lo:[0,0,1] neg_hi:[0,0,1]
    v_exp_f32 v72, v72
    v_exp_f32 v73, v73
    v_exp_f32 v74, v74
    v_exp_f32 v75, v75
    v_exp_f32 v76, v76
    v_exp_f32 v77, v77
    v_exp_f32 v78, v78
    v_exp_f32 v79, v79
    v_exp_f32 v80, v80
    v_cvt_pk_bf16_f32 v20, v72, v73
    v_cvt_pk_bf16_f32 v21, v74, v75
    v_cvt_pk_bf16_f32 v22, v76, v77
    v_cvt_pk_bf16_f32 v23, v78, v79
    v_exp_f32 v81, v81
    s_nop 0
    v_mfma_f32_32x32x16_bf16 v[40:55], v[88:91], v[20:23], 0
    v_exp_f32 v82, v82
    v_exp_f32 v83, v83
    v_exp_f32 v84, v84
    v_exp_f32 v85, v85
    v_exp_f32 v86, v86
    v_exp_f32 v87, v87
    v_exp_f32 v56, v56
    v_cvt_pk_bf16_f32 v24, v80, v81
    v_cvt_pk_bf16_f32 v25, v82, v83
    v_cvt_pk_bf16_f32 v26, v84, v85
    v_cvt_pk_bf16_f32 v27, v86, v87
    v_exp_f32 v57, v57
    s_nop 0
    v_mfma_f32_32x32x16_bf16 v[40:55], v[92:95], v[24:27], v[40:55]
    v_exp_f32 v58, v58
    v_exp_f32 v59, v59
    v_add_f32 v72, v72, v73
    v_cvt_pk_bf16_f32 v28, v56, v57
    v_cvt_pk_bf16_f32 v29, v58, v59
    v_add_f32 v74, v74, v75
    v_add_f32 v76, v76, v77
    v_mfma_f32_32x32x8_bf16 v[40:55], v[180:181], v[28:29], v[40:55]
    s_waitcnt vmcnt(0)
    s_mov_b64 exec, 1
    buffer_store_dword v182, off, s[12:15], s18 offset:512
    s_mov_b64 exec, -1
    ds_read_b128 v[96:99], v34 offset:0
    ds_read_b128 v[100:103], v34 offset:1024
    ds_read_b128 v[104:107], v34 offset:2048
    ds_read_b128 v[108:111], v34 offset:3072
    ds_read_b128 v[112:115], v34 offset:4096
    ds_read_b128 v[116:119], v34 offset:5120
    ds_read_b128 v[120:123], v34 offset:6144
    ds_read_b128 v[124:127], v34 offset:7168
    v_add_f32 v78, v78, v79
    v_add_f32 v80, v80, v81
    v_add_f32 v82, v82, v83
    v_add_f32 v84, v84, v85
    v_add_f32 v86, v86, v87
    v_add_f32 v56, v56, v57
    v_add_f32 v58, v58, v59
    v_add_f32 v72, v72, v74
    v_add_f32 v76, v76, v78
    v_add_f32 v80, v80, v82
    v_add_f32 v84, v84, v86
    v_add_f32 v56, v56, v58
    v_add_f32 v16, v72, v76
    v_add_f32 v17, v80, v84
    v_add_f32 v16, v16, v56
    v_add_f32 v18, v16, v17
    v_add_f32 v16, v16, v17
    v_add_u32 v35, 83968, v1
    s_nop 0
    v_permlane32_swap_b32 v16, v18
    v_add_f32 v16, v16, v18
    v_rcp_f32 v16, v16
    s_nop 0
    v_pk_mul_f32 v[40:41], v[40:41], v[16:17] op_sel_hi:[1,0]
    v_pk_mul_f32 v[42:43], v[42:43], v[16:17] op_sel_hi:[1,0]
    v_pk_mul_f32 v[44:45], v[44:45], v[16:17] op_sel_hi:[1,0]
    v_pk_mul_f32 v[46:47], v[46:47], v[16:17] op_sel_hi:[1,0]
    v_pk_mul_f32 v[48:49], v[48:49], v[16:17] op_sel_hi:[1,0]
    v_pk_mul_f32 v[50:51], v[50:51], v[16:17] op_sel_hi:[1,0]
    v_pk_mul_f32 v[52:53], v[52:53], v[16:17] op_sel_hi:[1,0]
    v_pk_mul_f32 v[54:55], v[54:55], v[16:17] op_sel_hi:[1,0]
    v_cvt_pk_bf16_f32 v160, v40, v41
    v_cvt_pk_bf16_f32 v161, v42, v43
    v_cvt_pk_bf16_f32 v162, v44, v45
    v_cvt_pk_bf16_f32 v163, v46, v47
    v_cvt_pk_bf16_f32 v164, v48, v49
    v_cvt_pk_bf16_f32 v165, v50, v51
    v_cvt_pk_bf16_f32 v166, v52, v53
    v_cvt_pk_bf16_f32 v167, v54, v55
    ds_write_b128 v9, v[160:163] offset:8192
    ds_write_b128 v9, v[164:167] offset:9216
    s_waitcnt lgkmcnt(9)
    v_mfma_f32_16x16x32_bf16 v[30:33], v[184:187], v[96:99], 0
    s_waitcnt lgkmcnt(8)
    v_mfma_f32_16x16x32_bf16 v[30:33], v[184:187], v[100:103], v[30:33]
    s_waitcnt lgkmcnt(7)
    v_mfma_f32_16x16x32_bf16 v[30:33], v[184:187], v[104:107], v[30:33]
    s_waitcnt lgkmcnt(6)
    v_mfma_f32_16x16x32_bf16 v[30:33], v[184:187], v[108:111], v[30:33]
    s_waitcnt lgkmcnt(0)
    s_barrier
    ds_read_b128 v[128:131], v4 offset:8192
    ds_read_b128 v[132:135], v4 offset:9216
    ds_read_b128 v[136:139], v4 offset:10240
    ds_read_b128 v[140:143], v4 offset:11264
    ds_read_b128 v[144:147], v4 offset:12288
    ds_read_b128 v[148:151], v4 offset:13312
    ds_read_b128 v[152:155], v4 offset:14336
    ds_read_b128 v[156:159], v4 offset:15360
    v_lshlrev_b32 v14, 1, v2
    buffer_load_dwordx2 v[14:15], v14, s[12:15], s26 offen offset:512 sc1
    v_mfma_f32_16x16x32_bf16 v[30:33], v[184:187], v[112:115], v[30:33]
    v_mfma_f32_16x16x32_bf16 v[30:33], v[184:187], v[116:119], v[30:33]
    v_mfma_f32_16x16x32_bf16 v[30:33], v[184:187], v[120:123], v[30:33]
    v_mfma_f32_16x16x32_bf16 v[30:33], v[184:187], v[124:127], v[30:33]
    ds_read_b128 v[72:75], v34 offset:8192
    ds_read_b128 v[76:79], v34 offset:9216
    ds_read_b128 v[80:83], v34 offset:10240
    ds_read_b128 v[84:87], v34 offset:11264
    ds_read_b128 v[96:99], v34 offset:12288
    ds_read_b128 v[100:103], v34 offset:13312
    ds_read_b128 v[104:107], v34 offset:14336
    ds_read_b128 v[108:111], v34 offset:15360
    s_waitcnt lgkmcnt(15)
    v_mfma_f32_32x32x16_bf16 v[56:71], a[4:7], v[128:131], 0
    s_waitcnt lgkmcnt(14)
    v_mfma_f32_32x32x16_bf16 v[56:71], a[44:47], v[132:135], v[56:71]
    s_waitcnt lgkmcnt(13)
    v_mfma_f32_32x32x16_bf16 v[56:71], a[84:87], v[136:139], v[56:71]
    s_mul_i32 s46, s59, 4096
    s_add_u32 s46, s46, s17
    s_cmp_gt_u32 s56, s59
    s_cselect_b32 s57, 1, 0
    s_cselect_b32 s90, s14, 0
    s_waitcnt lgkmcnt(12)
    v_mfma_f32_32x32x16_bf16 v[56:71], a[124:127], v[140:143], v[56:71]
    s_waitcnt lgkmcnt(11)
    v_mfma_f32_32x32x16_bf16 v[56:71], a[164:167], v[144:147], v[56:71]
    s_waitcnt lgkmcnt(10)
    v_mfma_f32_32x32x16_bf16 v[56:71], a[204:207], v[148:151], v[56:71]
    s_waitcnt lgkmcnt(9)
    v_mfma_f32_32x32x16_bf16 v[56:71], a[244:247], v[152:155], v[56:71]
    s_waitcnt lgkmcnt(8)
    v_mfma_f32_32x32x16_bf16 v[56:71], v[220:223], v[156:159], v[56:71]
    v_mfma_f32_32x32x16_bf16 v[40:55], a[12:15], v[128:131], 0
W_dn:
    s_waitcnt vmcnt(0)
    v_min_u32 v14, v14, v15
    v_cmp_gt_u32 vcc, s25, v14
    s_cbranch_vccnz W_dnx
    s_waitcnt lgkmcnt(7)
    v_mfma_f32_16x16x32_bf16 v[30:33], v[184:187], v[72:75], v[30:33]
    v_mfma_f32_32x32x16_bf16 v[40:55], a[52:55], v[132:135], v[40:55]
    v_cvt_pk_bf16_f32 v160, v56, v57
    v_cvt_pk_bf16_f32 v161, v58, v59
    v_cvt_pk_bf16_f32 v162, v60, v61
    v_cvt_pk_bf16_f32 v163, v62, v63
    s_waitcnt lgkmcnt(6)
    v_mfma_f32_16x16x32_bf16 v[30:33], v[184:187], v[76:79], v[30:33]
    v_mfma_f32_32x32x16_bf16 v[40:55], a[92:95], v[136:139], v[40:55]
    s_add_u32 s61, s42, 0
    buffer_store_dwordx4 v[160:163], v191, s[92:95], s61 offen
    v_cvt_pk_bf16_f32 v164, v64, v65
    v_cvt_pk_bf16_f32 v165, v66, v67
    v_cvt_pk_bf16_f32 v166, v68, v69
    v_cvt_pk_bf16_f32 v167, v70, v71
    s_waitcnt lgkmcnt(5)
    v_mfma_f32_16x16x32_bf16 v[30:33], v[184:187], v[80:83], v[30:33]
    v_mfma_f32_32x32x16_bf16 v[40:55], a[132:135], v[140:143], v[40:55]
    s_waitcnt lgkmcnt(4)
    v_mfma_f32_16x16x32_bf16 v[30:33], v[184:187], v[84:87], v[30:33]
    buffer_load_dwordx2 v[14:15], off, s[12:15], s41 sc1
    v_mfma_f32_32x32x16_bf16 v[40:55], a[172:175], v[144:147], v[40:55]
    s_add_u32 s61, s42, 34816
    buffer_store_dwordx4 v[164:167], v191, s[92:95], s61 offen
    s_waitcnt lgkmcnt(3)
    v_mfma_f32_16x16x32_bf16 v[30:33], v[184:187], v[96:99], v[30:33]
    v_mfma_f32_32x32x16_bf16 v[40:55], a[212:215], v[148:151], v[40:55]
    s_waitcnt lgkmcnt(2)
    v_mfma_f32_16x16x32_bf16 v[30:33], v[184:187], v[100:103], v[30:33]
    v_mfma_f32_32x32x16_bf16 v[40:55], a[252:255], v[152:155], v[40:55]
    s_waitcnt lgkmcnt(1)
    v_mfma_f32_16x16x32_bf16 v[30:33], v[184:187], v[104:107], v[30:33]
    buffer_load_dwordx4 v[88:91], v1, s[84:87], s45 offen offset:0
    v_mfma_f32_32x32x16_bf16 v[40:55], v[228:231], v[156:159], v[40:55]
    s_waitcnt lgkmcnt(0)
    v_mfma_f32_16x16x32_bf16 v[30:33], v[184:187], v[108:111], v[30:33]
    v_mfma_f32_32x32x16_bf16 v[56:71], a[20:23], v[128:131], 0
    buffer_load_dwordx4 v[92:95], v1, s[84:87], s45 offen offset:1024
    v_mfma_f32_32x32x16_bf16 v[56:71], a[60:63], v[132:135], v[56:71]
    v_cvt_pk_bf16_f32 v168, v40, v41
    v_cvt_pk_bf16_f32 v169, v42, v43
    v_cvt_pk_bf16_f32 v170, v44, v45
    v_cvt_pk_bf16_f32 v171, v46, v47
    v_mfma_f32_32x32x16_bf16 v[56:71], a[100:103], v[136:139], v[56:71]
    s_add_u32 s61, s42, 69632
    buffer_store_dwordx4 v[168:171], v191, s[92:95], s61 offen
    v_cvt_pk_bf16_f32 v172, v48, v49
    v_cvt_pk_bf16_f32 v173, v50, v51
    v_cvt_pk_bf16_f32 v174, v52, v53
    v_cvt_pk_bf16_f32 v175, v54, v55
    v_mfma_f32_32x32x16_bf16 v[56:71], a[140:143], v[140:143], v[56:71]
    v_cvt_pk_bf16_f32 v30, v30, v31
    v_cvt_pk_bf16_f32 v31, v32, v33
    v_lshlrev_b32 v16, 16, v30
    v_and_b32 v17, 0xffff0000, v30
    v_lshlrev_b32 v18, 16, v178
    v_mfma_f32_32x32x16_bf16 v[56:71], a[180:183], v[144:147], v[56:71]
    s_add_u32 s61, s42, 104448
    buffer_store_dwordx4 v[172:175], v191, s[92:95], s61 offen
    v_mfma_f32_32x32x16_bf16 v[56:71], a[220:223], v[148:151], v[56:71]
    v_and_b32 v19, 0xffff0000, v178
    v_mul_f32 v16, v16, v18
    v_mul_f32 v17, v17, v19
    v_cvt_pk_bf16_f32 v17, v16, v17
    v_lshlrev_b32 v18, 16, v176
    v_mfma_f32_32x32x16_bf16 v[56:71], v[196:199], v[152:155], v[56:71]
    v_and_b32 v19, 0xffff0000, v176
    v_lshlrev_b32 v16, 16, v17
    v_and_b32 v17, 0xffff0000, v17
    v_add_f32 v16, v16, v18
    v_add_f32 v17, v17, v19
    s_mov_b32 m0, s28
    s_nop 0
    buffer_load_dwordx4 v1, s[88:91], s46 offen  lds
    v_mfma_f32_32x32x16_bf16 v[56:71], v[236:239], v[156:159], v[56:71]
    v_cvt_pk_bf16_f32 v22, v16, v17
    v_lshlrev_b32 v16, 16, v31
    v_and_b32 v17, 0xffff0000, v31
    v_lshlrev_b32 v18, 16, v179
    v_and_b32 v19, 0xffff0000, v179
    v_mfma_f32_32x32x16_bf16 v[40:55], a[28:31], v[128:131], 0
    v_mul_f32 v16, v16, v18
    v_mul_f32 v17, v17, v19
    v_cvt_pk_bf16_f32 v17, v16, v17
    v_lshlrev_b32 v18, 16, v177
    v_and_b32 v19, 0xffff0000, v177
    buffer_load_dwordx4 v1, s[88:91], s46 offen offset:1024  lds
    ds_read_b128 v[96:99], v35 offset:0
    v_mfma_f32_32x32x16_bf16 v[40:55], a[68:71], v[132:135], v[40:55]
    v_cvt_pk_bf16_f32 v160, v56, v57
    v_cvt_pk_bf16_f32 v161, v58, v59
    v_cvt_pk_bf16_f32 v162, v60, v61
    v_cvt_pk_bf16_f32 v163, v62, v63
    ds_read_b128 v[100:103], v35 offset:1024
    v_mfma_f32_32x32x16_bf16 v[40:55], a[108:111], v[136:139], v[40:55]
    s_add_u32 s61, s42, 139264
    buffer_store_dwordx4 v[160:163], v191, s[92:95], s61 offen
    v_cvt_pk_bf16_f32 v164, v64, v65
    v_cvt_pk_bf16_f32 v165, v66, v67
    v_cvt_pk_bf16_f32 v166, v68, v69
    v_cvt_pk_bf16_f32 v167, v70, v71
    ds_read_b128 v[104:107], v35 offset:20480
    v_mfma_f32_32x32x16_bf16 v[40:55], a[148:151], v[140:143], v[40:55]
    v_lshlrev_b32 v16, 16, v17
    v_and_b32 v17, 0xffff0000, v17
    v_add_f32 v16, v16, v18
    v_add_f32 v17, v17, v19
    v_cvt_pk_bf16_f32 v23, v16, v17
    buffer_load_dwordx2 v[180:181], v5, s[88:91], s46 offen
    ds_read_b128 v[108:111], v35 offset:21504
    v_mfma_f32_32x32x16_bf16 v[40:55], a[188:191], v[144:147], v[40:55]
    s_add_u32 s61, s42, 174080
    buffer_store_dwordx4 v[164:167], v191, s[92:95], s61 offen
    ds_read_b128 v[112:115], v35 offset:40960
    v_mfma_f32_32x32x16_bf16 v[40:55], a[228:231], v[148:151], v[40:55]
    buffer_store_dwordx2 v[22:23], v188, s[80:83], s58 offen
    s_mov_b32 s43, s37
    ds_read_b128 v[116:119], v35 offset:41984
    v_mfma_f32_32x32x16_bf16 v[40:55], v[204:207], v[152:155], v[40:55]
    buffer_load_dwordx2 v[176:177], v188, s[72:75], s49 offen
    s_mul_i32 s82, s37, 2621440
    ds_read_b128 v[120:123], v35 offset:61440
    v_mfma_f32_32x32x16_bf16 v[40:55], v[244:247], v[156:159], v[40:55]
    buffer_load_dwordx2 v[178:179], v189, s[12:15], s49 offen
    ds_read_b128 v[124:127], v35 offset:62464
    v_mfma_f32_32x32x16_bf16 v[56:71], a[36:39], v[128:131], 0
    v_mfma_f32_32x32x16_bf16 v[56:71], a[76:79], v[132:135], v[56:71]
    v_cvt_pk_bf16_f32 v168, v40, v41
    v_cvt_pk_bf16_f32 v169, v42, v43
    v_cvt_pk_bf16_f32 v170, v44, v45
    v_cvt_pk_bf16_f32 v171, v46, v47
    v_mfma_f32_32x32x16_bf16 v[56:71], a[116:119], v[136:139], v[56:71]
    s_add_u32 s61, s42, 208896
    buffer_store_dwordx4 v[168:171], v191, s[92:95], s61 offen
    v_cvt_pk_bf16_f32 v172, v48, v49
    v_cvt_pk_bf16_f32 v173, v50, v51
    v_cvt_pk_bf16_f32 v174, v52, v53
    v_cvt_pk_bf16_f32 v175, v54, v55
    s_waitcnt lgkmcnt(0)
    v_mfma_f32_32x32x16_bf16 v[56:71], a[156:159], v[140:143], v[56:71]
    ds_read_b128 v[16:19], v10 offset:0
    v_mfma_f32_32x32x16_bf16 v[56:71], a[196:199], v[144:147], v[56:71]
    s_add_u32 s61, s42, 243712
    buffer_store_dwordx4 v[172:175], v191, s[92:95], s61 offen
    ds_read_b128 v[20:23], v11 offset:0
    v_mfma_f32_32x32x16_bf16 v[56:71], a[236:239], v[148:151], v[56:71]
    ds_read_b128 v[24:27], v12 offset:0
    v_mfma_f32_32x32x16_bf16 v[56:71], v[212:215], v[152:155], v[56:71]
    ds_read_b128 v[28:31], v13 offset:0
    v_mfma_f32_32x32x16_bf16 v[56:71], v[252:255], v[156:159], v[56:71]
    ds_read_b128 v[32:35], v10 offset:4096
    s_add_u32 s25, s25, 1
    s_mov_b32 s23, s59
    s_cmp_lt_u32 s59, 64
    s_cbranch_scc1 W_att
    s_nop 6
    v_cvt_pk_bf16_f32 v160, v56, v57
    v_cvt_pk_bf16_f32 v161, v58, v59
    v_cvt_pk_bf16_f32 v162, v60, v61
    v_cvt_pk_bf16_f32 v163, v62, v63
    s_add_u32 s61, s42, 278528
    buffer_store_dwordx4 v[160:163], v191, s[92:95], s61 offen
    v_cvt_pk_bf16_f32 v164, v64, v65
    v_cvt_pk_bf16_f32 v165, v66, v67
    v_cvt_pk_bf16_f32 v166, v68, v69
    v_cvt_pk_bf16_f32 v167, v70, v71
    s_add_u32 s61, s42, 313344
    buffer_store_dwordx4 v[164:167], v191, s[92:95], s61 offen
    s_waitcnt vmcnt(0) lgkmcnt(0)
    s_barrier
    v_mov_b32 v183, s25
    s_mov_b64 exec, s[54:55]
    buffer_store_dword v183, off, s[12:15], s20
    s_mov_b64 exec, -1
    s_cmp_eq_u32 s43, 0
    s_cbranch_scc1 W_exit
    s_mov_b32 s22, 262144
W_wo:
    buffer_load_dword v14, v190, s[12:15], s26 offen offset:0 sc1
    s_sub_u32 s22, s22, 1
    s_cbranch_scc1 W_fail
    s_waitcnt vmcnt(0)
    v_cmp_gt_u32 vcc, s25, v14
    s_cbranch_vccnz W_wo
    s_add_u32 s47, s36, 0
    buffer_load_dwordx4 v[96:99], v1, s[12:15], s47 offen offset:0 sc1
    buffer_load_dwordx4 v[100:103], v1, s[12:15], s47 offen offset:1024 sc1
    buffer_load_dwordx4 v[104:107], v1, s[12:15], s47 offen offset:2048 sc1
    buffer_load_dwordx4 v[108:111], v1, s[12:15], s47 offen offset:3072 sc1
    s_add_u32 s47, s36, 4096
    buffer_load_dwordx4 v[112:115], v1, s[12:15], s47 offen offset:0 sc1
    buffer_load_dwordx4 v[116:119], v1, s[12:15], s47 offen offset:1024 sc1
    buffer_load_dwordx4 v[120:123], v1, s[12:15], s47 offen offset:2048 sc1
    buffer_load_dwordx4 v[124:127], v1, s[12:15], s47 offen offset:3072 sc1
    s_add_u32 s47, s36, 8192
    buffer_load_dwordx4 v[128:131], v1, s[12:15], s47 offen offset:0 sc1
    buffer_load_dwordx4 v[132:135], v1, s[12:15], s47 offen offset:1024 sc1
    buffer_load_dwordx4 v[136:139], v1, s[12:15], s47 offen offset:2048 sc1
    buffer_load_dwordx4 v[140:143], v1, s[12:15], s47 offen offset:3072 sc1
    s_add_u32 s47, s36, 12288
    buffer_load_dwordx4 v[144:147], v1, s[12:15], s47 offen offset:0 sc1
    buffer_load_dwordx4 v[148:151], v1, s[12:15], s47 offen offset:1024 sc1
    buffer_load_dwordx4 v[152:155], v1, s[12:15], s47 offen offset:2048 sc1
    buffer_load_dwordx4 v[156:159], v1, s[12:15], s47 offen offset:3072 sc1
    s_waitcnt vmcnt(15)
    v_mfma_f32_16x16x32_bf16 v[30:33], v[184:187], v[96:99], 0
    s_waitcnt vmcnt(14)
    v_mfma_f32_16x16x32_bf16 v[30:33], v[184:187], v[100:103], v[30:33]
    s_waitcnt vmcnt(13)
    v_mfma_f32_16x16x32_bf16 v[30:33], v[184:187], v[104:107], v[30:33]
    s_waitcnt vmcnt(12)
    v_mfma_f32_16x16x32_bf16 v[30:33], v[184:187], v[108:111], v[30:33]
    s_waitcnt vmcnt(11)
    v_mfma_f32_16x16x32_bf16 v[30:33], v[184:187], v[112:115], v[30:33]
    s_waitcnt vmcnt(10)
    v_mfma_f32_16x16x32_bf16 v[30:33], v[184:187], v[116:119], v[30:33]
    s_waitcnt vmcnt(9)
    v_mfma_f32_16x16x32_bf16 v[30:33], v[184:187], v[120:123], v[30:33]
    s_waitcnt vmcnt(8)
    v_mfma_f32_16x16x32_bf16 v[30:33], v[184:187], v[124:127], v[30:33]
    s_waitcnt vmcnt(7)
    v_mfma_f32_16x16x32_bf16 v[30:33], v[184:187], v[128:131], v[30:33]
    s_waitcnt vmcnt(6)
    v_mfma_f32_16x16x32_bf16 v[30:33], v[184:187], v[132:135], v[30:33]
    s_waitcnt vmcnt(5)
    v_mfma_f32_16x16x32_bf16 v[30:33], v[184:187], v[136:139], v[30:33]
    s_waitcnt vmcnt(4)
    v_mfma_f32_16x16x32_bf16 v[30:33], v[184:187], v[140:143], v[30:33]
    s_waitcnt vmcnt(3)
    v_mfma_f32_16x16x32_bf16 v[30:33], v[184:187], v[144:147], v[30:33]
    s_waitcnt vmcnt(2)
    v_mfma_f32_16x16x32_bf16 v[30:33], v[184:187], v[148:151], v[30:33]
    s_waitcnt vmcnt(1)
    v_mfma_f32_16x16x32_bf16 v[30:33], v[184:187], v[152:155], v[30:33]
    s_waitcnt vmcnt(0)
    v_mfma_f32_16x16x32_bf16 v[30:33], v[184:187], v[156:159], v[30:33]
W_fi:
    s_nop 7
    v_cvt_pk_bf16_f32 v30, v30, v31
    v_cvt_pk_bf16_f32 v31, v32, v33
    v_lshlrev_b32 v16, 16, v30
    v_and_b32 v17, 0xffff0000, v30
    v_lshlrev_b32 v18, 16, v178
    v_and_b32 v19, 0xffff0000, v178
    v_mul_f32 v16, v16, v18
    v_mul_f32 v17, v17, v19
    v_cvt_pk_bf16_f32 v17, v16, v17
    v_lshlrev_b32 v18, 16, v176
    v_and_b32 v19, 0xffff0000, v176
    v_lshlrev_b32 v16, 16, v17
    v_and_b32 v17, 0xffff0000, v17
    v_add_f32 v16, v16, v18
    v_add_f32 v17, v17, v19
    v_cvt_pk_bf16_f32 v22, v16, v17
    v_lshlrev_b32 v16, 16, v31
    v_and_b32 v17, 0xffff0000, v31
    v_lshlrev_b32 v18, 16, v179
    v_and_b32 v19, 0xffff0000, v179
    v_mul_f32 v16, v16, v18
    v_mul_f32 v17, v17, v19
    v_cvt_pk_bf16_f32 v17, v16, v17
    v_lshlrev_b32 v18, 16, v177
    v_and_b32 v19, 0xffff0000, v177
    v_lshlrev_b32 v16, 16, v17
    v_and_b32 v17, 0xffff0000, v17
    v_add_f32 v16, v16, v18
    v_add_f32 v17, v17, v19
    v_cvt_pk_bf16_f32 v23, v16, v17
    buffer_store_dwordx2 v[22:23], v188, s[80:83], s49 offen
    s_branch W_exit
W_s0:
    s_waitcnt lgkmcnt(7)
    v_mfma_f32_32x32x16_bf16 v[72:87], v[96:99], v[128:131], 0
    s_waitcnt lgkmcnt(6)
    v_mfma_f32_32x32x16_bf16 v[72:87], v[100:103], v[132:135], v[72:87]
    ds_read_b64_tr_b16 v[96:97], v7 offset:0
    ds_read_b64_tr_b16 v[98:99], v7 offset:64
    s_waitcnt lgkmcnt(7)
    v_mfma_f32_32x32x16_bf16 v[72:87], v[104:107], v[136:139], v[72:87]
    ds_read_b64_tr_b16 v[100:101], v7 offset:128
    ds_read_b64_tr_b16 v[102:103], v7 offset:192
    s_waitcnt lgkmcnt(8)
    v_mfma_f32_32x32x16_bf16 v[72:87], v[108:111], v[140:143], v[72:87]
    ds_read_b64_tr_b16 v[104:105], v7 offset:512
    ds_read_b64_tr_b16 v[106:107], v7 offset:576
    s_waitcnt lgkmcnt(9)
    v_mfma_f32_32x32x16_bf16 v[72:87], v[112:115], v[144:147], v[72:87]
    ds_read_b64_tr_b16 v[108:109], v7 offset:640
    ds_read_b64_tr_b16 v[110:111], v7 offset:704
    s_waitcnt lgkmcnt(10)
    v_mfma_f32_32x32x16_bf16 v[72:87], v[116:119], v[148:151], v[72:87]
    ds_read_b64_tr_b16 v[112:113], v7 offset:1024
    ds_read_b64_tr_b16 v[114:115], v7 offset:1088
    s_waitcnt lgkmcnt(11)
    v_mfma_f32_32x32x16_bf16 v[72:87], v[120:123], v[152:155], v[72:87]
    ds_read_b64_tr_b16 v[116:117], v7 offset:1152
    ds_read_b64_tr_b16 v[118:119], v7 offset:1216
    s_waitcnt lgkmcnt(12)
    v_mfma_f32_32x32x16_bf16 v[72:87], v[124:127], v[156:159], v[72:87]
    ds_read_b64_tr_b16 v[120:121], v7 offset:1536
    ds_read_b64_tr_b16 v[122:123], v7 offset:1600
    s_waitcnt lgkmcnt(12)
    v_mfma_f32_32x32x16_bf16 v[56:71], v[96:99], v[128:131], 0
    ds_read_b64_tr_b16 v[124:125], v7 offset:1664
    ds_read_b64_tr_b16 v[126:127], v7 offset:1728
    s_waitcnt lgkmcnt(12)
    v_mfma_f32_32x32x16_bf16 v[56:71], v[100:103], v[132:135], v[56:71]
    v_cmp_gt_i32 s[60:61], 0, v6
    v_cmp_gt_i32 s[62:63], 1, v6
    v_cmp_gt_i32 s[66:67], 2, v6
    v_cmp_gt_i32 vcc, 3, v6
    v_cndmask_b32 v72, v72, v3, s[60:61]
    v_cndmask_b32 v73, v73, v3, s[62:63]
    s_waitcnt lgkmcnt(10)
    v_mfma_f32_32x32x16_bf16 v[56:71], v[104:107], v[136:139], v[56:71]
    v_cndmask_b32 v74, v74, v3, s[66:67]
    v_cndmask_b32 v75, v75, v3, vcc
    v_cmp_gt_i32 s[60:61], 8, v6
    v_cmp_gt_i32 s[62:63], 9, v6
    v_cmp_gt_i32 s[66:67], 10, v6
    v_cmp_gt_i32 vcc, 11, v6
    s_waitcnt lgkmcnt(8)
    v_mfma_f32_32x32x16_bf16 v[56:71], v[108:111], v[140:143], v[56:71]
    v_cndmask_b32 v76, v76, v3, s[60:61]
    v_cndmask_b32 v77, v77, v3, s[62:63]
    v_cndmask_b32 v78, v78, v3, s[66:67]
    v_cndmask_b32 v79, v79, v3, vcc
    v_cmp_gt_i32 s[60:61], 16, v6
    v_cmp_gt_i32 s[62:63], 17, v6
    s_waitcnt lgkmcnt(6)
    v_mfma_f32_32x32x16_bf16 v[56:71], v[112:115], v[144:147], v[56:71]
    v_cmp_gt_i32 s[66:67], 18, v6
    v_cmp_gt_i32 vcc, 19, v6
    v_cndmask_b32 v80, v80, v3, s[60:61]
    v_cndmask_b32 v81, v81, v3, s[62:63]
    v_cndmask_b32 v82, v82, v3, s[66:67]
    v_cndmask_b32 v83, v83, v3, vcc
    s_waitcnt lgkmcnt(4)
    v_mfma_f32_32x32x16_bf16 v[56:71], v[116:119], v[148:151], v[56:71]
    v_cmp_gt_i32 s[60:61], 24, v6
    v_cmp_gt_i32 s[62:63], 25, v6
    v_cmp_gt_i32 s[66:67], 26, v6
    v_cmp_gt_i32 vcc, 27, v6
    v_cndmask_b32 v84, v84, v3, s[60:61]
    v_cndmask_b32 v85, v85, v3, s[62:63]
    s_waitcnt lgkmcnt(2)
    v_mfma_f32_32x32x16_bf16 v[56:71], v[120:123], v[152:155], v[56:71]
    v_cndmask_b32 v86, v86, v3, s[66:67]
    v_cndmask_b32 v87, v87, v3, vcc
    v_max3_f32 v183, v72, v73, v74
    v_max3_f32 v183, v183, v75, v76
    v_max3_f32 v183, v183, v77, v78
    v_max3_f32 v183, v183, v79, v80
    s_waitcnt lgkmcnt(0)
    v_mfma_f32_32x32x16_bf16 v[56:71], v[124:127], v[156:159], v[56:71]
    v_max3_f32 v183, v183, v81, v82
    v_max3_f32 v183, v183, v83, v84
    v_max3_f32 v183, v183, v85, v86
    v_max_f32 v183, v183, v87
    s_branch W_soft
W_late:
    s_cmp_eq_u32 s43, 0
    s_cbranch_scc1 W_l0
    s_add_u32 s47, s36, 0
    s_add_u32 m0, s38, 0
    s_nop 0
    buffer_load_dwordx4 v1, s[12:15], s47 offen offset:0 sc1 lds
    buffer_load_dwordx4 v1, s[12:15], s47 offen offset:1024 sc1 lds
    buffer_load_dwordx4 v1, s[12:15], s47 offen offset:2048 sc1 lds
    buffer_load_dwordx4 v1, s[12:15], s47 offen offset:3072 sc1 lds
    s_add_u32 s47, s36, 4096
    s_add_u32 m0, s38, 4096
    s_nop 0
    buffer_load_dwordx4 v1, s[12:15], s47 offen offset:0 sc1 lds
    buffer_load_dwordx4 v1, s[12:15], s47 offen offset:1024 sc1 lds
    buffer_load_dwordx4 v1, s[12:15], s47 offen offset:2048 sc1 lds
    buffer_load_dwordx4 v1, s[12:15], s47 offen offset:3072 sc1 lds
    s_add_u32 s47, s36, 8192
    s_add_u32 m0, s38, 8192
    s_nop 0
    buffer_load_dwordx4 v1, s[12:15], s47 offen offset:0 sc1 lds
    buffer_load_dwordx4 v1, s[12:15], s47 offen offset:1024 sc1 lds
    buffer_load_dwordx4 v1, s[12:15], s47 offen offset:2048 sc1 lds
    buffer_load_dwordx4 v1, s[12:15], s47 offen offset:3072 sc1 lds
    s_add_u32 s47, s36, 12288
    s_add_u32 m0, s38, 12288
    s_nop 0
    buffer_load_dwordx4 v1, s[12:15], s47 offen offset:0 sc1 lds
    buffer_load_dwordx4 v1, s[12:15], s47 offen offset:1024 sc1 lds
    buffer_load_dwordx4 v1, s[12:15], s47 offen offset:2048 sc1 lds
    buffer_load_dwordx4 v1, s[12:15], s47 offen offset:3072 sc1 lds
W_l0:
    s_waitcnt lgkmcnt(7)
    v_mfma_f32_32x32x16_bf16 v[72:87], v[96:99], v[128:131], 0
    s_waitcnt lgkmcnt(6)
    v_mfma_f32_32x32x16_bf16 v[72:87], v[100:103], v[132:135], v[72:87]
    s_waitcnt lgkmcnt(5)
    v_mfma_f32_32x32x16_bf16 v[72:87], v[104:107], v[136:139], v[72:87]
    s_waitcnt lgkmcnt(4)
    v_mfma_f32_32x32x16_bf16 v[72:87], v[108:111], v[140:143], v[72:87]
    s_waitcnt lgkmcnt(3)
    v_mfma_f32_32x32x16_bf16 v[72:87], v[112:115], v[144:147], v[72:87]
    s_waitcnt lgkmcnt(2)
    v_mfma_f32_32x32x16_bf16 v[72:87], v[116:119], v[148:151], v[72:87]
    s_waitcnt lgkmcnt(1)
    v_mfma_f32_32x32x16_bf16 v[72:87], v[120:123], v[152:155], v[72:87]
    s_waitcnt lgkmcnt(0)
    v_mfma_f32_32x32x16_bf16 v[72:87], v[124:127], v[156:159], v[72:87]
    v_cmp_gt_i32 s[60:61], 0, v6
    v_cmp_gt_i32 s[62:63], 1, v6
    v_cmp_gt_i32 s[66:67], 2, v6
    v_cmp_gt_i32 vcc, 3, v6
    s_nop 7
    v_cndmask_b32 v72, v72, v3, s[60:61]
    v_cndmask_b32 v73, v73, v3, s[62:63]
    v_cndmask_b32 v74, v74, v3, s[66:67]
    v_cndmask_b32 v75, v75, v3, vcc
    v_cmp_gt_i32 s[60:61], 8, v6
    v_cmp_gt_i32 s[62:63], 9, v6
    v_cmp_gt_i32 s[66:67], 10, v6
    v_cmp_gt_i32 vcc, 11, v6
    v_cndmask_b32 v76, v76, v3, s[60:61]
    v_cndmask_b32 v77, v77, v3, s[62:63]
    v_cndmask_b32 v78, v78, v3, s[66:67]
    v_cndmask_b32 v79, v79, v3, vcc
    v_cmp_gt_i32 s[60:61], 16, v6
    v_cmp_gt_i32 s[62:63], 17, v6
    v_cmp_gt_i32 s[66:67], 18, v6
    v_cmp_gt_i32 vcc, 19, v6
    v_cndmask_b32 v80, v80, v3, s[60:61]
    v_cndmask_b32 v81, v81, v3, s[62:63]
    v_cndmask_b32 v82, v82, v3, s[66:67]
    v_cndmask_b32 v83, v83, v3, vcc
    v_cmp_gt_i32 s[60:61], 24, v6
    v_cmp_gt_i32 s[62:63], 25, v6
    v_cmp_gt_i32 s[66:67], 26, v6
    v_cmp_gt_i32 vcc, 27, v6
    v_cndmask_b32 v84, v84, v3, s[60:61]
    v_cndmask_b32 v85, v85, v3, s[62:63]
    v_cndmask_b32 v86, v86, v3, s[66:67]
    v_cndmask_b32 v87, v87, v3, vcc
    v_max3_f32 v183, v72, v73, v74
    v_max3_f32 v183, v183, v75, v76
    v_max3_f32 v183, v183, v77, v78
    v_max3_f32 v183, v183, v79, v80
    v_max3_f32 v183, v183, v81, v82
    v_max3_f32 v183, v183, v83, v84
    v_max3_f32 v183, v183, v85, v86
    v_max_f32 v183, v183, v87
    s_mov_b32 s63, 0
    s_cmp_ge_u32 s23, 58
    s_cbranch_scc1 W_dp
    s_cmp_eq_u32 s10, 3
    s_cbranch_scc0 W_wn
W_wm:
    buffer_load_dwordx2 v[14:15], off, s[12:15], s41 sc1
    s_sub_u32 s22, s22, 1
    s_cbranch_scc1 W_fail
    s_waitcnt vmcnt(0)
    v_min_u32 v14, v14, v15
    v_cmp_ge_u32 vcc, s23, v14
    s_cbranch_vccnz W_wm
W_wn:
    s_barrier
    s_mov_b32 m0, s28
    s_nop 0
    buffer_load_dwordx4 v1, s[12:15], s46 offen  lds
    buffer_load_dwordx4 v1, s[12:15], s46 offen offset:1024  lds
    buffer_load_dwordx2 v[180:181], v5, s[12:15], s46 offen
    s_waitcnt vmcnt(1)
W_km:
    ds_read_b64_tr_b16 v[96:97], v7 offset:0
    ds_read_b64_tr_b16 v[98:99], v7 offset:64
    ds_read_b64_tr_b16 v[100:101], v7 offset:128
    ds_read_b64_tr_b16 v[102:103], v7 offset:192
    ds_read_b64_tr_b16 v[104:105], v7 offset:512
    ds_read_b64_tr_b16 v[106:107], v7 offset:576
    ds_read_b64_tr_b16 v[108:109], v7 offset:640
    ds_read_b64_tr_b16 v[110:111], v7 offset:704
    ds_read_b64_tr_b16 v[112:113], v7 offset:1024
    ds_read_b64_tr_b16 v[114:115], v7 offset:1088
    ds_read_b64_tr_b16 v[116:117], v7 offset:1152
    ds_read_b64_tr_b16 v[118:119], v7 offset:1216
    ds_read_b64_tr_b16 v[120:121], v7 offset:1536
    ds_read_b64_tr_b16 v[122:123], v7 offset:1600
    ds_read_b64_tr_b16 v[124:125], v7 offset:1664
    ds_read_b64_tr_b16 v[126:127], v7 offset:1728
    v_add_u32 v7, s63, v7
    s_waitcnt lgkmcnt(14)
    v_mfma_f32_32x32x16_bf16 v[56:71], v[96:99], v[128:131], 0
    s_waitcnt lgkmcnt(12)
    v_mfma_f32_32x32x16_bf16 v[56:71], v[100:103], v[132:135], v[56:71]
    s_waitcnt lgkmcnt(10)
    v_mfma_f32_32x32x16_bf16 v[56:71], v[104:107], v[136:139], v[56:71]
    s_waitcnt lgkmcnt(8)
    v_mfma_f32_32x32x16_bf16 v[56:71], v[108:111], v[140:143], v[56:71]
    s_waitcnt lgkmcnt(6)
    v_mfma_f32_32x32x16_bf16 v[56:71], v[112:115], v[144:147], v[56:71]
    s_waitcnt lgkmcnt(4)
    v_mfma_f32_32x32x16_bf16 v[56:71], v[116:119], v[148:151], v[56:71]
    s_waitcnt lgkmcnt(2)
    v_mfma_f32_32x32x16_bf16 v[56:71], v[120:123], v[152:155], v[56:71]
    s_waitcnt lgkmcnt(0)
    v_mfma_f32_32x32x16_bf16 v[56:71], v[124:127], v[156:159], v[56:71]
    s_waitcnt vmcnt(0)
    s_branch W_soft
W_dp:
    s_sub_u32 s47, s46, 2048
    s_sub_u32 s63, s28, 81920
    v_subrev_u32 v7, s63, v7
    v_add_u32 v15, 79872, v5
    s_cmp_lt_u32 s59, 64
    s_cbranch_scc1 W_dq
    v_mov_b32 v16, v183
    v_mov_b32 v17, v183
    v_add_u32 v34, s38, v1
    v_mov_b32 v182, s25
    v_permlane32_swap_b32 v16, v17
    v_max_f32 v16, v16, v17
    v_mul_f32 v36, s40, v16
    v_pk_fma_f32 v[72:73], v[72:73], s[40:41], v[36:37] op_sel_hi:[1,0,0] neg_lo:[0,0,1] neg_hi:[0,0,1]
    v_pk_fma_f32 v[74:75], v[74:75], s[40:41], v[36:37] op_sel_hi:[1,0,0] neg_lo:[0,0,1] neg_hi:[0,0,1]
    v_pk_fma_f32 v[76:77], v[76:77], s[40:41], v[36:37] op_sel_hi:[1,0,0] neg_lo:[0,0,1] neg_hi:[0,0,1]
    v_pk_fma_f32 v[78:79], v[78:79], s[40:41], v[36:37] op_sel_hi:[1,0,0] neg_lo:[0,0,1] neg_hi:[0,0,1]
    v_pk_fma_f32 v[80:81], v[80:81], s[40:41], v[36:37] op_sel_hi:[1,0,0] neg_lo:[0,0,1] neg_hi:[0,0,1]
    v_pk_fma_f32 v[82:83], v[82:83], s[40:41], v[36:37] op_sel_hi:[1,0,0] neg_lo:[0,0,1] neg_hi:[0,0,1]
    v_pk_fma_f32 v[84:85], v[84:85], s[40:41], v[36:37] op_sel_hi:[1,0,0] neg_lo:[0,0,1] neg_hi:[0,0,1]
    v_pk_fma_f32 v[86:87], v[86:87], s[40:41], v[36:37] op_sel_hi:[1,0,0] neg_lo:[0,0,1] neg_hi:[0,0,1]
    v_exp_f32 v72, v72
    v_exp_f32 v73, v73
    v_exp_f32 v74, v74
    v_exp_f32 v75, v75
    v_exp_f32 v76, v76
    v_exp_f32 v77, v77
    v_exp_f32 v78, v78
    v_exp_f32 v79, v79
    v_exp_f32 v80, v80
    v_exp_f32 v81, v81
    v_exp_f32 v82, v82
    v_exp_f32 v83, v83
    v_exp_f32 v84, v84
    v_exp_f32 v85, v85
    v_exp_f32 v86, v86
    v_exp_f32 v87, v87
    v_cvt_pk_bf16_f32 v20, v72, v73
    v_cvt_pk_bf16_f32 v21, v74, v75
    v_cvt_pk_bf16_f32 v22, v76, v77
    v_cvt_pk_bf16_f32 v23, v78, v79
    v_cvt_pk_bf16_f32 v24, v80, v81
    v_cvt_pk_bf16_f32 v25, v82, v83
    v_cvt_pk_bf16_f32 v26, v84, v85
    v_cvt_pk_bf16_f32 v27, v86, v87
    v_mfma_f32_32x32x16_bf16 v[40:55], v[88:91], v[20:23], 0
    s_nop 0
    v_mfma_f32_32x32x16_bf16 v[40:55], v[92:95], v[24:27], v[40:55]
    v_add_f32 v72, v72, v73
    v_add_f32 v74, v74, v75
    v_add_f32 v76, v76, v77
    v_add_f32 v78, v78, v79
    v_add_f32 v80, v80, v81
    v_add_f32 v82, v82, v83
    v_add_f32 v84, v84, v85
    v_add_f32 v86, v86, v87
    v_add_f32 v72, v72, v74
    v_add_f32 v76, v76, v78
    v_add_f32 v80, v80, v82
    v_add_f32 v84, v84, v86
    v_add_f32 v72, v72, v76
    v_add_f32 v80, v80, v84
    v_add_f32 v37, v72, v80
    v_mov_b64 v[24:25], -1
    v_mov_b64 v[26:27], -1
    s_cmp_eq_u32 s43, 0
    s_waitcnt vmcnt(0)
    s_cbranch_scc1 W_dz
    s_add_u32 s61, s36, 0
    buffer_store_dwordx4 v[24:27], v1, s[12:15], s61 offen offset:0
    buffer_store_dwordx4 v[24:27], v1, s[12:15], s61 offen offset:1024
    buffer_store_dwordx4 v[24:27], v1, s[12:15], s61 offen offset:2048
    buffer_store_dwordx4 v[24:27], v1, s[12:15], s61 offen offset:3072
    s_add_u32 s61, s36, 4096
    buffer_store_dwordx4 v[24:27], v1, s[12:15], s61 offen offset:0
    buffer_store_dwordx4 v[24:27], v1, s[12:15], s61 offen offset:1024
    buffer_store_dwordx4 v[24:27], v1, s[12:15], s61 offen offset:2048
    buffer_store_dwordx4 v[24:27], v1, s[12:15], s61 offen offset:3072
    s_add_u32 s61, s36, 8192
    buffer_store_dwordx4 v[24:27], v1, s[12:15], s61 offen offset:0
    buffer_store_dwordx4 v[24:27], v1, s[12:15], s61 offen offset:1024
    buffer_store_dwordx4 v[24:27], v1, s[12:15], s61 offen offset:2048
    buffer_store_dwordx4 v[24:27], v1, s[12:15], s61 offen offset:3072
    s_add_u32 s61, s36, 12288
    buffer_store_dwordx4 v[24:27], v1, s[12:15], s61 offen offset:0
    buffer_store_dwordx4 v[24:27], v1, s[12:15], s61 offen offset:1024
    buffer_store_dwordx4 v[24:27], v1, s[12:15], s61 offen offset:2048
    buffer_store_dwordx4 v[24:27], v1, s[12:15], s61 offen offset:3072
W_dz:
    ds_read_b128 v[96:99], v34 offset:0
    ds_read_b128 v[100:103], v34 offset:1024
    ds_read_b128 v[104:107], v34 offset:2048
    ds_read_b128 v[108:111], v34 offset:3072
    ds_read_b128 v[112:115], v34 offset:4096
    ds_read_b128 v[116:119], v34 offset:5120
    ds_read_b128 v[120:123], v34 offset:6144
    ds_read_b128 v[124:127], v34 offset:7168
    s_waitcnt lgkmcnt(7)
    v_mfma_f32_16x16x32_bf16 v[30:33], v[184:187], v[96:99], 0
    s_waitcnt lgkmcnt(6)
    v_mfma_f32_16x16x32_bf16 v[30:33], v[184:187], v[100:103], v[30:33]
    s_waitcnt lgkmcnt(5)
    v_mfma_f32_16x16x32_bf16 v[30:33], v[184:187], v[104:107], v[30:33]
    s_waitcnt lgkmcnt(4)
    v_mfma_f32_16x16x32_bf16 v[30:33], v[184:187], v[108:111], v[30:33]
    s_waitcnt lgkmcnt(3)
    v_mfma_f32_16x16x32_bf16 v[30:33], v[184:187], v[112:115], v[30:33]
    s_waitcnt lgkmcnt(2)
    v_mfma_f32_16x16x32_bf16 v[30:33], v[184:187], v[116:119], v[30:33]
    s_waitcnt lgkmcnt(1)
    v_mfma_f32_16x16x32_bf16 v[30:33], v[184:187], v[120:123], v[30:33]
    s_waitcnt lgkmcnt(0)
    v_mfma_f32_16x16x32_bf16 v[30:33], v[184:187], v[124:127], v[30:33]
    ds_read_b128 v[96:99], v34 offset:8192
    ds_read_b128 v[100:103], v34 offset:9216
    ds_read_b128 v[104:107], v34 offset:10240
    ds_read_b128 v[108:111], v34 offset:11264
    ds_read_b128 v[112:115], v34 offset:12288
    ds_read_b128 v[116:119], v34 offset:13312
    ds_read_b128 v[120:123], v34 offset:14336
    ds_read_b128 v[124:127], v34 offset:15360
    s_waitcnt lgkmcnt(7)
    v_mfma_f32_16x16x32_bf16 v[30:33], v[184:187], v[96:99], v[30:33]
    s_waitcnt lgkmcnt(6)
    v_mfma_f32_16x16x32_bf16 v[30:33], v[184:187], v[100:103], v[30:33]
    s_waitcnt lgkmcnt(5)
    v_mfma_f32_16x16x32_bf16 v[30:33], v[184:187], v[104:107], v[30:33]
    s_waitcnt lgkmcnt(4)
    v_mfma_f32_16x16x32_bf16 v[30:33], v[184:187], v[108:111], v[30:33]
    s_waitcnt lgkmcnt(3)
    v_mfma_f32_16x16x32_bf16 v[30:33], v[184:187], v[112:115], v[30:33]
    s_waitcnt lgkmcnt(2)
    v_mfma_f32_16x16x32_bf16 v[30:33], v[184:187], v[116:119], v[30:33]
    s_waitcnt lgkmcnt(1)
    v_mfma_f32_16x16x32_bf16 v[30:33], v[184:187], v[120:123], v[30:33]
    s_waitcnt lgkmcnt(0)
    v_mfma_f32_16x16x32_bf16 v[30:33], v[184:187], v[124:127], v[30:33]
    s_waitcnt vmcnt(0)
    s_mov_b64 exec, 1
    buffer_store_dword v182, off, s[12:15], s18 offset:512
    s_mov_b64 exec, -1
    s_nop 3
    v_cvt_pk_bf16_f32 v30, v30, v31
    v_cvt_pk_bf16_f32 v31, v32, v33
    v_lshlrev_b32 v16, 16, v30
    v_and_b32 v17, 0xffff0000, v30
    v_lshlrev_b32 v18, 16, v178
    v_and_b32 v19, 0xffff0000, v178
    v_mul_f32 v16, v16, v18
    v_mul_f32 v17, v17, v19
    v_cvt_pk_bf16_f32 v17, v16, v17
    v_lshlrev_b32 v18, 16, v176
    v_and_b32 v19, 0xffff0000, v176
    v_lshlrev_b32 v16, 16, v17
    v_and_b32 v17, 0xffff0000, v17
    v_add_f32 v16, v16, v18
    v_add_f32 v17, v17, v19
    v_cvt_pk_bf16_f32 v22, v16, v17
    v_lshlrev_b32 v16, 16, v31
    v_and_b32 v17, 0xffff0000, v31
    v_lshlrev_b32 v18, 16, v179
    v_and_b32 v19, 0xffff0000, v179
    v_mul_f32 v16, v16, v18
    v_mul_f32 v17, v17, v19
    v_cvt_pk_bf16_f32 v17, v16, v17
    v_lshlrev_b32 v18, 16, v177
    v_and_b32 v19, 0xffff0000, v177
    v_lshlrev_b32 v16, 16, v17
    v_and_b32 v17, 0xffff0000, v17
    v_add_f32 v16, v16, v18
    v_add_f32 v17, v17, v19
    v_cvt_pk_bf16_f32 v23, v16, v17
    buffer_store_dwordx2 v[22:23], v188, s[80:83], s58 offen
    buffer_load_dwordx2 v[176:177], v188, s[72:75], s49 offen
    buffer_load_dwordx2 v[178:179], v189, s[12:15], s49 offen
W_dy:
    v_lshlrev_b32 v14, 1, v2
    buffer_load_dwordx2 v[14:15], v14, s[12:15], s26 offen offset:512 sc1
    s_sub_u32 s22, s22, 1
    s_cbranch_scc1 W_fail
    s_waitcnt vmcnt(0)
    v_min_u32 v14, v14, v15
    v_cmp_gt_u32 vcc, s25, v14
    s_cbranch_vccnz W_dy
    v_add_u32 v15, 79872, v5
    s_add_u32 s25, s25, 1
W_dq:
    buffer_load_dwordx2 v[160:161], v5, s[12:15], s47 offen sc1
    buffer_load_dwordx2 v[162:163], v5, s[12:15], s46 offen sc1
    s_waitcnt vmcnt(0)
    v_max_u32 v14, v160, v162
    v_cmp_eq_u32 vcc, -1, v14
    s_cbranch_vccz W_dr0
    s_sub_u32 s22, s22, 1
    s_cbranch_scc1 W_fail
    s_branch W_dq
W_dr0:
    ds_write_b64 v15, v[160:161]
    v_mov_b64 v[180:181], v[162:163]
    s_waitcnt lgkmcnt(0)
    s_barrier
    s_cmp_lt_u32 s59, 64
    s_cbranch_scc1 W_km
    ds_read_b64_tr_b16 v[96:97], v7 offset:0
    ds_read_b64_tr_b16 v[98:99], v7 offset:64
    ds_read_b64_tr_b16 v[100:101], v7 offset:128
    ds_read_b64_tr_b16 v[102:103], v7 offset:192
    ds_read_b64_tr_b16 v[104:105], v7 offset:512
    ds_read_b64_tr_b16 v[106:107], v7 offset:576
    ds_read_b64_tr_b16 v[108:109], v7 offset:640
    ds_read_b64_tr_b16 v[110:111], v7 offset:704
    ds_read_b64_tr_b16 v[112:113], v7 offset:1024
    ds_read_b64_tr_b16 v[114:115], v7 offset:1088
    ds_read_b64_tr_b16 v[116:117], v7 offset:1152
    ds_read_b64_tr_b16 v[118:119], v7 offset:1216
    ds_read_b64_tr_b16 v[120:121], v7 offset:1536
    ds_read_b64_tr_b16 v[122:123], v7 offset:1600
    ds_read_b64_tr_b16 v[124:125], v7 offset:1664
    ds_read_b64_tr_b16 v[126:127], v7 offset:1728
    s_waitcnt lgkmcnt(14)
    v_mfma_f32_32x32x16_bf16 v[56:71], v[96:99], v[128:131], 0
    s_waitcnt lgkmcnt(12)
    v_mfma_f32_32x32x16_bf16 v[56:71], v[100:103], v[132:135], v[56:71]
    s_waitcnt lgkmcnt(10)
    v_mfma_f32_32x32x16_bf16 v[56:71], v[104:107], v[136:139], v[56:71]
    s_waitcnt lgkmcnt(8)
    v_mfma_f32_32x32x16_bf16 v[56:71], v[108:111], v[140:143], v[56:71]
    s_waitcnt lgkmcnt(6)
    v_mfma_f32_32x32x16_bf16 v[56:71], v[112:115], v[144:147], v[56:71]
    s_waitcnt lgkmcnt(4)
    v_mfma_f32_32x32x16_bf16 v[56:71], v[116:119], v[148:151], v[56:71]
    s_waitcnt lgkmcnt(2)
    v_mfma_f32_32x32x16_bf16 v[56:71], v[120:123], v[152:155], v[56:71]
    s_waitcnt lgkmcnt(0)
    v_mfma_f32_32x32x16_bf16 v[56:71], v[124:127], v[156:159], v[56:71]
    s_nop 11
    v_max_f32 v16, v56, v57
    v_max3_f32 v17, v16, v58, v59
    v_max3_f32 v16, v16, v58, v59
    s_nop 1
    v_permlane32_swap_b32 v16, v17
    v_max_f32 v16, v16, v17
    v_mul_f32 v16, s40, v16
    v_max_f32 v16, v16, v36
    v_pk_fma_f32 v[56:57], v[56:57], s[40:41], v[16:17] op_sel_hi:[1,0,0] neg_lo:[0,0,1] neg_hi:[0,0,1]
    v_pk_fma_f32 v[58:59], v[58:59], s[40:41], v[16:17] op_sel_hi:[1,0,0] neg_lo:[0,0,1] neg_hi:[0,0,1]
    v_sub_f32 v38, v36, v16
    v_exp_f32 v56, v56
    v_exp_f32 v57, v57
    v_exp_f32 v58, v58
    v_exp_f32 v59, v59
    v_exp_f32 v38, v38
    v_cvt_pk_bf16_f32 v28, v56, v57
    v_cvt_pk_bf16_f32 v29, v58, v59
    s_nop 1
    v_mfma_f32_32x32x8_bf16 v[72:87], v[180:181], v[28:29], 0
    v_add_f32 v56, v56, v57
    v_add_f32 v58, v58, v59
    v_add_f32 v56, v56, v58
    v_fma_f32 v16, v37, v38, v56
    v_fma_f32 v18, v37, v38, v56
    s_nop 1
    v_permlane32_swap_b32 v16, v18
    v_add_f32 v16, v16, v18
    v_rcp_f32 v16, v16
    s_nop 1
    v_pk_fma_f32 v[40:41], v[40:41], v[38:39], v[72:73] op_sel_hi:[1,0,1]
    v_pk_fma_f32 v[42:43], v[42:43], v[38:39], v[74:75] op_sel_hi:[1,0,1]
    v_pk_fma_f32 v[44:45], v[44:45], v[38:39], v[76:77] op_sel_hi:[1,0,1]
    v_pk_fma_f32 v[46:47], v[46:47], v[38:39], v[78:79] op_sel_hi:[1,0,1]
    v_pk_fma_f32 v[48:49], v[48:49], v[38:39], v[80:81] op_sel_hi:[1,0,1]
    v_pk_fma_f32 v[50:51], v[50:51], v[38:39], v[82:83] op_sel_hi:[1,0,1]
    v_pk_fma_f32 v[52:53], v[52:53], v[38:39], v[84:85] op_sel_hi:[1,0,1]
    v_pk_fma_f32 v[54:55], v[54:55], v[38:39], v[86:87] op_sel_hi:[1,0,1]
    v_pk_mul_f32 v[40:41], v[40:41], v[16:17] op_sel_hi:[1,0]
    v_pk_mul_f32 v[42:43], v[42:43], v[16:17] op_sel_hi:[1,0]
    v_pk_mul_f32 v[44:45], v[44:45], v[16:17] op_sel_hi:[1,0]
    v_pk_mul_f32 v[46:47], v[46:47], v[16:17] op_sel_hi:[1,0]
    v_pk_mul_f32 v[48:49], v[48:49], v[16:17] op_sel_hi:[1,0]
    v_pk_mul_f32 v[50:51], v[50:51], v[16:17] op_sel_hi:[1,0]
    v_pk_mul_f32 v[52:53], v[52:53], v[16:17] op_sel_hi:[1,0]
    v_pk_mul_f32 v[54:55], v[54:55], v[16:17] op_sel_hi:[1,0]
    v_cvt_pk_bf16_f32 v160, v40, v41
    v_cvt_pk_bf16_f32 v161, v42, v43
    v_cvt_pk_bf16_f32 v162, v44, v45
    v_cvt_pk_bf16_f32 v163, v46, v47
    v_cvt_pk_bf16_f32 v164, v48, v49
    v_cvt_pk_bf16_f32 v165, v50, v51
    v_cvt_pk_bf16_f32 v166, v52, v53
    v_cvt_pk_bf16_f32 v167, v54, v55
    ds_write_b128 v9, v[160:163] offset:8192
    ds_write_b128 v9, v[164:167] offset:9216
    s_waitcnt lgkmcnt(0)
    s_barrier
    ds_read_b128 v[128:131], v4 offset:8192
    ds_read_b128 v[132:135], v4 offset:9216
    ds_read_b128 v[136:139], v4 offset:10240
    ds_read_b128 v[140:143], v4 offset:11264
    ds_read_b128 v[144:147], v4 offset:12288
    ds_read_b128 v[148:151], v4 offset:13312
    ds_read_b128 v[152:155], v4 offset:14336
    ds_read_b128 v[156:159], v4 offset:15360
    s_waitcnt lgkmcnt(7)
    v_mfma_f32_32x32x16_bf16 v[56:71], a[4:7], v[128:131], 0
    s_waitcnt lgkmcnt(6)
    v_mfma_f32_32x32x16_bf16 v[56:71], a[44:47], v[132:135], v[56:71]
    s_waitcnt lgkmcnt(5)
    v_mfma_f32_32x32x16_bf16 v[56:71], a[84:87], v[136:139], v[56:71]
    s_waitcnt lgkmcnt(4)
    v_mfma_f32_32x32x16_bf16 v[56:71], a[124:127], v[140:143], v[56:71]
    s_waitcnt lgkmcnt(3)
    v_mfma_f32_32x32x16_bf16 v[56:71], a[164:167], v[144:147], v[56:71]
    s_waitcnt lgkmcnt(2)
    v_mfma_f32_32x32x16_bf16 v[56:71], a[204:207], v[148:151], v[56:71]
    s_waitcnt lgkmcnt(1)
    v_mfma_f32_32x32x16_bf16 v[56:71], a[244:247], v[152:155], v[56:71]
    s_waitcnt lgkmcnt(0)
    v_mfma_f32_32x32x16_bf16 v[56:71], v[220:223], v[156:159], v[56:71]
    v_mfma_f32_32x32x16_bf16 v[40:55], a[12:15], v[128:131], 0
    v_mfma_f32_32x32x16_bf16 v[40:55], a[52:55], v[132:135], v[40:55]
    v_cvt_pk_bf16_f32 v160, v56, v57
    v_cvt_pk_bf16_f32 v161, v58, v59
    v_cvt_pk_bf16_f32 v162, v60, v61
    v_cvt_pk_bf16_f32 v163, v62, v63
    v_mfma_f32_32x32x16_bf16 v[40:55], a[92:95], v[136:139], v[40:55]
    s_add_u32 s61, s42, 0
    buffer_store_dwordx4 v[160:163], v191, s[92:95], s61 offen
    v_cvt_pk_bf16_f32 v164, v64, v65
    v_cvt_pk_bf16_f32 v165, v66, v67
    v_cvt_pk_bf16_f32 v166, v68, v69
    v_cvt_pk_bf16_f32 v167, v70, v71
    v_mfma_f32_32x32x16_bf16 v[40:55], a[132:135], v[140:143], v[40:55]
    v_mfma_f32_32x32x16_bf16 v[40:55], a[172:175], v[144:147], v[40:55]
    s_add_u32 s61, s42, 34816
    buffer_store_dwordx4 v[164:167], v191, s[92:95], s61 offen
    v_mfma_f32_32x32x16_bf16 v[40:55], a[212:215], v[148:151], v[40:55]
    v_mfma_f32_32x32x16_bf16 v[40:55], a[252:255], v[152:155], v[40:55]
    v_mfma_f32_32x32x16_bf16 v[40:55], v[228:231], v[156:159], v[40:55]
    v_mfma_f32_32x32x16_bf16 v[56:71], a[20:23], v[128:131], 0
    v_mfma_f32_32x32x16_bf16 v[56:71], a[60:63], v[132:135], v[56:71]
    v_cvt_pk_bf16_f32 v168, v40, v41
    v_cvt_pk_bf16_f32 v169, v42, v43
    v_cvt_pk_bf16_f32 v170, v44, v45
    v_cvt_pk_bf16_f32 v171, v46, v47
    v_mfma_f32_32x32x16_bf16 v[56:71], a[100:103], v[136:139], v[56:71]
    s_add_u32 s61, s42, 69632
    buffer_store_dwordx4 v[168:171], v191, s[92:95], s61 offen
    v_cvt_pk_bf16_f32 v172, v48, v49
    v_cvt_pk_bf16_f32 v173, v50, v51
    v_cvt_pk_bf16_f32 v174, v52, v53
    v_cvt_pk_bf16_f32 v175, v54, v55
    v_mfma_f32_32x32x16_bf16 v[56:71], a[140:143], v[140:143], v[56:71]
    v_mfma_f32_32x32x16_bf16 v[56:71], a[180:183], v[144:147], v[56:71]
    s_add_u32 s61, s42, 104448
    buffer_store_dwordx4 v[172:175], v191, s[92:95], s61 offen
    v_mfma_f32_32x32x16_bf16 v[56:71], a[220:223], v[148:151], v[56:71]
    v_mfma_f32_32x32x16_bf16 v[56:71], v[196:199], v[152:155], v[56:71]
    v_mfma_f32_32x32x16_bf16 v[56:71], v[236:239], v[156:159], v[56:71]
    v_mfma_f32_32x32x16_bf16 v[40:55], a[28:31], v[128:131], 0
    v_mfma_f32_32x32x16_bf16 v[40:55], a[68:71], v[132:135], v[40:55]
    v_cvt_pk_bf16_f32 v160, v56, v57
    v_cvt_pk_bf16_f32 v161, v58, v59
    v_cvt_pk_bf16_f32 v162, v60, v61
    v_cvt_pk_bf16_f32 v163, v62, v63
    v_mfma_f32_32x32x16_bf16 v[40:55], a[108:111], v[136:139], v[40:55]
    s_add_u32 s61, s42, 139264
    buffer_store_dwordx4 v[160:163], v191, s[92:95], s61 offen
    v_cvt_pk_bf16_f32 v164, v64, v65
    v_cvt_pk_bf16_f32 v165, v66, v67
    v_cvt_pk_bf16_f32 v166, v68, v69
    v_cvt_pk_bf16_f32 v167, v70, v71
    v_mfma_f32_32x32x16_bf16 v[40:55], a[148:151], v[140:143], v[40:55]
    v_mfma_f32_32x32x16_bf16 v[40:55], a[188:191], v[144:147], v[40:55]
    s_add_u32 s61, s42, 174080
    buffer_store_dwordx4 v[164:167], v191, s[92:95], s61 offen
    v_mfma_f32_32x32x16_bf16 v[40:55], a[228:231], v[148:151], v[40:55]
    v_mfma_f32_32x32x16_bf16 v[40:55], v[204:207], v[152:155], v[40:55]
    v_mfma_f32_32x32x16_bf16 v[40:55], v[244:247], v[156:159], v[40:55]
    v_mfma_f32_32x32x16_bf16 v[56:71], a[36:39], v[128:131], 0
    v_mfma_f32_32x32x16_bf16 v[56:71], a[76:79], v[132:135], v[56:71]
    v_cvt_pk_bf16_f32 v168, v40, v41
    v_cvt_pk_bf16_f32 v169, v42, v43
    v_cvt_pk_bf16_f32 v170, v44, v45
    v_cvt_pk_bf16_f32 v171, v46, v47
    v_mfma_f32_32x32x16_bf16 v[56:71], a[116:119], v[136:139], v[56:71]
    s_add_u32 s61, s42, 208896
    buffer_store_dwordx4 v[168:171], v191, s[92:95], s61 offen
    v_cvt_pk_bf16_f32 v172, v48, v49
    v_cvt_pk_bf16_f32 v173, v50, v51
    v_cvt_pk_bf16_f32 v174, v52, v53
    v_cvt_pk_bf16_f32 v175, v54, v55
    v_mfma_f32_32x32x16_bf16 v[56:71], a[156:159], v[140:143], v[56:71]
    v_mfma_f32_32x32x16_bf16 v[56:71], a[196:199], v[144:147], v[56:71]
    s_add_u32 s61, s42, 243712
    buffer_store_dwordx4 v[172:175], v191, s[92:95], s61 offen
    v_mfma_f32_32x32x16_bf16 v[56:71], a[236:239], v[148:151], v[56:71]
    v_mfma_f32_32x32x16_bf16 v[56:71], v[212:215], v[152:155], v[56:71]
    v_mfma_f32_32x32x16_bf16 v[56:71], v[252:255], v[156:159], v[56:71]
    s_nop 11
    v_cvt_pk_bf16_f32 v160, v56, v57
    v_cvt_pk_bf16_f32 v161, v58, v59
    v_cvt_pk_bf16_f32 v162, v60, v61
    v_cvt_pk_bf16_f32 v163, v62, v63
    s_add_u32 s61, s42, 278528
    buffer_store_dwordx4 v[160:163], v191, s[92:95], s61 offen
    v_cvt_pk_bf16_f32 v164, v64, v65
    v_cvt_pk_bf16_f32 v165, v66, v67
    v_cvt_pk_bf16_f32 v166, v68, v69
    v_cvt_pk_bf16_f32 v167, v70, v71
    s_add_u32 s61, s42, 313344
    buffer_store_dwordx4 v[164:167], v191, s[92:95], s61 offen
    s_cmp_eq_u32 s43, 0
    s_cbranch_scc0 W_dw
    s_waitcnt vmcnt(0)
    s_barrier
    v_mov_b32 v183, s25
    s_mov_b64 exec, s[54:55]
    buffer_store_dword v183, off, s[12:15], s20
    s_mov_b64 exec, -1
    s_branch W_exit
W_dw:
    s_waitcnt vmcnt(0)
    s_add_u32 s47, s36, 0
    buffer_load_dwordx4 v[96:99], v1, s[12:15], s47 offen offset:0 sc1
    buffer_load_dwordx4 v[100:103], v1, s[12:15], s47 offen offset:1024 sc1
    buffer_load_dwordx4 v[104:107], v1, s[12:15], s47 offen offset:2048 sc1
    buffer_load_dwordx4 v[108:111], v1, s[12:15], s47 offen offset:3072 sc1
    s_add_u32 s47, s36, 4096
    buffer_load_dwordx4 v[112:115], v1, s[12:15], s47 offen offset:0 sc1
    buffer_load_dwordx4 v[116:119], v1, s[12:15], s47 offen offset:1024 sc1
    buffer_load_dwordx4 v[120:123], v1, s[12:15], s47 offen offset:2048 sc1
    buffer_load_dwordx4 v[124:127], v1, s[12:15], s47 offen offset:3072 sc1
    s_add_u32 s47, s36, 8192
    buffer_load_dwordx4 v[128:131], v1, s[12:15], s47 offen offset:0 sc1
    buffer_load_dwordx4 v[132:135], v1, s[12:15], s47 offen offset:1024 sc1
    buffer_load_dwordx4 v[136:139], v1, s[12:15], s47 offen offset:2048 sc1
    buffer_load_dwordx4 v[140:143], v1, s[12:15], s47 offen offset:3072 sc1
    s_add_u32 s47, s36, 12288
    buffer_load_dwordx4 v[144:147], v1, s[12:15], s47 offen offset:0 sc1
    buffer_load_dwordx4 v[148:151], v1, s[12:15], s47 offen offset:1024 sc1
    buffer_load_dwordx4 v[152:155], v1, s[12:15], s47 offen offset:2048 sc1
    buffer_load_dwordx4 v[156:159], v1, s[12:15], s47 offen offset:3072 sc1
    s_waitcnt vmcnt(16)
    s_barrier
    s_branch W_dv
W_dx:
    s_add_u32 s47, s36, 0
    buffer_load_dwordx4 v[96:99], v1, s[12:15], s47 offen offset:0 sc1
    buffer_load_dwordx4 v[100:103], v1, s[12:15], s47 offen offset:1024 sc1
    buffer_load_dwordx4 v[104:107], v1, s[12:15], s47 offen offset:2048 sc1
    buffer_load_dwordx4 v[108:111], v1, s[12:15], s47 offen offset:3072 sc1
    s_add_u32 s47, s36, 4096
    buffer_load_dwordx4 v[112:115], v1, s[12:15], s47 offen offset:0 sc1
    buffer_load_dwordx4 v[116:119], v1, s[12:15], s47 offen offset:1024 sc1
    buffer_load_dwordx4 v[120:123], v1, s[12:15], s47 offen offset:2048 sc1
    buffer_load_dwordx4 v[124:127], v1, s[12:15], s47 offen offset:3072 sc1
    s_add_u32 s47, s36, 8192
    buffer_load_dwordx4 v[128:131], v1, s[12:15], s47 offen offset:0 sc1
    buffer_load_dwordx4 v[132:135], v1, s[12:15], s47 offen offset:1024 sc1
    buffer_load_dwordx4 v[136:139], v1, s[12:15], s47 offen offset:2048 sc1
    buffer_load_dwordx4 v[140:143], v1, s[12:15], s47 offen offset:3072 sc1
    s_add_u32 s47, s36, 12288
    buffer_load_dwordx4 v[144:147], v1, s[12:15], s47 offen offset:0 sc1
    buffer_load_dwordx4 v[148:151], v1, s[12:15], s47 offen offset:1024 sc1
    buffer_load_dwordx4 v[152:155], v1, s[12:15], s47 offen offset:2048 sc1
    buffer_load_dwordx4 v[156:159], v1, s[12:15], s47 offen offset:3072 sc1
    s_sub_u32 s22, s22, 1
    s_cbranch_scc1 W_fail
W_dv:
    s_waitcnt vmcnt(15)
    v_mfma_f32_16x16x32_bf16 v[30:33], v[184:187], v[96:99], 0
    s_waitcnt vmcnt(14)
    v_mfma_f32_16x16x32_bf16 v[30:33], v[184:187], v[100:103], v[30:33]
    s_waitcnt vmcnt(13)
    v_mfma_f32_16x16x32_bf16 v[30:33], v[184:187], v[104:107], v[30:33]
    s_waitcnt vmcnt(12)
    v_mfma_f32_16x16x32_bf16 v[30:33], v[184:187], v[108:111], v[30:33]
    s_waitcnt vmcnt(11)
    v_mfma_f32_16x16x32_bf16 v[30:33], v[184:187], v[112:115], v[30:33]
    s_waitcnt vmcnt(10)
    v_mfma_f32_16x16x32_bf16 v[30:33], v[184:187], v[116:119], v[30:33]
    s_waitcnt vmcnt(9)
    v_mfma_f32_16x16x32_bf16 v[30:33], v[184:187], v[120:123], v[30:33]
    s_waitcnt vmcnt(8)
    v_mfma_f32_16x16x32_bf16 v[30:33], v[184:187], v[124:127], v[30:33]
    s_waitcnt vmcnt(7)
    v_mfma_f32_16x16x32_bf16 v[30:33], v[184:187], v[128:131], v[30:33]
    s_waitcnt vmcnt(6)
    v_mfma_f32_16x16x32_bf16 v[30:33], v[184:187], v[132:135], v[30:33]
    s_waitcnt vmcnt(5)
    v_mfma_f32_16x16x32_bf16 v[30:33], v[184:187], v[136:139], v[30:33]
    s_waitcnt vmcnt(4)
    v_mfma_f32_16x16x32_bf16 v[30:33], v[184:187], v[140:143], v[30:33]
    s_waitcnt vmcnt(3)
    v_mfma_f32_16x16x32_bf16 v[30:33], v[184:187], v[144:147], v[30:33]
    s_waitcnt vmcnt(2)
    v_mfma_f32_16x16x32_bf16 v[30:33], v[184:187], v[148:151], v[30:33]
    s_waitcnt vmcnt(1)
    v_mfma_f32_16x16x32_bf16 v[30:33], v[184:187], v[152:155], v[30:33]
    s_waitcnt vmcnt(0)
    v_mfma_f32_16x16x32_bf16 v[30:33], v[184:187], v[156:159], v[30:33]
    s_nop 7
    v_cmp_u_f32 vcc, v30, v30
    s_cbranch_vccnz W_dx
    s_branch W_fi
W_k2:
    s_mov_b32 m0, s28
    s_nop 0
    buffer_load_dwordx4 v1, s[12:15], s46 offen  lds
    buffer_load_dwordx4 v1, s[12:15], s46 offen offset:1024  lds
    buffer_load_dwordx2 v[180:181], v5, s[12:15], s46 offen
    s_mov_b32 s57, 1
    s_branch W_k2b
W_rdx:
    buffer_load_dword v182, v190, s[12:15], s26 offen sc1
    s_sub_u32 s22, s22, 1
    s_cbranch_scc1 W_fail
    s_waitcnt vmcnt(0)
    s_branch W_rd
W_dnx:
    v_lshlrev_b32 v14, 1, v2
    buffer_load_dwordx2 v[14:15], v14, s[12:15], s26 offen offset:512 sc1
    s_sub_u32 s22, s22, 1
    s_cbranch_scc1 W_fail
    s_branch W_dn
W_exit:
    s_endpgm
W_fail:
    s_mov_b64 exec, 1
    v_mov_b32 v14, s25
    v_add_u32 v14, 0x2000, v14
    v_mov_b32 v15, 248
    global_store_dword v15, v14, s[6:7]
    s_endpgm

.section .rodata,"a"
.p2align 6
.amdhsa_kernel recurrent_scan__memory_aug_recurrent_mem_tr__dense_activation_silu__prompt_kernel
  .amdhsa_next_free_vgpr 512
  .amdhsa_next_free_sgpr 102
  .amdhsa_accum_offset 256
  .amdhsa_group_segment_fixed_size 0
  .amdhsa_kernarg_size 104
  .amdhsa_user_sgpr_count 2
  .amdhsa_user_sgpr_kernarg_segment_ptr 1
  .amdhsa_system_sgpr_workgroup_id_x 1
.end_amdhsa_kernel
```
